```python
import torch

def _softmax(x, axis=-1):
    return torch.softmax(x, dim=axis)

def _gelu(x):
    return torch.nn.functional.gelu(x, approximate='tanh')

def _silu(x):
    return torch.nn.functional.silu(x)

def _sigmoid(x):
    return torch.sigmoid(x)

def _layernorm(x, axis=-1, eps=1e-05):
    m = x.mean(dim=axis, keepdim=True)
    v = x.var(dim=axis, keepdim=True, unbiased=False)
    return (x - m) / torch.sqrt(v + eps)

def _scatter_add(tgt, idx, src, axis=0):
    return tgt.clone().index_add_(axis, idx, src)

def _segment_sum(src, seg, n):
    out = torch.zeros((n,) + src.shape[1:], dtype=src.dtype)
    return out.index_add_(0, seg, src)

def _pad(x, pw):
    flat = tuple((v for pair in reversed(pw) for v in pair))
    return torch.nn.functional.pad(x, flat)
kernel_name = 'parallel_sum__sliding_local_dilated__mixer_gmlp__prompt'

def setup_inputs():

    _w = lambda a: (lambda t: t.to(torch.bfloat16) if t.is_floating_point() else t)(torch.as_tensor(a))

    def _A_setup():
        B, S, D = (1, 2048, 512)
        return {'x': _w((lambda *s: torch.randn(*s, dtype=torch.bfloat16) * 0.05)(B, S, D)), 'wqkv': _w((lambda *s: torch.randn(*s, dtype=torch.bfloat16) * 0.1)(D, 3 * D)), 'wo': _w((lambda *s: torch.randn(*s, dtype=torch.bfloat16) * 0.05)(D, D))}
    _A_in = _A_setup()

    def _B_setup():
        B, S, D, F = (1, 2048, 512, 1376)
        Fh = F // 2
        return {'x': _w((lambda *s: torch.randn(*s, dtype=torch.bfloat16) * 0.05)(B, S, D)), 'w_in': _w((lambda *s: torch.randn(*s, dtype=torch.bfloat16) * 0.4)(D, 2 * Fh)), 'w_sp': _w(0.01 * (lambda *s: torch.randn(*s, dtype=torch.bfloat16) * 0.4)(S, S)), 'b_sp': _w(1.0 + 0.01 * (lambda *s: torch.randn(*s, dtype=torch.bfloat16) * 0.05)(S)), 'w_out': _w((lambda *s: torch.randn(*s, dtype=torch.bfloat16) * 0.05)(Fh, D))}
    _B_in = _B_setup()
    return {'A_x': _A_in['x'], 'A_wqkv': _A_in['wqkv'], 'A_wo': _A_in['wo'], 'B_x': _B_in['x'], 'B_w_in': _B_in['w_in'], 'B_w_sp': _B_in['w_sp'], 'B_b_sp': _B_in['b_sp'], 'B_w_out': _B_in['w_out']}

def reference(A_x, A_wqkv, A_wo, B_x, B_w_in, B_w_sp, B_b_sp, B_w_out):

    def _A_ref(x, wqkv, wo):
        B, S, D = x.shape
        H = 32
        Dh = D // H
        W, dil = (8, 2)
        qkv = (lambda x, *d: x.permute(*d))((x @ wqkv).reshape(B, S, 3, H, Dh), 2, 0, 3, 1, 4)
        q, k, v = (qkv[0], qkv[1], qkv[2])
        scale = Dh ** (-0.5)
        pos = torch.arange(S)
        off = torch.arange(W) * dil
        idx = pos[:, None] - off[None, :]
        mask = idx >= 0
        idx_c = torch.where(mask, idx, 0).reshape(-1)
        kg = k[:, :, idx_c, :].reshape(B, H, S, W, Dh)
        vg = v[:, :, idx_c, :].reshape(B, H, S, W, Dh)
        logits = torch.einsum('bhsd,bhswd->bhsw', q, kg) * scale
        logits = torch.where(mask[None, None, :, :], logits, -1000000000.0)
        attn = _softmax(logits, axis=-1)
        o = torch.einsum('bhsw,bhswd->bhsd', attn, vg)
        return (lambda x, *d: x.permute(*d))(o, 0, 2, 1, 3).reshape(B, S, D) @ wo

    def _B_ref(x, w_in, w_sp, b_sp, w_out):
        B, S, D = x.shape
        F = w_in.shape[-1]
        Fh = F // 2
        z = _gelu(torch.einsum('bsd,df->bsf', x, w_in))
        z1 = z[..., :Fh].clone()
        z2 = _layernorm(z[..., Fh:], axis=-1)
        g = torch.einsum('ts,bsf->btf', w_sp, z2) + b_sp[None, :, None]
        return torch.einsum('bsf,fd->bsd', z1 * g, w_out)
    x = A_x
    xn = _layernorm(x, axis=-1)
    return x + _A_ref(xn, A_wqkv, A_wo) + _B_ref(xn, B_w_in, B_w_sp, B_b_sp, B_w_out)
```

```asm
; @launch grid=(256,1,1) block=(256,1,1) lds=163840
.amdgcn_target "amdgcn-amd-amdhsa--gfx950"
.text
.globl parallel_sum__sliding_local_dilated__mixer_gmlp__prompt_kernel
.p2align 8
.type parallel_sum__sliding_local_dilated__mixer_gmlp__prompt_kernel,@function
parallel_sum__sliding_local_dilated__mixer_gmlp__prompt_kernel:
.set CODE_LAST, (.Lcode_end - parallel_sum__sliding_local_dilated__mixer_gmlp__prompt_kernel - 4096 - 64) / 16 * 16
    s_cmp_ge_u32 s2, 256
    s_cbranch_scc1 .Lend
    s_load_dwordx16 s[64:79], s[0:1], 0
    s_load_dwordx4 s[80:83], s[0:1], 64
    s_load_dwordx2 s[84:85], s[0:1], 80
    s_getpc_b64 s[14:15]
    s_lshr_b32 s6, s2, 3
    s_and_b32 s58, s6, 15
    s_lshl_b32 s58, s58, 12
    s_min_u32 s58, s58, CODE_LAST
    v_lshlrev_b32 v2, 4, v0
    v_add_u32 v2, s58, v2
    global_load_dwordx4 v[252:255], v2, s[14:15]
    v_lshrrev_b32 v2, 6, v0
    v_and_b32 v1, 63, v0
    s_and_b32 s5, s2, 7
    v_readfirstlane_b32 s4, v2
    s_and_b32 s8, s6, 7
    s_bfe_u32 s7, s6, 0x10003
    s_lshl_b32 s58, s5, 1
    s_add_u32 s7, s7, s58
    s_lshl_b32 s3, s7, 2
    s_add_u32 s3, s3, s4
    s_mul_i32 s54, s4, 16384
    s_lshl_b32 s52, s3, 15
    v_lshrrev_b32 v2, 3, v1
    v_lshlrev_b32 v2, 10, v2
    v_lshrrev_b32 v3, 4, v1
    v_and_b32 v11, 7, v1
    v_xor_b32 v3, v3, v11
    v_lshl_add_u32 v4, v3, 4, v2
    v_xor_b32 v5, 64, v4
    v_add_u32 v5, 7168, v5
    v_add_u32 v6, 14336, v4
    v_add_u32 v7, 14336, v5
    s_cmp_ge_u32 s6, 16
    s_cbranch_scc1 .Lrole_a
.Lrole_z:
    s_cmp_eq_u32 s8, 7
    s_cselect_b32 s61, 1, 15
    v_mov_b32 v16, 2147483648
    v_add_u32 v2, 0, v1
    v_mul_u32_u24 v3, 5462, v2
    v_lshrrev_b32 v3, 16, v3
    v_mul_u32_u24 v11, 12, v3
    v_sub_u32 v11, v2, v11
    v_bfe_u32 v2, v3, 3, 1
    v_lshlrev_b32 v2, 1, v2
    v_xor_b32 v11, v11, v2
    v_cmp_lt_u32 vcc, s61, v11
    v_mul_u32_u24 v3, 2752, v3
    v_lshl_add_u32 v8, v11, 4, v3
    v_cndmask_b32 v8, v8, v16, vcc
    v_add_u32 v2, 64, v1
    v_mul_u32_u24 v3, 5462, v2
    v_lshrrev_b32 v3, 16, v3
    v_mul_u32_u24 v11, 12, v3
    v_sub_u32 v11, v2, v11
    v_bfe_u32 v2, v3, 3, 1
    v_lshlrev_b32 v2, 1, v2
    v_xor_b32 v11, v11, v2
    v_cmp_lt_u32 vcc, s61, v11
    v_mul_u32_u24 v3, 2752, v3
    v_lshl_add_u32 v9, v11, 4, v3
    v_subrev_u32 v9, 1024, v9
    v_cndmask_b32 v9, v9, v16, vcc
    v_add_u32 v2, 128, v1
    v_mul_u32_u24 v3, 5462, v2
    v_lshrrev_b32 v3, 16, v3
    v_mul_u32_u24 v11, 12, v3
    v_sub_u32 v11, v2, v11
    v_bfe_u32 v2, v3, 3, 1
    v_lshlrev_b32 v2, 1, v2
    v_xor_b32 v11, v11, v2
    v_cmp_lt_u32 vcc, s61, v11
    v_mul_u32_u24 v3, 2752, v3
    v_lshl_add_u32 v10, v11, 4, v3
    v_subrev_u32 v10, 2048, v10
    v_cndmask_b32 v10, v10, v16, vcc
    s_mul_i32 s58, s8, 192
    s_add_u32 s59, s58, 1408
    s_cmp_eq_u32 s8, 7
    s_cselect_b32 s59, 1376, s59
    s_mul_i32 s60, s4, 44032
    s_add_u32 s53, s59, s60
    s_add_u32 s56, s58, s60
    s_mul_i32 s55, s4, 3072
    s_add_u32 s55, s55, 65536
    v_mov_b32 v31, 0
    v_lshlrev_b32 v28, 4, v1
    s_waitcnt lgkmcnt(0)
    s_and_b32 s71, s6, 7
    s_mov_b32 s16, s64
    s_mov_b32 s17, s65
    s_mov_b32 s18, 2097152
    s_mov_b32 s19, 0x20000
    s_mov_b32 s20, s72
    s_mov_b32 s21, s73
    s_mov_b32 s22, 1409024
    s_mov_b32 s23, 0x20000
    s_mov_b32 s28, s84
    s_mov_b32 s29, s85
    s_mov_b32 s30, 13631488
    s_mov_b32 s31, 0x20000
    s_add_u32 m0, s54, 0
    s_add_u32 s0, s52, 0
    buffer_load_dwordx4 v4, s[16:19], s0 offen offset:0 lds
    buffer_load_dwordx4 v5, s[16:19], s0 offen offset:1024 lds
    buffer_load_dwordx4 v6, s[16:19], s0 offen offset:2048 lds
    buffer_load_dword v86, v31, s[28:31], 0 offen sc1
    buffer_load_dwordx4 v7, s[16:19], s0 offen offset:3072 lds
    s_lshl_b32 s85, s5, 5
    s_add_u32 s85, s85, s6
    s_lshl_b32 s85, s85, 2
    s_add_u32 s85, s85, s4
    s_lshl_b32 s85, s85, 11
    buffer_load_dwordx4 v[192:195], v28, s[16:19], s85 offen offset:0
    s_branch .Lmid_z
.Lrole_a:
    v_lshrrev_b32 v2, 3, v1
    v_mul_u32_u24 v2, 3072, v2
    v_bfe_u32 v3, v1, 4, 1
    v_lshlrev_b32 v3, 2, v3
    v_xor_b32 v3, v3, v11
    v_lshl_add_u32 v8, v3, 4, v2
    v_xor_b32 v9, 32, v8
    v_add_u32 v9, 23552, v9
    s_lshl_b32 s58, s8, 7
    s_mul_i32 s60, s4, 49152
    s_add_u32 s53, s58, s60
    s_lshl_b32 s55, s4, 11
    s_add_u32 s55, s55, 65536
    v_mov_b32 v31, 0
    v_lshlrev_b32 v28, 4, v1
    s_waitcnt lgkmcnt(0)
    s_and_b32 s71, s6, 7
    s_mov_b32 s16, s64
    s_mov_b32 s17, s65
    s_mov_b32 s18, 2097152
    s_mov_b32 s19, 0x20000
    s_mov_b32 s20, s66
    s_mov_b32 s21, s67
    s_mov_b32 s22, 1572864
    s_mov_b32 s23, 0x20000
    s_mov_b32 s28, s84
    s_mov_b32 s29, s85
    s_mov_b32 s30, 13631488
    s_mov_b32 s31, 0x20000
    s_add_u32 m0, s54, 0
    s_add_u32 s0, s52, 0
    buffer_load_dwordx4 v4, s[16:19], s0 offen offset:0 lds
    buffer_load_dwordx4 v5, s[16:19], s0 offen offset:1024 lds
    buffer_load_dwordx4 v6, s[16:19], s0 offen offset:2048 lds
    buffer_load_dword v30, v31, s[28:31], 0 offen sc1
    buffer_load_dwordx4 v7, s[16:19], s0 offen offset:3072 lds
    s_lshl_b32 s85, s5, 5
    s_add_u32 s85, s85, s6
    s_lshl_b32 s85, s85, 2
    s_add_u32 s85, s85, s4
    s_lshl_b32 s85, s85, 11
    buffer_load_dwordx4 v[192:195], v28, s[16:19], s85 offen offset:0
    s_branch .Lmid_a
.Lmid_z:
    s_mov_b32 s24, s74
    s_mov_b32 s25, s75
    s_mov_b32 s26, 8388608
    s_mov_b32 s27, 0x20000
    s_mov_b32 s32, s68
    s_mov_b32 s33, s69
    s_mov_b32 s34, 524288
    s_mov_b32 s35, 0x20000
    s_mov_b32 s36, s78
    s_mov_b32 s37, s79
    s_mov_b32 s38, 704512
    s_mov_b32 s39, 0x20000
    s_mov_b32 s40, s80
    s_mov_b32 s41, s81
    s_mov_b32 s42, 2097152
    s_mov_b32 s43, 0x20000
    s_mov_b32 s44, s76
    s_mov_b32 s45, s77
    s_mov_b32 s46, 4096
    buffer_load_dwordx4 v[196:199], v28, s[16:19], s85 offen offset:1024
    s_mov_b32 s47, 0x20000
    s_mov_b32 s48, s82
    s_mov_b32 s49, s83
    s_mov_b32 s50, 256
    s_mov_b32 s51, 0x20000
    s_getreg_b32 s13, hwreg(HW_REG_XCC_ID, 0, 4)
    s_and_b32 s9, s6, 1
    s_lshl_b32 s58, s5, 2
    s_add_u32 s9, s9, s58
    s_bfe_u32 s10, s6, 0x30001
    v_and_b32 v2, 31, v1
    v_lshlrev_b32 v3, 7, v2
    v_bfe_u32 v2, v1, 1, 3
    v_lshrrev_b32 v11, 5, v1
    v_xor_b32 v2, v2, v11
    v_lshl_add_u32 v12, v2, 4, v3
    v_add_u32 v12, s54, v12
    v_xor_b32 v13, 32, v12
    v_xor_b32 v14, 64, v12
    v_cmp_gt_u32 vcc, 24, v1
    v_mov_b32 v29, 2147483648
    s_nop 0
    v_cndmask_b32 v29, v29, v28, vcc
    s_lshl_b32 s85, s5, 4
    s_and_b32 s84, s6, 15
    s_add_u32 s85, s85, s84
    s_lshl_b32 s85, s85, 2
    s_add_u32 s85, s85, s4
    s_mul_i32 s85, s85, 2752
    s_add_u32 s85, s85, 1344
    buffer_load_dwordx4 v[200:203], v28, s[20:23], s85 offen offset:0
    v_xor_b32 v15, 96, v12
    v_mov_b32 v20, 0x3f803f80
    v_mov_b32 v21, 0x3f803f80
    v_mov_b32 v22, 0x3f803f80
    v_mov_b32 v23, 0x3f803f80
    v_lshrrev_b32 v2, 4, v1
    v_bfe_u32 v3, v1, 2, 2
    v_lshl_add_u32 v16, v2, 3, v3
    v_mul_u32_u24 v16, 192, v16
    v_and_b32 v3, 1, v2
    v_lshl_add_u32 v16, v3, 5, v16
    v_and_b32 v11, 3, v1
    v_lshl_add_u32 v16, v11, 3, v16
    v_add_u32 v16, 65536, v16
    s_cmp_eq_u32 s4, 3
    s_cselect_b32 s68, 0, s4
    s_add_u32 s69, s68, 1
    s_cmp_eq_u32 s69, 3
    s_cselect_b32 s69, 0, s69
    s_add_u32 s85, s85, 1024
    buffer_load_dwordx4 v[204:207], v29, s[20:23], s85 offen offset:0
    s_sub_u32 s70, 3, s68
    s_sub_u32 s70, s70, s69
    v_lshl_add_u32 v18, s69, 6, v16
    v_lshl_add_u32 v64, s70, 6, v16
    v_lshl_add_u32 v16, s68, 6, v16
    v_xor_b32 v17, 32, v16
    v_xor_b32 v19, 32, v18
    v_xor_b32 v65, 32, v64
    v_and_b32 v3, 15, v1
    v_lshlrev_b32 v80, 7, v3
    v_lshrrev_b32 v3, 1, v3
    v_xor_b32 v3, v3, v2
    v_lshl_add_u32 v80, v3, 4, v80
    v_xor_b32 v81, 64, v80
    v_add_u32 v80, s54, v80
    v_add_u32 v81, s54, v81
    v_lshrrev_b32 v11, 5, v1
    v_lshlrev_b32 v11, 4, v11
    v_add_u32 v11, 126976, v11
    s_add_u32 m0, s54, 4096
    s_add_u32 s0, s52, 128
    buffer_load_dwordx4 v4, s[16:19], s0 offen offset:0 lds
    v_lshrrev_b32 v2, 3, v1
    v_lshlrev_b32 v2, 12, v2
    v_lshrrev_b32 v3, 4, v1
    v_and_b32 v11, 7, v1
    v_xor_b32 v3, v3, v11
    v_lshl_add_u32 v76, v3, 4, v2
    v_xor_b32 v77, 64, v76
    v_add_u32 v77, 31744, v77
    v_add_u32 v78, 63488, v76
    v_add_u32 v79, 63488, v77
    v_lshrrev_b32 v2, 3, v1
    v_lshlrev_b32 v2, 10, v2
    v_bfe_u32 v3, v1, 4, 1
    v_lshlrev_b32 v3, 2, v3
    v_and_b32 v87, 7, v1
    v_xor_b32 v3, v3, v87
    v_lshl_add_u32 v87, v3, 4, v2
    s_lshl_b32 s73, s9, 18
    s_lshl_b32 s58, s4, 10
    buffer_load_dwordx4 v5, s[16:19], s0 offen offset:1024 lds
    s_add_u32 s73, s73, s58
    s_lshl_b32 s74, s10, 7
    s_lshl_b32 s58, s4, 17
    s_add_u32 s74, s74, s58
    s_mul_i32 s58, s4, 6400
    s_add_u32 s58, s58, 128000
    v_and_b32 v82, 15, v1
    v_mul_u32_u24 v82, 200, v82
    v_lshrrev_b32 v2, 4, v1
    v_lshl_add_u32 v82, v2, 3, v82
    v_add_u32 v82, s58, v82
    v_lshl_add_u32 v66, s69, 6, v82
    v_lshl_add_u32 v67, s70, 6, v82
    v_lshl_add_u32 v82, s68, 6, v82
    v_lshrrev_b32 v2, 4, v1
    v_bfe_u32 v3, v1, 2, 2
    v_lshrrev_b32 v83, 1, v2
    v_lshl_add_u32 v83, v83, 3, v3
    v_mul_u32_u24 v83, 200, v83
    buffer_load_dwordx4 v6, s[16:19], s0 offen offset:2048 lds
    v_and_b32 v2, 1, v2
    v_lshl_add_u32 v83, v2, 5, v83
    v_and_b32 v2, 3, v1
    v_lshl_add_u32 v83, v2, 3, v83
    v_add_u32 v83, s58, v83
    s_lshl_b32 s75, s3, 12
    s_add_u32 s75, s75, 524288
    s_lshl_b32 s58, s8, 9
    s_add_u32 s76, s75, s58
    s_mul_i32 s77, s8, 393216
    s_mul_i32 s58, s3, 6144
    s_add_u32 s77, s77, s58
    s_add_u32 s77, s77, 1048576
    s_add_u32 s78, s77, 3072
    s_lshl_b32 s79, s8, 6
    s_add_u32 s79, s79, s3
    s_lshl_b32 s79, s79, 7
    s_add_u32 s79, s79, 65536
    s_mul_i32 s80, s3, 49152
    buffer_load_dwordx4 v7, s[16:19], s0 offen offset:3072 lds
    s_mul_i32 s58, s8, 6144
    s_add_u32 s80, s80, s58
    s_add_u32 s80, s80, 4194304
    s_lshl_b32 s58, s69, 11
    s_add_u32 s81, s80, s58
    s_lshl_b32 s58, s70, 11
    s_add_u32 s72, s80, s58
    s_lshl_b32 s58, s68, 11
    s_add_u32 s80, s80, s58
    s_lshl_b32 s63, s3, 7
    s_lshl_b32 s58, s8, 2
    s_add_u32 s63, s63, s58
    s_add_u32 s63, s63, 131072
    s_add_u32 s8, s5, s10
    s_and_b32 s8, s8, 7
    s_add_u32 m0, s54, 8192
    s_add_u32 s0, s52, 256
    buffer_load_dwordx4 v4, s[16:19], s0 offen offset:0 lds
    buffer_load_dwordx4 v5, s[16:19], s0 offen offset:1024 lds
    buffer_load_dwordx4 v6, s[16:19], s0 offen offset:2048 lds
    buffer_load_dwordx4 v7, s[16:19], s0 offen offset:3072 lds
    s_add_u32 m0, s54, 12288
    s_add_u32 s0, s52, 384
    buffer_load_dwordx4 v4, s[16:19], s0 offen offset:0 lds
    s_waitcnt vmcnt(13)
    ds_read_b128 a[0:3], v80 offset:0
    ds_read_b128 a[4:7], v80 offset:2048
    ds_read_b128 a[8:11], v81 offset:0
    ds_read_b128 a[12:15], v81 offset:2048
    buffer_load_dwordx4 v5, s[16:19], s0 offen offset:1024 lds
    buffer_load_dwordx4 v6, s[16:19], s0 offen offset:2048 lds
    buffer_load_dwordx4 v7, s[16:19], s0 offen offset:3072 lds
    s_add_u32 m0, s55, 0
    s_add_u32 s1, s53, 0
    buffer_load_dwordx4 v8, s[20:23], s1 offen offset:0 lds
    buffer_load_dwordx4 v9, s[20:23], s1 offen offset:1024 lds
    buffer_load_dwordx4 v10, s[20:23], s1 offen offset:2048 lds
    s_waitcnt vmcnt(11)
    ds_read_b128 a[16:19], v80 offset:4096
    ds_read_b128 a[20:23], v80 offset:6144
    ds_read_b128 a[24:27], v81 offset:4096
    ds_read_b128 a[28:31], v81 offset:6144
    s_waitcnt lgkmcnt(4)
    s_add_u32 m0, s54, 0
    s_add_u32 s0, s52, 512
    v_mfma_f32_4x4x4_16b_bf16 v[144:147], a[0:1], a[0:1], 0
    v_mfma_f32_4x4x4_16b_bf16 v[148:151], a[4:5], a[4:5], 0
    buffer_load_dwordx4 v4, s[16:19], s0 offen offset:0 lds
    v_mfma_f32_4x4x4_16b_bf16 v[152:155], a[2:3], a[2:3], 0
    v_mfma_f32_4x4x4_16b_bf16 v[156:159], a[6:7], a[6:7], 0
    v_mfma_f32_4x4x4_16b_bf16 v[144:147], a[8:9], a[8:9], v[144:147]
    v_mfma_f32_4x4x4_16b_bf16 v[148:151], a[12:13], a[12:13], v[148:151]
    v_mfma_f32_4x4x4_16b_bf16 v[152:155], a[10:11], a[10:11], v[152:155]
    v_mfma_f32_4x4x4_16b_bf16 v[156:159], a[14:15], a[14:15], v[156:159]
    buffer_load_dwordx4 v5, s[16:19], s0 offen offset:1024 lds
    v_mfma_f32_16x16x32_bf16 v[160:163], v[20:23], a[0:3], 0
    v_mfma_f32_16x16x32_bf16 v[164:167], v[20:23], a[4:7], 0
    v_mfma_f32_16x16x32_bf16 v[160:163], v[20:23], a[8:11], v[160:163]
    buffer_load_dwordx4 v6, s[16:19], s0 offen offset:2048 lds
    v_mfma_f32_16x16x32_bf16 v[164:167], v[20:23], a[12:15], v[164:167]
    buffer_load_dwordx4 v7, s[16:19], s0 offen offset:3072 lds
    s_add_u32 m0, s55, 12288
    s_add_u32 s1, s53, 176128
    s_waitcnt vmcnt(11)
    ds_read_b128 a[32:35], v80 offset:8192
    ds_read_b128 a[36:39], v80 offset:10240
    ds_read_b128 a[40:43], v81 offset:8192
    ds_read_b128 a[44:47], v81 offset:10240
    s_waitcnt lgkmcnt(4)
    buffer_load_dwordx4 v8, s[20:23], s1 offen offset:0 lds
    v_mfma_f32_4x4x4_16b_bf16 v[144:147], a[16:17], a[16:17], v[144:147]
    v_mfma_f32_4x4x4_16b_bf16 v[148:151], a[20:21], a[20:21], v[148:151]
    v_mfma_f32_4x4x4_16b_bf16 v[152:155], a[18:19], a[18:19], v[152:155]
    v_mfma_f32_4x4x4_16b_bf16 v[156:159], a[22:23], a[22:23], v[156:159]
    v_mfma_f32_4x4x4_16b_bf16 v[144:147], a[24:25], a[24:25], v[144:147]
    v_mfma_f32_4x4x4_16b_bf16 v[148:151], a[28:29], a[28:29], v[148:151]
    v_mfma_f32_4x4x4_16b_bf16 v[152:155], a[26:27], a[26:27], v[152:155]
    v_mfma_f32_4x4x4_16b_bf16 v[156:159], a[30:31], a[30:31], v[156:159]
    buffer_load_dwordx4 v9, s[20:23], s1 offen offset:1024 lds
    v_mfma_f32_16x16x32_bf16 v[160:163], v[20:23], a[16:19], v[160:163]
    v_mfma_f32_16x16x32_bf16 v[164:167], v[20:23], a[20:23], v[164:167]
    v_mfma_f32_16x16x32_bf16 v[160:163], v[20:23], a[24:27], v[160:163]
    v_mfma_f32_16x16x32_bf16 v[164:167], v[20:23], a[28:31], v[164:167]
    buffer_load_dwordx4 v10, s[20:23], s1 offen offset:2048 lds
    s_waitcnt vmcnt(10)
    ds_read_b128 a[48:51], v80 offset:12288
    ds_read_b128 a[52:55], v80 offset:14336
    ds_read_b128 a[56:59], v81 offset:12288
    ds_read_b128 a[60:63], v81 offset:14336
    s_waitcnt lgkmcnt(4)
    s_add_u32 m0, s54, 4096
    s_add_u32 s0, s52, 640
    v_mfma_f32_4x4x4_16b_bf16 v[144:147], a[32:33], a[32:33], v[144:147]
    v_mfma_f32_4x4x4_16b_bf16 v[148:151], a[36:37], a[36:37], v[148:151]
    buffer_load_dwordx4 v4, s[16:19], s0 offen offset:0 lds
    v_mfma_f32_4x4x4_16b_bf16 v[152:155], a[34:35], a[34:35], v[152:155]
    v_mfma_f32_4x4x4_16b_bf16 v[156:159], a[38:39], a[38:39], v[156:159]
    v_mfma_f32_4x4x4_16b_bf16 v[144:147], a[40:41], a[40:41], v[144:147]
    v_mfma_f32_4x4x4_16b_bf16 v[148:151], a[44:45], a[44:45], v[148:151]
    v_mfma_f32_4x4x4_16b_bf16 v[152:155], a[42:43], a[42:43], v[152:155]
    v_mfma_f32_4x4x4_16b_bf16 v[156:159], a[46:47], a[46:47], v[156:159]
    buffer_load_dwordx4 v5, s[16:19], s0 offen offset:1024 lds
    v_mfma_f32_16x16x32_bf16 v[160:163], v[20:23], a[32:35], v[160:163]
    v_mfma_f32_16x16x32_bf16 v[164:167], v[20:23], a[36:39], v[164:167]
    v_mfma_f32_16x16x32_bf16 v[160:163], v[20:23], a[40:43], v[160:163]
    buffer_load_dwordx4 v6, s[16:19], s0 offen offset:2048 lds
    v_mfma_f32_16x16x32_bf16 v[164:167], v[20:23], a[44:47], v[164:167]
    s_waitcnt lgkmcnt(0)
    v_mfma_f32_4x4x4_16b_bf16 v[144:147], a[48:49], a[48:49], v[144:147]
    v_mfma_f32_4x4x4_16b_bf16 v[148:151], a[52:53], a[52:53], v[148:151]
    v_mfma_f32_4x4x4_16b_bf16 v[152:155], a[50:51], a[50:51], v[152:155]
    v_mfma_f32_4x4x4_16b_bf16 v[156:159], a[54:55], a[54:55], v[156:159]
    buffer_load_dwordx4 v7, s[16:19], s0 offen offset:3072 lds
    v_mfma_f32_4x4x4_16b_bf16 v[144:147], a[56:57], a[56:57], v[144:147]
    v_mfma_f32_4x4x4_16b_bf16 v[148:151], a[60:61], a[60:61], v[148:151]
    v_mfma_f32_4x4x4_16b_bf16 v[152:155], a[58:59], a[58:59], v[152:155]
    v_mfma_f32_4x4x4_16b_bf16 v[156:159], a[62:63], a[62:63], v[156:159]
    v_mfma_f32_16x16x32_bf16 v[160:163], v[20:23], a[48:51], v[160:163]
    s_lshl_b32 s85, s5, 4
    s_and_b32 s84, s6, 15
    s_add_u32 s85, s85, s84
    s_lshl_b32 s85, s85, 2
    s_add_u32 s85, s85, s4
    s_mul_i32 s85, s85, 2752
    buffer_load_dwordx4 v[208:211], v28, s[20:23], s85 offen offset:0
    v_mfma_f32_16x16x32_bf16 v[164:167], v[20:23], a[52:55], v[164:167]
    v_mfma_f32_16x16x32_bf16 v[160:163], v[20:23], a[56:59], v[160:163]
    v_mfma_f32_16x16x32_bf16 v[164:167], v[20:23], a[60:63], v[164:167]
    s_add_u32 s85, s85, 1024
    buffer_load_dwordx4 v[212:215], v29, s[20:23], s85 offen offset:0
    s_branch .Lrest_z
.Lmid_a:
    s_mov_b32 s24, s74
    s_mov_b32 s25, s75
    s_mov_b32 s26, 8388608
    s_mov_b32 s27, 0x20000
    s_mov_b32 s32, s68
    s_mov_b32 s33, s69
    s_mov_b32 s34, 524288
    s_mov_b32 s35, 0x20000
    s_mov_b32 s36, s78
    s_mov_b32 s37, s79
    s_mov_b32 s38, 704512
    s_mov_b32 s39, 0x20000
    s_mov_b32 s40, s80
    s_mov_b32 s41, s81
    s_mov_b32 s42, 2097152
    s_mov_b32 s43, 0x20000
    s_mov_b32 s44, s76
    s_mov_b32 s45, s77
    s_mov_b32 s46, 4096
    buffer_load_dwordx4 v[196:199], v28, s[16:19], s85 offen offset:1024
    s_mov_b32 s47, 0x20000
    s_mov_b32 s48, s82
    s_mov_b32 s49, s83
    s_mov_b32 s50, 256
    s_mov_b32 s51, 0x20000
    s_getreg_b32 s13, hwreg(HW_REG_XCC_ID, 0, 4)
    s_and_b32 s9, s6, 1
    s_lshl_b32 s58, s5, 2
    s_add_u32 s9, s9, s58
    s_add_u32 s9, s9, 2
    s_bfe_u32 s10, s6, 0x30001
    v_and_b32 v2, 31, v1
    v_lshlrev_b32 v3, 7, v2
    v_bfe_u32 v2, v1, 1, 3
    v_lshrrev_b32 v11, 5, v1
    v_xor_b32 v2, v2, v11
    v_lshl_add_u32 v12, v2, 4, v3
    v_add_u32 v12, s54, v12
    v_xor_b32 v13, 32, v12
    s_lshl_b32 s85, s5, 4
    s_and_b32 s84, s6, 15
    s_add_u32 s85, s85, s84
    s_lshl_b32 s85, s85, 2
    s_add_u32 s85, s85, s4
    s_mul_i32 s85, s85, 3072
    buffer_load_dwordx4 v[200:203], v28, s[20:23], s85 offen offset:0
    v_xor_b32 v14, 64, v12
    v_xor_b32 v15, 96, v12
    v_mov_b32 v20, 0x3f803f80
    v_mov_b32 v21, 0x3f803f80
    v_mov_b32 v22, 0x3f803f80
    v_mov_b32 v23, 0x3f803f80
    v_lshrrev_b32 v2, 4, v1
    v_bfe_u32 v3, v1, 2, 2
    v_lshl_add_u32 v16, v2, 3, v3
    v_lshlrev_b32 v16, 7, v16
    v_lshrrev_b32 v3, 1, v3
    v_lshl_add_u32 v16, v3, 6, v16
    v_and_b32 v3, 1, v2
    v_lshl_add_u32 v16, v3, 5, v16
    v_and_b32 v11, 3, v1
    v_lshl_add_u32 v16, v11, 3, v16
    v_add_u32 v16, 65536, v16
    s_lshl_b32 s58, s4, 5
    v_xor_b32 v16, s58, v16
    s_add_u32 m0, s54, 4096
    s_add_u32 s0, s52, 128
    buffer_load_dwordx4 v4, s[16:19], s0 offen offset:0 lds
    v_xor_b32 v17, 32, v16
    v_xor_b32 v190, 64, v16
    v_xor_b32 v191, 96, v16
    v_and_b32 v3, 15, v1
    v_lshlrev_b32 v188, 7, v3
    v_lshrrev_b32 v3, 1, v3
    v_xor_b32 v3, v3, v2
    v_lshl_add_u32 v188, v3, 4, v188
    v_xor_b32 v189, 64, v188
    v_add_u32 v188, s54, v188
    v_add_u32 v189, s54, v189
    v_and_b32 v3, 15, v1
    v_xor_b32 v2, v2, v3
    v_lshlrev_b32 v19, 10, v3
    v_lshl_add_u32 v19, v2, 4, v19
    v_add_u32 v19, 114688, v19
    v_lshrrev_b32 v10, 5, v1
    v_lshlrev_b32 v10, 4, v10
    v_add_u32 v10, 151808, v10
    buffer_load_dwordx4 v5, s[16:19], s0 offen offset:1024 lds
    v_lshrrev_b32 v2, 3, v1
    v_lshlrev_b32 v2, 12, v2
    v_lshrrev_b32 v3, 4, v1
    v_and_b32 v11, 7, v1
    v_xor_b32 v3, v3, v11
    v_lshl_add_u32 v76, v3, 4, v2
    v_xor_b32 v77, 64, v76
    v_add_u32 v77, 31744, v77
    v_add_u32 v78, 63488, v76
    v_add_u32 v79, 63488, v77
    v_lshrrev_b32 v2, 3, v1
    v_lshlrev_b32 v2, 10, v2
    v_bfe_u32 v3, v1, 4, 1
    v_lshlrev_b32 v3, 2, v3
    v_and_b32 v87, 7, v1
    v_xor_b32 v3, v3, v87
    v_lshl_add_u32 v87, v3, 4, v2
    s_lshl_b32 s73, s9, 18
    s_lshl_b32 s58, s4, 10
    buffer_load_dwordx4 v6, s[16:19], s0 offen offset:2048 lds
    s_add_u32 s73, s73, s58
    s_lshl_b32 s74, s10, 7
    s_lshl_b32 s58, s4, 17
    s_add_u32 s74, s74, s58
    v_and_b32 v2, 31, v1
    s_lshl_b32 s58, s4, 5
    v_add_u32 v2, s58, v2
    v_lshrrev_b32 v3, 5, v1
    v_xor_b32 v3, s4, v3
    v_mul_u32_u24 v176, 144, v2
    v_mul_u32_u24 v177, 272, v2
    v_lshl_add_u32 v176, v3, 5, v176
    v_add_u32 v176, 131360, v176
    v_lshl_add_u32 v177, v3, 6, v177
    v_add_u32 v177, 66080, v177
    v_and_b32 v2, 15, v1
    v_lshrrev_b32 v3, 4, v1
    v_mul_u32_u24 v180, 144, v2
    v_lshl_add_u32 v180, v3, 3, v180
    buffer_load_dwordx4 v7, s[16:19], s0 offen offset:3072 lds
    s_mul_i32 s59, s4, 4608
    s_add_u32 s59, s59, 133376
    v_add_u32 v178, s59, v180
    s_add_u32 s58, s58, 131072
    v_add_u32 v180, s58, v180
    v_mul_u32_u24 v181, 272, v2
    v_lshl_add_u32 v181, v3, 4, v181
    s_mul_i32 s59, s4, 8704
    s_add_u32 s59, s59, 69888
    v_add_u32 v179, s59, v181
    s_lshl_b32 s58, s4, 6
    s_add_u32 s58, s58, 65536
    v_add_u32 v181, s58, v181
    v_mov_b32 v184, 3480120104
    v_mov_b32 v185, 1052289595
    s_lshr_b32 s59, s3, 1
    s_lshl_b32 s59, s59, 16
    s_and_b32 s60, s4, 1
    s_lshl_b32 s60, s60, 10
    s_add_u32 m0, s54, 8192
    s_add_u32 s0, s52, 256
    buffer_load_dwordx4 v4, s[16:19], s0 offen offset:0 lds
    s_add_u32 s59, s59, s60
    s_lshl_b32 s60, s8, 13
    s_add_u32 s59, s59, s60
    s_add_u32 s80, s59, 7340032
    v_and_b32 v2, 31, v1
    v_lshlrev_b32 v186, 4, v2
    v_lshrrev_b32 v3, 5, v1
    v_xor_b32 v3, s4, v3
    v_lshl_add_u32 v186, v3, 11, v186
    s_lshr_b32 s63, s3, 1
    s_lshl_b32 s63, s63, 7
    s_and_b32 s58, s4, 1
    s_lshl_b32 s59, s8, 1
    s_add_u32 s58, s58, s59
    s_lshl_b32 s58, s58, 2
    s_add_u32 s63, s63, s58
    s_add_u32 s63, s63, 196608
    s_add_u32 s8, s5, s10
    s_and_b32 s8, s8, 7
    buffer_load_dwordx4 v5, s[16:19], s0 offen offset:1024 lds
    buffer_load_dwordx4 v6, s[16:19], s0 offen offset:2048 lds
    buffer_load_dwordx4 v7, s[16:19], s0 offen offset:3072 lds
    s_add_u32 m0, s54, 12288
    s_add_u32 s0, s52, 384
    buffer_load_dwordx4 v4, s[16:19], s0 offen offset:0 lds
    buffer_load_dwordx4 v5, s[16:19], s0 offen offset:1024 lds
    s_waitcnt vmcnt(13)
    ds_read_b128 a[0:3], v188 offset:0
    ds_read_b128 a[4:7], v188 offset:2048
    ds_read_b128 a[8:11], v189 offset:0
    ds_read_b128 a[12:15], v189 offset:2048
    buffer_load_dwordx4 v6, s[16:19], s0 offen offset:2048 lds
    buffer_load_dwordx4 v7, s[16:19], s0 offen offset:3072 lds
    s_add_u32 m0, s55, 0
    s_add_u32 s1, s53, 0
    buffer_load_dwordx4 v8, s[20:23], s1 offen offset:0 lds
    buffer_load_dwordx4 v9, s[20:23], s1 offen offset:1024 lds
    s_waitcnt vmcnt(10)
    ds_read_b128 a[16:19], v188 offset:4096
    ds_read_b128 a[20:23], v188 offset:6144
    ds_read_b128 a[24:27], v189 offset:4096
    ds_read_b128 a[28:31], v189 offset:6144
    s_waitcnt lgkmcnt(4)
    s_add_u32 m0, s54, 0
    s_add_u32 s0, s52, 512
    v_mfma_f32_4x4x4_16b_bf16 v[128:131], a[0:1], a[0:1], 0
    v_mfma_f32_4x4x4_16b_bf16 v[132:135], a[4:5], a[4:5], 0
    buffer_load_dwordx4 v4, s[16:19], s0 offen offset:0 lds
    v_mfma_f32_4x4x4_16b_bf16 v[136:139], a[2:3], a[2:3], 0
    v_mfma_f32_4x4x4_16b_bf16 v[140:143], a[6:7], a[6:7], 0
    v_mfma_f32_4x4x4_16b_bf16 v[128:131], a[8:9], a[8:9], v[128:131]
    v_mfma_f32_4x4x4_16b_bf16 v[132:135], a[12:13], a[12:13], v[132:135]
    v_mfma_f32_4x4x4_16b_bf16 v[136:139], a[10:11], a[10:11], v[136:139]
    v_mfma_f32_4x4x4_16b_bf16 v[140:143], a[14:15], a[14:15], v[140:143]
    buffer_load_dwordx4 v5, s[16:19], s0 offen offset:1024 lds
    v_mfma_f32_16x16x32_bf16 v[144:147], v[20:23], a[0:3], 0
    v_mfma_f32_16x16x32_bf16 v[148:151], v[20:23], a[4:7], 0
    v_mfma_f32_16x16x32_bf16 v[144:147], v[20:23], a[8:11], v[144:147]
    buffer_load_dwordx4 v6, s[16:19], s0 offen offset:2048 lds
    v_mfma_f32_16x16x32_bf16 v[148:151], v[20:23], a[12:15], v[148:151]
    buffer_load_dwordx4 v7, s[16:19], s0 offen offset:3072 lds
    s_add_u32 m0, s55, 8192
    s_add_u32 s1, s53, 196608
    s_waitcnt vmcnt(10)
    ds_read_b128 a[32:35], v188 offset:8192
    ds_read_b128 a[36:39], v188 offset:10240
    ds_read_b128 a[40:43], v189 offset:8192
    ds_read_b128 a[44:47], v189 offset:10240
    s_waitcnt lgkmcnt(4)
    buffer_load_dwordx4 v8, s[20:23], s1 offen offset:0 lds
    v_mfma_f32_4x4x4_16b_bf16 v[128:131], a[16:17], a[16:17], v[128:131]
    v_mfma_f32_4x4x4_16b_bf16 v[132:135], a[20:21], a[20:21], v[132:135]
    v_mfma_f32_4x4x4_16b_bf16 v[136:139], a[18:19], a[18:19], v[136:139]
    v_mfma_f32_4x4x4_16b_bf16 v[140:143], a[22:23], a[22:23], v[140:143]
    v_mfma_f32_4x4x4_16b_bf16 v[128:131], a[24:25], a[24:25], v[128:131]
    v_mfma_f32_4x4x4_16b_bf16 v[132:135], a[28:29], a[28:29], v[132:135]
    buffer_load_dwordx4 v9, s[20:23], s1 offen offset:1024 lds
    v_mfma_f32_4x4x4_16b_bf16 v[136:139], a[26:27], a[26:27], v[136:139]
    v_mfma_f32_4x4x4_16b_bf16 v[140:143], a[30:31], a[30:31], v[140:143]
    s_add_u32 m0, s54, 4096
    s_add_u32 s0, s52, 640
    v_mfma_f32_16x16x32_bf16 v[144:147], v[20:23], a[16:19], v[144:147]
    v_mfma_f32_16x16x32_bf16 v[148:151], v[20:23], a[20:23], v[148:151]
    buffer_load_dwordx4 v4, s[16:19], s0 offen offset:0 lds
    v_mfma_f32_16x16x32_bf16 v[144:147], v[20:23], a[24:27], v[144:147]
    v_mfma_f32_16x16x32_bf16 v[148:151], v[20:23], a[28:31], v[148:151]
    buffer_load_dwordx4 v5, s[16:19], s0 offen offset:1024 lds
    s_waitcnt vmcnt(10)
    ds_read_b128 a[48:51], v188 offset:12288
    ds_read_b128 a[52:55], v188 offset:14336
    ds_read_b128 a[56:59], v189 offset:12288
    ds_read_b128 a[60:63], v189 offset:14336
    s_waitcnt lgkmcnt(4)
    buffer_load_dwordx4 v6, s[16:19], s0 offen offset:2048 lds
    v_mfma_f32_4x4x4_16b_bf16 v[128:131], a[32:33], a[32:33], v[128:131]
    v_mfma_f32_4x4x4_16b_bf16 v[132:135], a[36:37], a[36:37], v[132:135]
    v_mfma_f32_4x4x4_16b_bf16 v[136:139], a[34:35], a[34:35], v[136:139]
    v_mfma_f32_4x4x4_16b_bf16 v[140:143], a[38:39], a[38:39], v[140:143]
    v_mfma_f32_4x4x4_16b_bf16 v[128:131], a[40:41], a[40:41], v[128:131]
    v_mfma_f32_4x4x4_16b_bf16 v[132:135], a[44:45], a[44:45], v[132:135]
    buffer_load_dwordx4 v7, s[16:19], s0 offen offset:3072 lds
    v_mfma_f32_4x4x4_16b_bf16 v[136:139], a[42:43], a[42:43], v[136:139]
    v_mfma_f32_4x4x4_16b_bf16 v[140:143], a[46:47], a[46:47], v[140:143]
    v_mfma_f32_16x16x32_bf16 v[144:147], v[20:23], a[32:35], v[144:147]
    v_mfma_f32_16x16x32_bf16 v[148:151], v[20:23], a[36:39], v[148:151]
    s_lshl_b32 s85, s5, 4
    s_and_b32 s84, s6, 15
    s_add_u32 s85, s85, s84
    s_lshl_b32 s85, s85, 2
    s_add_u32 s85, s85, s4
    s_mul_i32 s85, s85, 3072
    s_add_u32 s85, s85, 1024
    buffer_load_dwordx4 v[204:207], v28, s[20:23], s85 offen offset:0
    v_mfma_f32_16x16x32_bf16 v[144:147], v[20:23], a[40:43], v[144:147]
    v_mfma_f32_16x16x32_bf16 v[148:151], v[20:23], a[44:47], v[148:151]
    s_waitcnt lgkmcnt(0)
    v_mfma_f32_4x4x4_16b_bf16 v[128:131], a[48:49], a[48:49], v[128:131]
    v_mfma_f32_4x4x4_16b_bf16 v[132:135], a[52:53], a[52:53], v[132:135]
    buffer_load_dwordx4 v[208:211], v28, s[20:23], s85 offen offset:1024
    v_mfma_f32_4x4x4_16b_bf16 v[136:139], a[50:51], a[50:51], v[136:139]
    v_mfma_f32_4x4x4_16b_bf16 v[140:143], a[54:55], a[54:55], v[140:143]
    s_add_u32 m0, s55, 16384
    s_add_u32 s1, s53, 393216
    v_mfma_f32_4x4x4_16b_bf16 v[128:131], a[56:57], a[56:57], v[128:131]
    v_mfma_f32_4x4x4_16b_bf16 v[132:135], a[60:61], a[60:61], v[132:135]
    buffer_load_dwordx4 v8, s[20:23], s1 offen offset:0 lds
    v_mfma_f32_4x4x4_16b_bf16 v[136:139], a[58:59], a[58:59], v[136:139]
    v_mfma_f32_4x4x4_16b_bf16 v[140:143], a[62:63], a[62:63], v[140:143]
    v_mfma_f32_16x16x32_bf16 v[144:147], v[20:23], a[48:51], v[144:147]
    v_mfma_f32_16x16x32_bf16 v[148:151], v[20:23], a[52:55], v[148:151]
    buffer_load_dwordx4 v9, s[20:23], s1 offen offset:1024 lds
    v_mfma_f32_16x16x32_bf16 v[144:147], v[20:23], a[56:59], v[144:147]
    s_add_u32 m0, s54, 8192
    s_add_u32 s0, s52, 768
    v_mfma_f32_16x16x32_bf16 v[148:151], v[20:23], a[60:63], v[148:151]
    s_waitcnt vmcnt(14)
    v_add_u32 v30, 1, v30
    s_nop 0
    v_readfirstlane_b32 s11, v30
    s_barrier
    s_cmp_lg_u32 s4, 0
    s_cbranch_scc1 .nw0_a_1
    s_mov_b64 exec, 1
    s_lshl_b32 s58, s5, 8
    s_lshl_b32 s59, s6, 3
    s_add_u32 s58, s58, s59
    s_add_u32 s58, s58, 4096
    v_mov_b32 v2, s11
    v_mov_b32 v3, s13
    v_mov_b32 v11, 0
    buffer_store_dwordx2 v[2:3], v11, s[28:31], s58 offen sc1
    s_mov_b64 exec, -1
.nw0_a_1:
    ds_read_b64_tr_b16 v[32:33], v16 offset:0
    ds_read_b64_tr_b16 v[34:35], v16 offset:512
    ds_read_b64_tr_b16 v[36:37], v17 offset:0
    ds_read_b64_tr_b16 v[38:39], v17 offset:512
    ds_read_b64_tr_b16 v[40:41], v190 offset:0
    ds_read_b64_tr_b16 v[42:43], v190 offset:512
    ds_read_b64_tr_b16 v[44:45], v191 offset:0
    ds_read_b64_tr_b16 v[46:47], v191 offset:512
    s_waitcnt lgkmcnt(4)
    v_mfma_f32_16x16x32_bf16 v[96:99], v[32:35], a[0:3], 0
    ds_read_b64_tr_b16 v[48:49], v16 offset:4096
    ds_read_b64_tr_b16 v[50:51], v16 offset:4608
    v_mfma_f32_16x16x32_bf16 v[100:103], v[32:35], a[4:7], 0
    buffer_load_dwordx4 v4, s[16:19], s0 offen offset:0 lds
    v_mfma_f32_16x16x32_bf16 v[88:91], v[32:35], v[20:23], 0
    v_mfma_f32_16x16x32_bf16 v[104:107], v[36:39], a[0:3], 0
    ds_read_b64_tr_b16 v[52:53], v17 offset:4096
    ds_read_b64_tr_b16 v[54:55], v17 offset:4608
    v_mfma_f32_16x16x32_bf16 v[108:111], v[36:39], a[4:7], 0
    buffer_load_dwordx4 v5, s[16:19], s0 offen offset:1024 lds
    s_waitcnt lgkmcnt(4)
    v_mfma_f32_16x16x32_bf16 v[112:115], v[40:43], a[0:3], 0
    ds_read_b64_tr_b16 v[56:57], v190 offset:4096
    ds_read_b64_tr_b16 v[58:59], v190 offset:4608
    v_mfma_f32_16x16x32_bf16 v[116:119], v[40:43], a[4:7], 0
    v_mfma_f32_16x16x32_bf16 v[120:123], v[44:47], a[0:3], 0
    ds_read_b64_tr_b16 v[60:61], v191 offset:4096
    ds_read_b64_tr_b16 v[62:63], v191 offset:4608
    v_mfma_f32_16x16x32_bf16 v[124:127], v[44:47], a[4:7], 0
    buffer_load_dwordx4 v6, s[16:19], s0 offen offset:2048 lds
    s_waitcnt vmcnt(13)
    ds_read_b128 a[64:67], v188 offset:0
    ds_read_b128 a[68:71], v188 offset:2048
    ds_read_b128 a[72:75], v189 offset:0
    ds_read_b128 a[76:79], v189 offset:2048
    s_waitcnt lgkmcnt(8)
    v_mfma_f32_16x16x32_bf16 v[96:99], v[48:51], a[8:11], v[96:99]
    s_waitcnt vmcnt(11)
    s_barrier
    ds_read_b64_tr_b16 v[32:33], v16 offset:8192
    ds_read_b64_tr_b16 v[34:35], v16 offset:8704
    v_mfma_f32_16x16x32_bf16 v[100:103], v[48:51], a[12:15], v[100:103]
    buffer_load_dwordx4 v7, s[16:19], s0 offen offset:3072 lds
    v_mfma_f32_16x16x32_bf16 v[88:91], v[48:51], v[20:23], v[88:91]
    v_mfma_f32_16x16x32_bf16 v[104:107], v[52:55], a[8:11], v[104:107]
    ds_read_b64_tr_b16 v[36:37], v17 offset:8192
    ds_read_b64_tr_b16 v[38:39], v17 offset:8704
    v_mfma_f32_16x16x32_bf16 v[108:111], v[52:55], a[12:15], v[108:111]
    s_add_u32 m0, s55, 24576
    s_add_u32 s1, s53, 589824
    s_waitcnt lgkmcnt(8)
    v_mfma_f32_16x16x32_bf16 v[112:115], v[56:59], a[8:11], v[112:115]
    ds_read_b64_tr_b16 v[40:41], v190 offset:8192
    ds_read_b64_tr_b16 v[42:43], v190 offset:8704
    v_mfma_f32_16x16x32_bf16 v[116:119], v[56:59], a[12:15], v[116:119]
    buffer_load_dwordx4 v8, s[20:23], s1 offen offset:0 lds
    v_mfma_f32_16x16x32_bf16 v[120:123], v[60:63], a[8:11], v[120:123]
    ds_read_b64_tr_b16 v[44:45], v191 offset:8192
    ds_read_b64_tr_b16 v[46:47], v191 offset:8704
    v_mfma_f32_16x16x32_bf16 v[124:127], v[60:63], a[12:15], v[124:127]
    s_waitcnt lgkmcnt(8)
    v_mfma_f32_4x4x4_16b_bf16 v[128:131], a[64:65], a[64:65], v[128:131]
    v_mfma_f32_4x4x4_16b_bf16 v[132:135], a[68:69], a[68:69], v[132:135]
    v_mfma_f32_4x4x4_16b_bf16 v[136:139], a[66:67], a[66:67], v[136:139]
    v_mfma_f32_4x4x4_16b_bf16 v[140:143], a[70:71], a[70:71], v[140:143]
    v_mfma_f32_4x4x4_16b_bf16 v[128:131], a[72:73], a[72:73], v[128:131]
    v_mfma_f32_4x4x4_16b_bf16 v[132:135], a[76:77], a[76:77], v[132:135]
    v_mfma_f32_4x4x4_16b_bf16 v[136:139], a[74:75], a[74:75], v[136:139]
    v_mfma_f32_4x4x4_16b_bf16 v[140:143], a[78:79], a[78:79], v[140:143]
    v_mfma_f32_16x16x32_bf16 v[144:147], v[20:23], a[64:67], v[144:147]
    v_mfma_f32_16x16x32_bf16 v[148:151], v[20:23], a[68:71], v[148:151]
    v_mfma_f32_16x16x32_bf16 v[144:147], v[20:23], a[72:75], v[144:147]
    v_mfma_f32_16x16x32_bf16 v[148:151], v[20:23], a[76:79], v[148:151]
    s_waitcnt lgkmcnt(4)
    v_mfma_f32_16x16x32_bf16 v[96:99], v[32:35], a[16:19], v[96:99]
    ds_read_b64_tr_b16 v[48:49], v16 offset:12288
    ds_read_b64_tr_b16 v[50:51], v16 offset:12800
    v_mfma_f32_16x16x32_bf16 v[100:103], v[32:35], a[20:23], v[100:103]
    buffer_load_dwordx4 v9, s[20:23], s1 offen offset:1024 lds
    v_mfma_f32_16x16x32_bf16 v[88:91], v[32:35], v[20:23], v[88:91]
    v_mfma_f32_16x16x32_bf16 v[104:107], v[36:39], a[16:19], v[104:107]
    ds_read_b64_tr_b16 v[52:53], v17 offset:12288
    ds_read_b64_tr_b16 v[54:55], v17 offset:12800
    v_mfma_f32_16x16x32_bf16 v[108:111], v[36:39], a[20:23], v[108:111]
    s_add_u32 m0, s54, 12288
    s_add_u32 s0, s52, 896
    s_waitcnt lgkmcnt(4)
    v_mfma_f32_16x16x32_bf16 v[112:115], v[40:43], a[16:19], v[112:115]
    ds_read_b64_tr_b16 v[56:57], v190 offset:12288
    ds_read_b64_tr_b16 v[58:59], v190 offset:12800
    v_mfma_f32_16x16x32_bf16 v[116:119], v[40:43], a[20:23], v[116:119]
    buffer_load_dwordx4 v4, s[16:19], s0 offen offset:0 lds
    v_mfma_f32_16x16x32_bf16 v[120:123], v[44:47], a[16:19], v[120:123]
    ds_read_b64_tr_b16 v[60:61], v191 offset:12288
    ds_read_b64_tr_b16 v[62:63], v191 offset:12800
    v_mfma_f32_16x16x32_bf16 v[124:127], v[44:47], a[20:23], v[124:127]
    s_waitcnt vmcnt(11)
    ds_read_b128 a[80:83], v188 offset:4096
    ds_read_b128 a[84:87], v188 offset:6144
    ds_read_b128 a[88:91], v189 offset:4096
    ds_read_b128 a[92:95], v189 offset:6144
    s_waitcnt lgkmcnt(8)
    v_mfma_f32_16x16x32_bf16 v[96:99], v[48:51], a[24:27], v[96:99]
    buffer_load_dwordx4 v5, s[16:19], s0 offen offset:1024 lds
    buffer_load_dwordx4 v6, s[16:19], s0 offen offset:2048 lds
    buffer_load_dwordx4 v7, s[16:19], s0 offen offset:3072 lds
    s_waitcnt vmcnt(10)
    s_barrier
    ds_read_b64_tr_b16 v[32:33], v16 offset:16384
    ds_read_b64_tr_b16 v[34:35], v16 offset:16896
    v_mfma_f32_16x16x32_bf16 v[100:103], v[48:51], a[28:31], v[100:103]
    s_add_u32 m0, s55, 32768
    s_add_u32 s1, s53, 786432
    v_mfma_f32_16x16x32_bf16 v[88:91], v[48:51], v[20:23], v[88:91]
    v_mfma_f32_16x16x32_bf16 v[104:107], v[52:55], a[24:27], v[104:107]
    ds_read_b64_tr_b16 v[36:37], v17 offset:16384
    ds_read_b64_tr_b16 v[38:39], v17 offset:16896
    v_mfma_f32_16x16x32_bf16 v[108:111], v[52:55], a[28:31], v[108:111]
    buffer_load_dwordx4 v8, s[20:23], s1 offen offset:0 lds
    s_waitcnt lgkmcnt(8)
    v_mfma_f32_16x16x32_bf16 v[112:115], v[56:59], a[24:27], v[112:115]
    ds_read_b64_tr_b16 v[40:41], v190 offset:16384
    ds_read_b64_tr_b16 v[42:43], v190 offset:16896
    v_mfma_f32_16x16x32_bf16 v[116:119], v[56:59], a[28:31], v[116:119]
    v_mfma_f32_16x16x32_bf16 v[120:123], v[60:63], a[24:27], v[120:123]
    ds_read_b64_tr_b16 v[44:45], v191 offset:16384
    ds_read_b64_tr_b16 v[46:47], v191 offset:16896
    v_mfma_f32_16x16x32_bf16 v[124:127], v[60:63], a[28:31], v[124:127]
    buffer_load_dwordx4 v9, s[20:23], s1 offen offset:1024 lds
    s_waitcnt lgkmcnt(8)
    v_mfma_f32_4x4x4_16b_bf16 v[128:131], a[80:81], a[80:81], v[128:131]
    v_mfma_f32_4x4x4_16b_bf16 v[132:135], a[84:85], a[84:85], v[132:135]
    v_mfma_f32_4x4x4_16b_bf16 v[136:139], a[82:83], a[82:83], v[136:139]
    v_mfma_f32_4x4x4_16b_bf16 v[140:143], a[86:87], a[86:87], v[140:143]
    v_mfma_f32_4x4x4_16b_bf16 v[128:131], a[88:89], a[88:89], v[128:131]
    v_mfma_f32_4x4x4_16b_bf16 v[132:135], a[92:93], a[92:93], v[132:135]
    v_mfma_f32_4x4x4_16b_bf16 v[136:139], a[90:91], a[90:91], v[136:139]
    v_mfma_f32_4x4x4_16b_bf16 v[140:143], a[94:95], a[94:95], v[140:143]
    v_mfma_f32_16x16x32_bf16 v[144:147], v[20:23], a[80:83], v[144:147]
    v_mfma_f32_16x16x32_bf16 v[148:151], v[20:23], a[84:87], v[148:151]
    v_mfma_f32_16x16x32_bf16 v[144:147], v[20:23], a[88:91], v[144:147]
    v_mfma_f32_16x16x32_bf16 v[148:151], v[20:23], a[92:95], v[148:151]
    s_waitcnt lgkmcnt(4)
    v_mfma_f32_16x16x32_bf16 v[96:99], v[32:35], a[32:35], v[96:99]
    ds_read_b64_tr_b16 v[48:49], v16 offset:20480
    ds_read_b64_tr_b16 v[50:51], v16 offset:20992
    v_mfma_f32_16x16x32_bf16 v[100:103], v[32:35], a[36:39], v[100:103]
    s_add_u32 m0, s55, 40960
    s_add_u32 s1, s53, 983040
    v_mfma_f32_16x16x32_bf16 v[88:91], v[32:35], v[20:23], v[88:91]
    v_mfma_f32_16x16x32_bf16 v[104:107], v[36:39], a[32:35], v[104:107]
    ds_read_b64_tr_b16 v[52:53], v17 offset:20480
    ds_read_b64_tr_b16 v[54:55], v17 offset:20992
    v_mfma_f32_16x16x32_bf16 v[108:111], v[36:39], a[36:39], v[108:111]
    buffer_load_dwordx4 v8, s[20:23], s1 offen offset:0 lds
    s_waitcnt lgkmcnt(4)
    v_mfma_f32_16x16x32_bf16 v[112:115], v[40:43], a[32:35], v[112:115]
    ds_read_b64_tr_b16 v[56:57], v190 offset:20480
    ds_read_b64_tr_b16 v[58:59], v190 offset:20992
    v_mfma_f32_16x16x32_bf16 v[116:119], v[40:43], a[36:39], v[116:119]
    v_mfma_f32_16x16x32_bf16 v[120:123], v[44:47], a[32:35], v[120:123]
    ds_read_b64_tr_b16 v[60:61], v191 offset:20480
    ds_read_b64_tr_b16 v[62:63], v191 offset:20992
    v_mfma_f32_16x16x32_bf16 v[124:127], v[44:47], a[36:39], v[124:127]
    buffer_load_dwordx4 v9, s[20:23], s1 offen offset:1024 lds
    s_waitcnt vmcnt(10)
    ds_read_b128 a[96:99], v188 offset:8192
    ds_read_b128 a[100:103], v188 offset:10240
    ds_read_b128 a[104:107], v189 offset:8192
    ds_read_b128 a[108:111], v189 offset:10240
    s_waitcnt lgkmcnt(8)
    v_mfma_f32_16x16x32_bf16 v[96:99], v[48:51], a[40:43], v[96:99]
    s_lshl_b32 s0, s4, 2
    s_add_u32 s0, s0, 0
    v_xor_b32 v2, s0, v1
    v_lshlrev_b32 v2, 4, v2
    s_lshl_b32 s0, s0, 10
    s_add_u32 m0, s0, 114688
    s_lshl_b32 s84, s7, 17
    s_add_u32 s0, s0, s84
    s_sub_u32 s0, s0, 16384
    s_cmp_eq_u32 s7, 0
    s_cselect_b32 s0, 2147418112, s0
    buffer_load_dwordx4 v2, s[16:19], s0 offen lds
    s_lshl_b32 s0, s4, 2
    s_add_u32 s0, s0, 1
    v_xor_b32 v2, s0, v1
    v_lshlrev_b32 v2, 4, v2
    s_lshl_b32 s0, s0, 10
    s_add_u32 m0, s0, 114688
    s_lshl_b32 s84, s7, 17
    s_add_u32 s0, s0, s84
    s_sub_u32 s0, s0, 16384
    s_cmp_eq_u32 s7, 0
    s_cselect_b32 s0, 2147418112, s0
    buffer_load_dwordx4 v2, s[16:19], s0 offen lds
    s_lshl_b32 s0, s4, 2
    s_add_u32 s0, s0, 2
    v_xor_b32 v2, s0, v1
    v_lshlrev_b32 v2, 4, v2
    s_lshl_b32 s0, s0, 10
    s_add_u32 m0, s0, 114688
    s_lshl_b32 s84, s7, 17
    s_add_u32 s0, s0, s84
    s_sub_u32 s0, s0, 16384
    s_cmp_eq_u32 s7, 0
    s_cselect_b32 s0, 2147418112, s0
    buffer_load_dwordx4 v2, s[16:19], s0 offen lds
    s_lshl_b32 s0, s4, 2
    s_add_u32 s0, s0, 3
    v_xor_b32 v2, s0, v1
    v_lshlrev_b32 v2, 4, v2
    s_lshl_b32 s0, s0, 10
    s_add_u32 m0, s0, 114688
    s_lshl_b32 s84, s7, 17
    s_add_u32 s0, s0, s84
    s_sub_u32 s0, s0, 16384
    s_cmp_eq_u32 s7, 0
    s_cselect_b32 s0, 2147418112, s0
    buffer_load_dwordx4 v2, s[16:19], s0 offen lds
    s_waitcnt vmcnt(12)
    s_barrier
    ds_read_b64_tr_b16 v[32:33], v16 offset:24576
    ds_read_b64_tr_b16 v[34:35], v16 offset:25088
    v_mfma_f32_16x16x32_bf16 v[100:103], v[48:51], a[44:47], v[100:103]
    s_add_u32 m0, s55, 0
    s_add_u32 s1, s53, 1179648
    v_mfma_f32_16x16x32_bf16 v[88:91], v[48:51], v[20:23], v[88:91]
    v_mfma_f32_16x16x32_bf16 v[104:107], v[52:55], a[40:43], v[104:107]
    ds_read_b64_tr_b16 v[36:37], v17 offset:24576
    ds_read_b64_tr_b16 v[38:39], v17 offset:25088
    v_mfma_f32_16x16x32_bf16 v[108:111], v[52:55], a[44:47], v[108:111]
    buffer_load_dwordx4 v8, s[20:23], s1 offen offset:0 lds
    s_waitcnt lgkmcnt(8)
    v_mfma_f32_16x16x32_bf16 v[112:115], v[56:59], a[40:43], v[112:115]
    ds_read_b64_tr_b16 v[40:41], v190 offset:24576
    ds_read_b64_tr_b16 v[42:43], v190 offset:25088
    v_mfma_f32_16x16x32_bf16 v[116:119], v[56:59], a[44:47], v[116:119]
    v_mfma_f32_16x16x32_bf16 v[120:123], v[60:63], a[40:43], v[120:123]
    ds_read_b64_tr_b16 v[44:45], v191 offset:24576
    ds_read_b64_tr_b16 v[46:47], v191 offset:25088
    v_mfma_f32_16x16x32_bf16 v[124:127], v[60:63], a[44:47], v[124:127]
    buffer_load_dwordx4 v9, s[20:23], s1 offen offset:1024 lds
    s_waitcnt lgkmcnt(8)
    v_mfma_f32_4x4x4_16b_bf16 v[128:131], a[96:97], a[96:97], v[128:131]
    v_mfma_f32_4x4x4_16b_bf16 v[132:135], a[100:101], a[100:101], v[132:135]
    v_mfma_f32_4x4x4_16b_bf16 v[136:139], a[98:99], a[98:99], v[136:139]
    v_mfma_f32_4x4x4_16b_bf16 v[140:143], a[102:103], a[102:103], v[140:143]
    v_mfma_f32_4x4x4_16b_bf16 v[128:131], a[104:105], a[104:105], v[128:131]
    v_mfma_f32_4x4x4_16b_bf16 v[132:135], a[108:109], a[108:109], v[132:135]
    v_mfma_f32_4x4x4_16b_bf16 v[136:139], a[106:107], a[106:107], v[136:139]
    v_mfma_f32_4x4x4_16b_bf16 v[140:143], a[110:111], a[110:111], v[140:143]
    v_mfma_f32_16x16x32_bf16 v[144:147], v[20:23], a[96:99], v[144:147]
    v_mfma_f32_16x16x32_bf16 v[148:151], v[20:23], a[100:103], v[148:151]
    v_mfma_f32_16x16x32_bf16 v[144:147], v[20:23], a[104:107], v[144:147]
    v_mfma_f32_16x16x32_bf16 v[148:151], v[20:23], a[108:111], v[148:151]
    s_waitcnt lgkmcnt(4)
    v_mfma_f32_16x16x32_bf16 v[96:99], v[32:35], a[48:51], v[96:99]
    ds_read_b64_tr_b16 v[48:49], v16 offset:28672
    ds_read_b64_tr_b16 v[50:51], v16 offset:29184
    v_mfma_f32_16x16x32_bf16 v[100:103], v[32:35], a[52:55], v[100:103]
    s_add_u32 m0, s55, 8192
    s_add_u32 s1, s53, 1376256
    v_mfma_f32_16x16x32_bf16 v[88:91], v[32:35], v[20:23], v[88:91]
    v_mfma_f32_16x16x32_bf16 v[104:107], v[36:39], a[48:51], v[104:107]
    ds_read_b64_tr_b16 v[52:53], v17 offset:28672
    ds_read_b64_tr_b16 v[54:55], v17 offset:29184
    v_mfma_f32_16x16x32_bf16 v[108:111], v[36:39], a[52:55], v[108:111]
    buffer_load_dwordx4 v8, s[20:23], s1 offen offset:0 lds
    s_waitcnt lgkmcnt(4)
    v_mfma_f32_16x16x32_bf16 v[112:115], v[40:43], a[48:51], v[112:115]
    ds_read_b64_tr_b16 v[56:57], v190 offset:28672
    ds_read_b64_tr_b16 v[58:59], v190 offset:29184
    v_mfma_f32_16x16x32_bf16 v[116:119], v[40:43], a[52:55], v[116:119]
    v_mfma_f32_16x16x32_bf16 v[120:123], v[44:47], a[48:51], v[120:123]
    ds_read_b64_tr_b16 v[60:61], v191 offset:28672
    ds_read_b64_tr_b16 v[62:63], v191 offset:29184
    v_mfma_f32_16x16x32_bf16 v[124:127], v[44:47], a[52:55], v[124:127]
    buffer_load_dwordx4 v9, s[20:23], s1 offen offset:1024 lds
    s_waitcnt vmcnt(12)
    ds_read_b128 a[112:115], v188 offset:12288
    ds_read_b128 a[116:119], v188 offset:14336
    ds_read_b128 a[120:123], v189 offset:12288
    ds_read_b128 a[124:127], v189 offset:14336
    s_waitcnt lgkmcnt(8)
    v_mfma_f32_16x16x32_bf16 v[96:99], v[48:51], a[56:59], v[96:99]
    s_waitcnt vmcnt(10)
    s_barrier
    ds_read_b64_tr_b16 v[32:33], v16 offset:32768
    ds_read_b64_tr_b16 v[34:35], v16 offset:33280
    v_mfma_f32_16x16x32_bf16 v[100:103], v[48:51], a[60:63], v[100:103]
    s_lshl_b32 s85, s5, 4
    s_and_b32 s84, s6, 15
    s_add_u32 s85, s85, s84
    s_lshl_b32 s85, s85, 2
    s_add_u32 s85, s85, s4
    s_lshl_b32 s85, s85, 10
    buffer_load_dwordx4 v[212:215], v28, s[32:35], s85 offen offset:0
    v_mfma_f32_16x16x32_bf16 v[88:91], v[48:51], v[20:23], v[88:91]
    v_mfma_f32_16x16x32_bf16 v[104:107], v[52:55], a[56:59], v[104:107]
    ds_read_b64_tr_b16 v[36:37], v17 offset:32768
    ds_read_b64_tr_b16 v[38:39], v17 offset:33280
    v_mfma_f32_16x16x32_bf16 v[108:111], v[52:55], a[60:63], v[108:111]
    s_lshl_b32 s85, s5, 4
    s_and_b32 s84, s6, 15
    s_add_u32 s85, s85, s84
    s_lshl_b32 s85, s85, 2
    s_add_u32 s85, s85, s4
    s_mul_i32 s85, s85, 1408
    buffer_load_dwordx4 v[216:219], v28, s[36:39], s85 offen offset:0
    s_waitcnt lgkmcnt(8)
    v_mfma_f32_16x16x32_bf16 v[112:115], v[56:59], a[56:59], v[112:115]
    ds_read_b64_tr_b16 v[40:41], v190 offset:32768
    ds_read_b64_tr_b16 v[42:43], v190 offset:33280
    v_mfma_f32_16x16x32_bf16 v[116:119], v[56:59], a[60:63], v[116:119]
    v_mfma_f32_16x16x32_bf16 v[120:123], v[60:63], a[56:59], v[120:123]
    ds_read_b64_tr_b16 v[44:45], v191 offset:32768
    ds_read_b64_tr_b16 v[46:47], v191 offset:33280
    v_mfma_f32_16x16x32_bf16 v[124:127], v[60:63], a[60:63], v[124:127]
    buffer_load_dwordx4 v[220:223], v28, s[36:39], s85 offen offset:1024
    s_waitcnt lgkmcnt(8)
    v_mfma_f32_4x4x4_16b_bf16 v[128:131], a[112:113], a[112:113], v[128:131]
    v_mfma_f32_4x4x4_16b_bf16 v[132:135], a[116:117], a[116:117], v[132:135]
    v_mfma_f32_4x4x4_16b_bf16 v[136:139], a[114:115], a[114:115], v[136:139]
    v_mfma_f32_4x4x4_16b_bf16 v[140:143], a[118:119], a[118:119], v[140:143]
    v_mfma_f32_4x4x4_16b_bf16 v[128:131], a[120:121], a[120:121], v[128:131]
    v_mfma_f32_4x4x4_16b_bf16 v[132:135], a[124:125], a[124:125], v[132:135]
    v_mfma_f32_4x4x4_16b_bf16 v[136:139], a[122:123], a[122:123], v[136:139]
    v_mfma_f32_4x4x4_16b_bf16 v[140:143], a[126:127], a[126:127], v[140:143]
    v_mfma_f32_16x16x32_bf16 v[144:147], v[20:23], a[112:115], v[144:147]
    v_mfma_f32_16x16x32_bf16 v[148:151], v[20:23], a[116:119], v[148:151]
    v_mfma_f32_16x16x32_bf16 v[144:147], v[20:23], a[120:123], v[144:147]
    v_mfma_f32_16x16x32_bf16 v[148:151], v[20:23], a[124:127], v[148:151]
    s_waitcnt lgkmcnt(4)
    v_mfma_f32_16x16x32_bf16 v[96:99], v[32:35], a[64:67], v[96:99]
    ds_read_b64_tr_b16 v[48:49], v16 offset:36864
    ds_read_b64_tr_b16 v[50:51], v16 offset:37376
    v_mfma_f32_16x16x32_bf16 v[100:103], v[32:35], a[68:71], v[100:103]
    s_add_u32 m0, s55, 16384
    s_add_u32 s1, s53, 1024
    v_mfma_f32_16x16x32_bf16 v[88:91], v[32:35], v[20:23], v[88:91]
    v_mfma_f32_16x16x32_bf16 v[104:107], v[36:39], a[64:67], v[104:107]
    ds_read_b64_tr_b16 v[52:53], v17 offset:36864
    ds_read_b64_tr_b16 v[54:55], v17 offset:37376
    v_mfma_f32_16x16x32_bf16 v[108:111], v[36:39], a[68:71], v[108:111]
    buffer_load_dwordx4 v8, s[20:23], s1 offen offset:0 lds
    s_waitcnt lgkmcnt(4)
    v_mfma_f32_16x16x32_bf16 v[112:115], v[40:43], a[64:67], v[112:115]
    ds_read_b64_tr_b16 v[56:57], v190 offset:36864
    ds_read_b64_tr_b16 v[58:59], v190 offset:37376
    v_mfma_f32_16x16x32_bf16 v[116:119], v[40:43], a[68:71], v[116:119]
    v_mfma_f32_16x16x32_bf16 v[120:123], v[44:47], a[64:67], v[120:123]
    ds_read_b64_tr_b16 v[60:61], v191 offset:36864
    ds_read_b64_tr_b16 v[62:63], v191 offset:37376
    v_mfma_f32_16x16x32_bf16 v[124:127], v[44:47], a[68:71], v[124:127]
    buffer_load_dwordx4 v9, s[20:23], s1 offen offset:1024 lds
    s_mov_b32 s64, 0xaaaaaaaa
    s_mov_b32 s65, 0xaaaaaaaa
    s_mov_b32 s66, 0xcccccccc
    s_mov_b32 s67, 0xcccccccc
    v_pk_add_f32 v[128:129], v[128:129], v[136:137]
    v_pk_add_f32 v[130:131], v[130:131], v[138:139]
    v_pk_add_f32 v[132:133], v[132:133], v[140:141]
    v_pk_add_f32 v[134:135], v[134:135], v[142:143]
    v_cndmask_b32 v128, v128, v129, s[64:65]
    v_cndmask_b32 v130, v130, v131, s[64:65]
    v_cndmask_b32 v132, v132, v133, s[64:65]
    v_cndmask_b32 v134, v134, v135, s[64:65]
    v_cndmask_b32 v128, v128, v130, s[66:67]
    v_cndmask_b32 v132, v132, v134, s[66:67]
    v_mov_b32 v129, v128
    v_mov_b32 v133, v132
    s_nop 0
    v_permlane32_swap_b32 v128, v129
    v_permlane32_swap_b32 v132, v133
    v_add_f32 v128, v128, v129
    v_add_f32 v132, v132, v133
    v_mov_b32 v129, v128
    v_mov_b32 v133, v132
    s_nop 0
    v_permlane16_swap_b32 v128, v129
    v_permlane16_swap_b32 v132, v133
    v_add_f32 v128, v128, v129
    v_add_f32 v132, v132, v133
    v_mul_f32 v24, 3137339392, v144
    v_mul_f32 v129, 989855744, v128
    v_fma_f32 v129, -v24, v24, v129
    v_max_f32 v129, 0, v129
    v_add_f32 v129, 925353388, v129
    v_rsq_f32 v25, v129
    v_mul_f32 v26, 3137339392, v148
    v_mul_f32 v133, 989855744, v132
    v_fma_f32 v133, -v26, v26, v133
    v_max_f32 v133, 0, v133
    v_add_f32 v133, 925353388, v133
    v_rsq_f32 v27, v133
    s_waitcnt lgkmcnt(4)
    v_mfma_f32_16x16x32_bf16 v[96:99], v[48:51], a[72:75], v[96:99]
    s_waitcnt vmcnt(13)
    s_barrier
    ds_read_b64_tr_b16 v[32:33], v16 offset:40960
    ds_read_b64_tr_b16 v[34:35], v16 offset:41472
    v_mfma_f32_16x16x32_bf16 v[100:103], v[48:51], a[76:79], v[100:103]
    s_add_u32 m0, s55, 24576
    s_add_u32 s1, s53, 197632
    v_mfma_f32_16x16x32_bf16 v[88:91], v[48:51], v[20:23], v[88:91]
    v_mfma_f32_16x16x32_bf16 v[104:107], v[52:55], a[72:75], v[104:107]
    ds_read_b64_tr_b16 v[36:37], v17 offset:40960
    ds_read_b64_tr_b16 v[38:39], v17 offset:41472
    v_mfma_f32_16x16x32_bf16 v[108:111], v[52:55], a[76:79], v[108:111]
    buffer_load_dwordx4 v8, s[20:23], s1 offen offset:0 lds
    s_waitcnt lgkmcnt(4)
    v_mfma_f32_16x16x32_bf16 v[112:115], v[56:59], a[72:75], v[112:115]
    ds_read_b64_tr_b16 v[40:41], v190 offset:40960
    ds_read_b64_tr_b16 v[42:43], v190 offset:41472
    v_mfma_f32_16x16x32_bf16 v[116:119], v[56:59], a[76:79], v[116:119]
    v_mfma_f32_16x16x32_bf16 v[120:123], v[60:63], a[72:75], v[120:123]
    ds_read_b64_tr_b16 v[44:45], v191 offset:40960
    ds_read_b64_tr_b16 v[46:47], v191 offset:41472
    v_mfma_f32_16x16x32_bf16 v[124:127], v[60:63], a[76:79], v[124:127]
    buffer_load_dwordx4 v9, s[20:23], s1 offen offset:1024 lds
    s_waitcnt lgkmcnt(4)
    v_mfma_f32_16x16x32_bf16 v[96:99], v[32:35], a[80:83], v[96:99]
    ds_read_b64_tr_b16 v[48:49], v16 offset:45056
    ds_read_b64_tr_b16 v[50:51], v16 offset:45568
    v_mfma_f32_16x16x32_bf16 v[100:103], v[32:35], a[84:87], v[100:103]
    v_mfma_f32_16x16x32_bf16 v[88:91], v[32:35], v[20:23], v[88:91]
    v_mfma_f32_16x16x32_bf16 v[104:107], v[36:39], a[80:83], v[104:107]
    ds_read_b64_tr_b16 v[52:53], v17 offset:45056
    ds_read_b64_tr_b16 v[54:55], v17 offset:45568
    v_mfma_f32_16x16x32_bf16 v[108:111], v[36:39], a[84:87], v[108:111]
    s_waitcnt lgkmcnt(4)
    v_mfma_f32_16x16x32_bf16 v[112:115], v[40:43], a[80:83], v[112:115]
    ds_read_b64_tr_b16 v[56:57], v190 offset:45056
    ds_read_b64_tr_b16 v[58:59], v190 offset:45568
    v_mfma_f32_16x16x32_bf16 v[116:119], v[40:43], a[84:87], v[116:119]
    v_mfma_f32_16x16x32_bf16 v[120:123], v[44:47], a[80:83], v[120:123]
    ds_read_b64_tr_b16 v[60:61], v191 offset:45056
    ds_read_b64_tr_b16 v[62:63], v191 offset:45568
    v_mfma_f32_16x16x32_bf16 v[124:127], v[44:47], a[84:87], v[124:127]
    s_waitcnt lgkmcnt(4)
    v_mfma_f32_16x16x32_bf16 v[96:99], v[48:51], a[88:91], v[96:99]
    s_waitcnt vmcnt(9)
    s_barrier
    ds_read_b64_tr_b16 v[32:33], v16 offset:0
    ds_read_b64_tr_b16 v[34:35], v16 offset:512
    v_mfma_f32_16x16x32_bf16 v[100:103], v[48:51], a[92:95], v[100:103]
    s_add_u32 m0, s55, 32768
    s_add_u32 s1, s53, 394240
    v_mfma_f32_16x16x32_bf16 v[88:91], v[48:51], v[20:23], v[88:91]
    v_mfma_f32_16x16x32_bf16 v[104:107], v[52:55], a[88:91], v[104:107]
    ds_read_b64_tr_b16 v[36:37], v17 offset:0
    ds_read_b64_tr_b16 v[38:39], v17 offset:512
    v_mfma_f32_16x16x32_bf16 v[108:111], v[52:55], a[92:95], v[108:111]
    buffer_load_dwordx4 v8, s[20:23], s1 offen offset:0 lds
    s_waitcnt lgkmcnt(4)
    v_mfma_f32_16x16x32_bf16 v[112:115], v[56:59], a[88:91], v[112:115]
    ds_read_b64_tr_b16 v[40:41], v190 offset:0
    ds_read_b64_tr_b16 v[42:43], v190 offset:512
    v_mfma_f32_16x16x32_bf16 v[116:119], v[56:59], a[92:95], v[116:119]
    v_mfma_f32_16x16x32_bf16 v[120:123], v[60:63], a[88:91], v[120:123]
    ds_read_b64_tr_b16 v[44:45], v191 offset:0
    ds_read_b64_tr_b16 v[46:47], v191 offset:512
    v_mfma_f32_16x16x32_bf16 v[124:127], v[60:63], a[92:95], v[124:127]
    buffer_load_dwordx4 v9, s[20:23], s1 offen offset:1024 lds
    s_waitcnt lgkmcnt(4)
    v_mfma_f32_16x16x32_bf16 v[96:99], v[32:35], a[96:99], v[96:99]
    ds_read_b64_tr_b16 v[48:49], v16 offset:4096
    ds_read_b64_tr_b16 v[50:51], v16 offset:4608
    v_mfma_f32_16x16x32_bf16 v[100:103], v[32:35], a[100:103], v[100:103]
    s_lshl_b32 s0, s8, 7
    s_add_u32 s52, s73, 131072
    s_add_u32 m0, s54, 0
    s_add_u32 s81, s73, s0
    v_mfma_f32_16x16x32_bf16 v[88:91], v[32:35], v[20:23], v[88:91]
    v_mfma_f32_16x16x32_bf16 v[104:107], v[36:39], a[96:99], v[104:107]
    ds_read_b64_tr_b16 v[52:53], v17 offset:4096
    ds_read_b64_tr_b16 v[54:55], v17 offset:4608
    v_mfma_f32_16x16x32_bf16 v[108:111], v[36:39], a[100:103], v[108:111]
    buffer_load_dwordx4 v76, s[24:27], s81 offen offset:0 lds
    s_waitcnt lgkmcnt(4)
    v_mfma_f32_16x16x32_bf16 v[112:115], v[40:43], a[96:99], v[112:115]
    ds_read_b64_tr_b16 v[56:57], v190 offset:4096
    ds_read_b64_tr_b16 v[58:59], v190 offset:4608
    v_mfma_f32_16x16x32_bf16 v[116:119], v[40:43], a[100:103], v[116:119]
    v_mfma_f32_16x16x32_bf16 v[120:123], v[44:47], a[96:99], v[120:123]
    ds_read_b64_tr_b16 v[60:61], v191 offset:4096
    ds_read_b64_tr_b16 v[62:63], v191 offset:4608
    v_mfma_f32_16x16x32_bf16 v[124:127], v[44:47], a[100:103], v[124:127]
    buffer_load_dwordx4 v77, s[24:27], s81 offen offset:1024 lds
    s_waitcnt lgkmcnt(4)
    v_mfma_f32_16x16x32_bf16 v[96:99], v[48:51], a[104:107], v[96:99]
    s_waitcnt vmcnt(11)
    s_barrier
    ds_read_b64_tr_b16 v[32:33], v16 offset:8192
    ds_read_b64_tr_b16 v[34:35], v16 offset:8704
    v_mfma_f32_16x16x32_bf16 v[100:103], v[48:51], a[108:111], v[100:103]
    buffer_load_dwordx4 v78, s[24:27], s81 offen offset:2048 lds
    v_mfma_f32_16x16x32_bf16 v[88:91], v[48:51], v[20:23], v[88:91]
    v_mfma_f32_16x16x32_bf16 v[104:107], v[52:55], a[104:107], v[104:107]
    ds_read_b64_tr_b16 v[36:37], v17 offset:8192
    ds_read_b64_tr_b16 v[38:39], v17 offset:8704
    v_mfma_f32_16x16x32_bf16 v[108:111], v[52:55], a[108:111], v[108:111]
    s_waitcnt lgkmcnt(4)
    v_mfma_f32_16x16x32_bf16 v[112:115], v[56:59], a[104:107], v[112:115]
    ds_read_b64_tr_b16 v[40:41], v190 offset:8192
    ds_read_b64_tr_b16 v[42:43], v190 offset:8704
    v_mfma_f32_16x16x32_bf16 v[116:119], v[56:59], a[108:111], v[116:119]
    buffer_load_dwordx4 v79, s[24:27], s81 offen offset:3072 lds
    v_mfma_f32_16x16x32_bf16 v[120:123], v[60:63], a[104:107], v[120:123]
    ds_read_b64_tr_b16 v[44:45], v191 offset:8192
    ds_read_b64_tr_b16 v[46:47], v191 offset:8704
    v_mfma_f32_16x16x32_bf16 v[124:127], v[60:63], a[108:111], v[124:127]
    s_add_u32 m0, s55, 40960
    s_add_u32 s1, s53, 590848
    s_waitcnt lgkmcnt(4)
    v_mfma_f32_16x16x32_bf16 v[96:99], v[32:35], a[112:115], v[96:99]
    ds_read_b64_tr_b16 v[48:49], v16 offset:12288
    ds_read_b64_tr_b16 v[50:51], v16 offset:12800
    v_mfma_f32_16x16x32_bf16 v[100:103], v[32:35], a[116:119], v[100:103]
    buffer_load_dwordx4 v8, s[20:23], s1 offen offset:0 lds
    v_mfma_f32_16x16x32_bf16 v[88:91], v[32:35], v[20:23], v[88:91]
    v_mfma_f32_16x16x32_bf16 v[104:107], v[36:39], a[112:115], v[104:107]
    ds_read_b64_tr_b16 v[52:53], v17 offset:12288
    ds_read_b64_tr_b16 v[54:55], v17 offset:12800
    v_mfma_f32_16x16x32_bf16 v[108:111], v[36:39], a[116:119], v[108:111]
    buffer_load_dwordx4 v9, s[20:23], s1 offen offset:1024 lds
    s_add_u32 m0, s54, 4096
    s_add_u32 s81, s52, s0
    s_waitcnt lgkmcnt(4)
    v_mfma_f32_16x16x32_bf16 v[112:115], v[40:43], a[112:115], v[112:115]
    ds_read_b64_tr_b16 v[56:57], v190 offset:12288
    ds_read_b64_tr_b16 v[58:59], v190 offset:12800
    v_mfma_f32_16x16x32_bf16 v[116:119], v[40:43], a[116:119], v[116:119]
    v_mfma_f32_16x16x32_bf16 v[120:123], v[44:47], a[112:115], v[120:123]
    ds_read_b64_tr_b16 v[60:61], v191 offset:12288
    ds_read_b64_tr_b16 v[62:63], v191 offset:12800
    v_mfma_f32_16x16x32_bf16 v[124:127], v[44:47], a[116:119], v[124:127]
    buffer_load_dwordx4 v76, s[24:27], s81 offen offset:0 lds
    s_waitcnt lgkmcnt(4)
    v_mfma_f32_16x16x32_bf16 v[96:99], v[48:51], a[120:123], v[96:99]
    v_mfma_f32_16x16x32_bf16 v[100:103], v[48:51], a[124:127], v[100:103]
    v_mfma_f32_16x16x32_bf16 v[88:91], v[48:51], v[20:23], v[88:91]
    v_mfma_f32_16x16x32_bf16 v[104:107], v[52:55], a[120:123], v[104:107]
    v_mfma_f32_16x16x32_bf16 v[108:111], v[52:55], a[124:127], v[108:111]
    buffer_load_dwordx4 v77, s[24:27], s81 offen offset:1024 lds
    s_waitcnt lgkmcnt(0)
    v_mfma_f32_16x16x32_bf16 v[112:115], v[56:59], a[120:123], v[112:115]
    v_mfma_f32_16x16x32_bf16 v[116:119], v[56:59], a[124:127], v[116:119]
    v_mfma_f32_16x16x32_bf16 v[120:123], v[60:63], a[120:123], v[120:123]
    v_mfma_f32_16x16x32_bf16 v[124:127], v[60:63], a[124:127], v[124:127]
    buffer_load_dwordx4 v78, s[24:27], s81 offen offset:2048 lds
    v_and_b32 v10, 48, v1
    v_add_u32 v10, 151808, v10
    s_lshl_b32 s58, s4, 6
    v_add_u32 v3, s58, v10
    s_mov_b32 exec_lo, 0x00010001
    s_mov_b32 exec_hi, 0x00010001
    ds_write_b128 v3, v[88:91] offset:0
    s_mov_b64 exec, -1
    s_waitcnt lgkmcnt(0)
    s_cmp_lg_u32 s4, 0
    s_cbranch_scc1 .ones_a_2
    v_add_u32 v2, 114688, v28
    ds_write_b128 v2, v[20:23]
    s_waitcnt lgkmcnt(0)
.ones_a_2:
    s_barrier
    v_and_b32 v29, 31, v1
    v_lshlrev_b32 v29, 3, v29
    s_lshl_b32 s58, s5, 8
    s_add_u32 s58, s58, 4096
    v_add_u32 v29, s58, v29
    buffer_load_dwordx2 v[30:31], v29, s[28:31], 0 offen sc1
    s_lshl_b32 s58, s4, 6
    v_xor_b32 v56, s58, v10
    v_xor_b32 v57, 64, v56
    v_xor_b32 v58, 128, v56
    v_xor_b32 v59, 192, v56
    ds_read_b128 v[32:35], v56 offset:0
    ds_read_b128 v[36:39], v57 offset:0
    ds_read_b128 v[40:43], v58 offset:0
    ds_read_b128 v[44:47], v59 offset:0
    s_waitcnt lgkmcnt(3)
    v_pk_fma_f32 v[96:97], v[32:33], v[24:25], v[96:97] op_sel_hi:[1,0,1]
    v_pk_fma_f32 v[98:99], v[34:35], v[24:25], v[98:99] op_sel_hi:[1,0,1]
    v_pk_fma_f32 v[100:101], v[32:33], v[26:27], v[100:101] op_sel_hi:[1,0,1]
    v_pk_fma_f32 v[102:103], v[34:35], v[26:27], v[102:103] op_sel_hi:[1,0,1]
    s_waitcnt lgkmcnt(2)
    v_pk_fma_f32 v[104:105], v[36:37], v[24:25], v[104:105] op_sel_hi:[1,0,1]
    v_pk_fma_f32 v[106:107], v[38:39], v[24:25], v[106:107] op_sel_hi:[1,0,1]
    v_pk_fma_f32 v[108:109], v[36:37], v[26:27], v[108:109] op_sel_hi:[1,0,1]
    v_pk_fma_f32 v[110:111], v[38:39], v[26:27], v[110:111] op_sel_hi:[1,0,1]
    buffer_load_dwordx4 v79, s[24:27], s81 offen offset:3072 lds
    s_waitcnt lgkmcnt(1)
    v_pk_fma_f32 v[112:113], v[40:41], v[24:25], v[112:113] op_sel_hi:[1,0,1]
    v_pk_fma_f32 v[114:115], v[42:43], v[24:25], v[114:115] op_sel_hi:[1,0,1]
    v_pk_fma_f32 v[116:117], v[40:41], v[26:27], v[116:117] op_sel_hi:[1,0,1]
    v_pk_fma_f32 v[118:119], v[42:43], v[26:27], v[118:119] op_sel_hi:[1,0,1]
    s_waitcnt lgkmcnt(0)
    v_pk_fma_f32 v[120:121], v[44:45], v[24:25], v[120:121] op_sel_hi:[1,0,1]
    v_pk_fma_f32 v[122:123], v[46:47], v[24:25], v[122:123] op_sel_hi:[1,0,1]
    v_pk_fma_f32 v[124:125], v[44:45], v[26:27], v[124:125] op_sel_hi:[1,0,1]
    v_pk_fma_f32 v[126:127], v[46:47], v[26:27], v[126:127] op_sel_hi:[1,0,1]
    s_add_u32 m0, s55, 0
    s_add_u32 s1, s53, 787456
    s_mov_b32 s64, 0xffff0000
    s_mov_b32 s65, 0xffff0000
    v_cndmask_b32 v2, v25, v27, s[64:65]
    v_mul_f32 v185, v185, v2
    v_rcp_f32 v184, v2
    s_nop 0
    v_mul_f32 v184, 3480120104, v184
    v_cvt_pk_bf16_f32 v160, v96, v97
    v_cvt_pk_bf16_f32 v161, v98, v99
    v_cvt_pk_bf16_f32 v162, v100, v101
    v_cvt_pk_bf16_f32 v163, v102, v103
    v_cvt_pk_bf16_f32 v164, v104, v105
    v_cvt_pk_bf16_f32 v165, v106, v107
    v_cvt_pk_bf16_f32 v166, v108, v109
    v_cvt_pk_bf16_f32 v167, v110, v111
    v_cvt_pk_bf16_f32 v168, v112, v113
    v_cvt_pk_bf16_f32 v169, v114, v115
    v_cvt_pk_bf16_f32 v170, v116, v117
    v_cvt_pk_bf16_f32 v171, v118, v119
    v_cvt_pk_bf16_f32 v172, v120, v121
    v_cvt_pk_bf16_f32 v173, v122, v123
    v_cvt_pk_bf16_f32 v174, v124, v125
    v_cvt_pk_bf16_f32 v175, v126, v127
    buffer_load_dwordx4 v8, s[20:23], s1 offen offset:0 lds
    v_permlane16_swap_b32 v160, v162
    v_permlane16_swap_b32 v161, v163
    v_permlane16_swap_b32 v164, v166
    v_permlane16_swap_b32 v165, v167
    v_permlane16_swap_b32 v168, v170
    v_permlane16_swap_b32 v169, v171
    v_permlane16_swap_b32 v172, v174
    v_permlane16_swap_b32 v173, v175
    v_permlane32_swap_b32 v160, v164
    v_permlane32_swap_b32 v161, v165
    v_permlane32_swap_b32 v162, v166
    v_permlane32_swap_b32 v163, v167
    v_permlane32_swap_b32 v168, v172
    v_permlane32_swap_b32 v169, v173
    v_permlane32_swap_b32 v170, v174
    v_permlane32_swap_b32 v171, v175
    buffer_load_dwordx4 v9, s[20:23], s1 offen offset:1024 lds
    s_add_u32 m0, s54, 8192
    s_add_u32 s0, s0, 128
    s_and_b32 s0, s0, 1023
    s_add_u32 s81, s73, s0
    v_xor_b32 v148, 0, v19
    v_xor_b32 v149, 64, v19
    v_xor_b32 v150, 128, v19
    v_xor_b32 v151, 192, v19
    s_waitcnt vmcnt(17)
    s_barrier
    ds_read_b64_tr_b16 v[32:33], v16 offset:16384
    ds_read_b64_tr_b16 v[34:35], v16 offset:16896
    ds_read_b64_tr_b16 v[36:37], v17 offset:16384
    ds_read_b64_tr_b16 v[38:39], v17 offset:16896
    ds_read_b64_tr_b16 v[40:41], v190 offset:16384
    ds_read_b64_tr_b16 v[42:43], v190 offset:16896
    ds_read_b64_tr_b16 v[44:45], v191 offset:16384
    ds_read_b64_tr_b16 v[46:47], v191 offset:16896
    ds_read_b128 v[72:75], v148 offset:0
    s_waitcnt lgkmcnt(5)
    v_mfma_f32_16x16x32_bf16 v[96:99], v[32:35], a[0:3], 0
    ds_read_b64_tr_b16 v[48:49], v16 offset:20480
    ds_read_b64_tr_b16 v[50:51], v16 offset:20992
    v_mfma_f32_16x16x32_bf16 v[100:103], v[32:35], a[4:7], 0
    buffer_load_dwordx4 v76, s[24:27], s81 offen offset:0 lds
    s_waitcnt lgkmcnt(2)
    v_mfma_f32_16x16x32_bf16 v[88:91], v[32:35], v[72:75], 0
    v_mfma_f32_16x16x32_bf16 v[80:83], v[72:75], v[72:75], 0
    v_mfma_f32_16x16x32_bf16 v[104:107], v[36:39], a[0:3], 0
    ds_read_b64_tr_b16 v[52:53], v17 offset:20480
    ds_read_b64_tr_b16 v[54:55], v17 offset:20992
    v_mfma_f32_16x16x32_bf16 v[108:111], v[36:39], a[4:7], 0
    buffer_load_dwordx4 v77, s[24:27], s81 offen offset:1024 lds
    v_mfma_f32_16x16x32_bf16 v[112:115], v[40:43], a[0:3], 0
    ds_read_b64_tr_b16 v[56:57], v190 offset:20480
    ds_read_b64_tr_b16 v[58:59], v190 offset:20992
    v_mfma_f32_16x16x32_bf16 v[116:119], v[40:43], a[4:7], 0
    ds_read_b128 v[144:147], v149 offset:0
    v_mfma_f32_16x16x32_bf16 v[120:123], v[44:47], a[0:3], 0
    ds_read_b64_tr_b16 v[60:61], v191 offset:20480
    ds_read_b64_tr_b16 v[62:63], v191 offset:20992
    v_mfma_f32_16x16x32_bf16 v[124:127], v[44:47], a[4:7], 0
    buffer_load_dwordx4 v78, s[24:27], s81 offen offset:2048 lds
    s_waitcnt lgkmcnt(5)
    v_mfma_f32_16x16x32_bf16 v[96:99], v[48:51], a[8:11], v[96:99]
    s_waitcnt vmcnt(18)
    s_barrier
    ds_read_b64_tr_b16 v[32:33], v16 offset:24576
    ds_read_b64_tr_b16 v[34:35], v16 offset:25088
    v_mfma_f32_16x16x32_bf16 v[100:103], v[48:51], a[12:15], v[100:103]
    buffer_load_dwordx4 v79, s[24:27], s81 offen offset:3072 lds
    s_waitcnt lgkmcnt(4)
    v_mfma_f32_16x16x32_bf16 v[88:91], v[48:51], v[144:147], v[88:91]
    v_mfma_f32_16x16x32_bf16 v[80:83], v[144:147], v[144:147], v[80:83]
    v_mfma_f32_16x16x32_bf16 v[104:107], v[52:55], a[8:11], v[104:107]
    ds_read_b64_tr_b16 v[36:37], v17 offset:24576
    ds_read_b64_tr_b16 v[38:39], v17 offset:25088
    v_mfma_f32_16x16x32_bf16 v[108:111], v[52:55], a[12:15], v[108:111]
    s_add_u32 m0, s55, 8192
    s_add_u32 s1, s53, 984064
    s_waitcnt lgkmcnt(4)
    v_mfma_f32_16x16x32_bf16 v[112:115], v[56:59], a[8:11], v[112:115]
    ds_read_b64_tr_b16 v[40:41], v190 offset:24576
    ds_read_b64_tr_b16 v[42:43], v190 offset:25088
    v_mfma_f32_16x16x32_bf16 v[116:119], v[56:59], a[12:15], v[116:119]
    ds_read_b128 v[72:75], v150 offset:0
    buffer_load_dwordx4 v8, s[20:23], s1 offen offset:0 lds
    v_mfma_f32_16x16x32_bf16 v[120:123], v[60:63], a[8:11], v[120:123]
    ds_read_b64_tr_b16 v[44:45], v191 offset:24576
    ds_read_b64_tr_b16 v[46:47], v191 offset:25088
    v_mfma_f32_16x16x32_bf16 v[124:127], v[60:63], a[12:15], v[124:127]
    s_waitcnt lgkmcnt(5)
    v_mfma_f32_16x16x32_bf16 v[96:99], v[32:35], a[16:19], v[96:99]
    ds_read_b64_tr_b16 v[48:49], v16 offset:28672
    ds_read_b64_tr_b16 v[50:51], v16 offset:29184
    v_mfma_f32_16x16x32_bf16 v[100:103], v[32:35], a[20:23], v[100:103]
    buffer_load_dwordx4 v9, s[20:23], s1 offen offset:1024 lds
    s_add_u32 m0, s54, 12288
    s_add_u32 s81, s52, s0
    s_waitcnt lgkmcnt(4)
    v_mfma_f32_16x16x32_bf16 v[88:91], v[32:35], v[72:75], v[88:91]
    v_mfma_f32_16x16x32_bf16 v[80:83], v[72:75], v[72:75], v[80:83]
    v_mfma_f32_16x16x32_bf16 v[104:107], v[36:39], a[16:19], v[104:107]
    ds_read_b64_tr_b16 v[52:53], v17 offset:28672
    ds_read_b64_tr_b16 v[54:55], v17 offset:29184
    v_mfma_f32_16x16x32_bf16 v[108:111], v[36:39], a[20:23], v[108:111]
    s_waitcnt vmcnt(15)
    ds_read_b128 a[128:131], v12 offset:0
    ds_read_b128 a[132:135], v13 offset:0
    buffer_load_dwordx4 v76, s[24:27], s81 offen offset:0 lds
    s_waitcnt lgkmcnt(6)
    v_mfma_f32_16x16x32_bf16 v[112:115], v[40:43], a[16:19], v[112:115]
    ds_read_b64_tr_b16 v[56:57], v190 offset:28672
    ds_read_b64_tr_b16 v[58:59], v190 offset:29184
    v_mfma_f32_16x16x32_bf16 v[116:119], v[40:43], a[20:23], v[116:119]
    ds_read_b128 v[144:147], v151 offset:0
    ds_read_b128 a[136:139], v14 offset:0
    ds_read_b128 a[140:143], v15 offset:0
    v_mfma_f32_16x16x32_bf16 v[120:123], v[44:47], a[16:19], v[120:123]
    ds_read_b64_tr_b16 v[60:61], v191 offset:28672
    ds_read_b64_tr_b16 v[62:63], v191 offset:29184
    v_mfma_f32_16x16x32_bf16 v[124:127], v[44:47], a[20:23], v[124:127]
    buffer_load_dwordx4 v77, s[24:27], s81 offen offset:1024 lds
    s_waitcnt lgkmcnt(9)
    v_mfma_f32_16x16x32_bf16 v[96:99], v[48:51], a[24:27], v[96:99]
    s_barrier
    ds_read_b64_tr_b16 v[32:33], v16 offset:32768
    ds_read_b64_tr_b16 v[34:35], v16 offset:33280
    v_mfma_f32_16x16x32_bf16 v[100:103], v[48:51], a[28:31], v[100:103]
    buffer_load_dwordx4 v78, s[24:27], s81 offen offset:2048 lds
    s_waitcnt lgkmcnt(6)
    v_mfma_f32_16x16x32_bf16 v[88:91], v[48:51], v[144:147], v[88:91]
    v_mfma_f32_16x16x32_bf16 v[80:83], v[144:147], v[144:147], v[80:83]
    v_mfma_f32_16x16x32_bf16 v[104:107], v[52:55], a[24:27], v[104:107]
    ds_read_b64_tr_b16 v[36:37], v17 offset:32768
    ds_read_b64_tr_b16 v[38:39], v17 offset:33280
    v_mfma_f32_16x16x32_bf16 v[108:111], v[52:55], a[28:31], v[108:111]
    s_waitcnt lgkmcnt(6)
    buffer_load_dwordx4 v79, s[24:27], s81 offen offset:3072 lds
    s_waitcnt lgkmcnt(4)
    v_mfma_f32_16x16x32_bf16 v[112:115], v[56:59], a[24:27], v[112:115]
    ds_read_b64_tr_b16 v[40:41], v190 offset:32768
    ds_read_b64_tr_b16 v[42:43], v190 offset:33280
    v_mfma_f32_16x16x32_bf16 v[116:119], v[56:59], a[28:31], v[116:119]
    ds_read_b128 v[72:75], v148 offset:256
    s_add_u32 m0, s55, 16384
    s_add_u32 s1, s53, 1180672
    v_mfma_f32_16x16x32_bf16 v[120:123], v[60:63], a[24:27], v[120:123]
    ds_read_b64_tr_b16 v[44:45], v191 offset:32768
    ds_read_b64_tr_b16 v[46:47], v191 offset:33280
    v_mfma_f32_16x16x32_bf16 v[124:127], v[60:63], a[28:31], v[124:127]
    buffer_load_dwordx4 v8, s[20:23], s1 offen offset:0 lds
    s_waitcnt lgkmcnt(5)
    v_mfma_f32_16x16x32_bf16 v[96:99], v[32:35], a[32:35], v[96:99]
    ds_read_b64_tr_b16 v[48:49], v16 offset:36864
    ds_read_b64_tr_b16 v[50:51], v16 offset:37376
    v_mfma_f32_16x16x32_bf16 v[100:103], v[32:35], a[36:39], v[100:103]
    s_waitcnt lgkmcnt(4)
    v_mfma_f32_16x16x32_bf16 v[88:91], v[32:35], v[72:75], v[88:91]
    v_mfma_f32_16x16x32_bf16 v[80:83], v[72:75], v[72:75], v[80:83]
    v_mfma_f32_16x16x32_bf16 v[104:107], v[36:39], a[32:35], v[104:107]
    ds_read_b64_tr_b16 v[52:53], v17 offset:36864
    ds_read_b64_tr_b16 v[54:55], v17 offset:37376
    v_mfma_f32_16x16x32_bf16 v[108:111], v[36:39], a[36:39], v[108:111]
    buffer_load_dwordx4 v9, s[20:23], s1 offen offset:1024 lds
    s_add_u32 m0, s54, 0
    s_add_u32 s0, s0, 128
    s_and_b32 s0, s0, 1023
    s_add_u32 s81, s73, s0
    s_waitcnt lgkmcnt(4)
    v_mfma_f32_16x16x32_bf16 v[112:115], v[40:43], a[32:35], v[112:115]
    ds_read_b64_tr_b16 v[56:57], v190 offset:36864
    ds_read_b64_tr_b16 v[58:59], v190 offset:37376
    v_mfma_f32_16x16x32_bf16 v[116:119], v[40:43], a[36:39], v[116:119]
    ds_read_b128 v[144:147], v149 offset:256
    buffer_load_dwordx4 v76, s[24:27], s81 offen offset:0 lds
    v_mfma_f32_16x16x32_bf16 v[120:123], v[44:47], a[32:35], v[120:123]
    ds_read_b64_tr_b16 v[60:61], v191 offset:36864
    ds_read_b64_tr_b16 v[62:63], v191 offset:37376
    v_mfma_f32_16x16x32_bf16 v[124:127], v[44:47], a[36:39], v[124:127]
    s_waitcnt lgkmcnt(5)
    v_mfma_f32_16x16x32_bf16 v[96:99], v[48:51], a[40:43], v[96:99]
    s_waitcnt vmcnt(20)
    s_barrier
    ds_read_b64_tr_b16 v[32:33], v16 offset:40960
    ds_read_b64_tr_b16 v[34:35], v16 offset:41472
    v_mfma_f32_16x16x32_bf16 v[100:103], v[48:51], a[44:47], v[100:103]
    buffer_load_dwordx4 v77, s[24:27], s81 offen offset:1024 lds
    s_waitcnt lgkmcnt(4)
    v_mfma_f32_16x16x32_bf16 v[88:91], v[48:51], v[144:147], v[88:91]
    v_mfma_f32_16x16x32_bf16 v[80:83], v[144:147], v[144:147], v[80:83]
    v_mfma_f32_16x16x32_bf16 v[104:107], v[52:55], a[40:43], v[104:107]
    ds_read_b64_tr_b16 v[36:37], v17 offset:40960
    ds_read_b64_tr_b16 v[38:39], v17 offset:41472
    v_mfma_f32_16x16x32_bf16 v[108:111], v[52:55], a[44:47], v[108:111]
    buffer_load_dwordx4 v78, s[24:27], s81 offen offset:2048 lds
    s_waitcnt lgkmcnt(4)
    v_mfma_f32_16x16x32_bf16 v[112:115], v[56:59], a[40:43], v[112:115]
    ds_read_b64_tr_b16 v[40:41], v190 offset:40960
    ds_read_b64_tr_b16 v[42:43], v190 offset:41472
    v_mfma_f32_16x16x32_bf16 v[116:119], v[56:59], a[44:47], v[116:119]
    ds_read_b128 v[72:75], v150 offset:256
    v_mfma_f32_16x16x32_bf16 v[120:123], v[60:63], a[40:43], v[120:123]
    ds_read_b64_tr_b16 v[44:45], v191 offset:40960
    ds_read_b64_tr_b16 v[46:47], v191 offset:41472
    v_mfma_f32_16x16x32_bf16 v[124:127], v[60:63], a[44:47], v[124:127]
    buffer_load_dwordx4 v79, s[24:27], s81 offen offset:3072 lds
    s_waitcnt lgkmcnt(5)
    v_mfma_f32_16x16x32_bf16 v[96:99], v[32:35], a[48:51], v[96:99]
    ds_read_b64_tr_b16 v[48:49], v16 offset:45056
    ds_read_b64_tr_b16 v[50:51], v16 offset:45568
    v_mfma_f32_16x16x32_bf16 v[100:103], v[32:35], a[52:55], v[100:103]
    s_add_u32 m0, s55, 24576
    s_add_u32 s1, s53, 1377280
    s_waitcnt vmcnt(18)
    ds_read_b128 a[160:163], v12 offset:4096
    ds_read_b128 a[164:167], v13 offset:4096
    s_waitcnt lgkmcnt(6)
    v_mfma_f32_16x16x32_bf16 v[88:91], v[32:35], v[72:75], v[88:91]
    v_mfma_f32_16x16x32_bf16 v[80:83], v[72:75], v[72:75], v[80:83]
    v_mfma_f32_16x16x32_bf16 v[104:107], v[36:39], a[48:51], v[104:107]
    ds_read_b64_tr_b16 v[52:53], v17 offset:45056
    ds_read_b64_tr_b16 v[54:55], v17 offset:45568
    v_mfma_f32_16x16x32_bf16 v[108:111], v[36:39], a[52:55], v[108:111]
    buffer_load_dwordx4 v8, s[20:23], s1 offen offset:0 lds
    ds_read_b128 a[168:171], v14 offset:4096
    ds_read_b128 a[172:175], v15 offset:4096
    s_waitcnt lgkmcnt(8)
    v_mfma_f32_16x16x32_bf16 v[112:115], v[40:43], a[48:51], v[112:115]
    ds_read_b64_tr_b16 v[56:57], v190 offset:45056
    ds_read_b64_tr_b16 v[58:59], v190 offset:45568
    v_mfma_f32_16x16x32_bf16 v[116:119], v[40:43], a[52:55], v[116:119]
    ds_read_b128 v[144:147], v151 offset:256
    buffer_load_dwordx4 v9, s[20:23], s1 offen offset:1024 lds
    v_mfma_f32_16x16x32_bf16 v[120:123], v[44:47], a[48:51], v[120:123]
    ds_read_b64_tr_b16 v[60:61], v191 offset:45056
    ds_read_b64_tr_b16 v[62:63], v191 offset:45568
    v_mfma_f32_16x16x32_bf16 v[124:127], v[44:47], a[52:55], v[124:127]
    s_waitcnt lgkmcnt(7)
    v_mfma_f32_16x16x32_bf16 v[96:99], v[48:51], a[56:59], v[96:99]
    s_waitcnt vmcnt(18)
    s_barrier
    ds_read_b64_tr_b16 v[32:33], v16 offset:0
    ds_read_b64_tr_b16 v[34:35], v16 offset:512
    v_mfma_f32_16x16x32_bf16 v[100:103], v[48:51], a[60:63], v[100:103]
    s_add_u32 m0, s55, 32768
    s_add_u32 s1, s53, 2048
    s_waitcnt lgkmcnt(7)
    s_waitcnt lgkmcnt(4)
    v_mfma_f32_16x16x32_bf16 v[88:91], v[48:51], v[144:147], v[88:91]
    v_mfma_f32_16x16x32_bf16 v[80:83], v[144:147], v[144:147], v[80:83]
    v_mfma_f32_16x16x32_bf16 v[104:107], v[52:55], a[56:59], v[104:107]
    ds_read_b64_tr_b16 v[36:37], v17 offset:0
    ds_read_b64_tr_b16 v[38:39], v17 offset:512
    v_mfma_f32_16x16x32_bf16 v[108:111], v[52:55], a[60:63], v[108:111]
    buffer_load_dwordx4 v8, s[20:23], s1 offen offset:0 lds
    s_waitcnt lgkmcnt(4)
    v_mfma_f32_16x16x32_bf16 v[112:115], v[56:59], a[56:59], v[112:115]
    ds_read_b64_tr_b16 v[40:41], v190 offset:0
    ds_read_b64_tr_b16 v[42:43], v190 offset:512
    v_mfma_f32_16x16x32_bf16 v[116:119], v[56:59], a[60:63], v[116:119]
    ds_read_b128 v[72:75], v148 offset:512
    v_mfma_f32_16x16x32_bf16 v[120:123], v[60:63], a[56:59], v[120:123]
    ds_read_b64_tr_b16 v[44:45], v191 offset:0
    ds_read_b64_tr_b16 v[46:47], v191 offset:512
    v_mfma_f32_16x16x32_bf16 v[124:127], v[60:63], a[60:63], v[124:127]
    buffer_load_dwordx4 v9, s[20:23], s1 offen offset:1024 lds
    s_add_u32 m0, s54, 4096
    s_add_u32 s81, s52, s0
    s_waitcnt lgkmcnt(5)
    v_mfma_f32_16x16x32_bf16 v[96:99], v[32:35], a[64:67], v[96:99]
    ds_read_b64_tr_b16 v[48:49], v16 offset:4096
    ds_read_b64_tr_b16 v[50:51], v16 offset:4608
    v_mfma_f32_16x16x32_bf16 v[100:103], v[32:35], a[68:71], v[100:103]
    buffer_load_dwordx4 v76, s[24:27], s81 offen offset:0 lds
    s_waitcnt lgkmcnt(4)
    v_mfma_f32_16x16x32_bf16 v[88:91], v[32:35], v[72:75], v[88:91]
    v_mfma_f32_16x16x32_bf16 v[80:83], v[72:75], v[72:75], v[80:83]
    v_mfma_f32_16x16x32_bf16 v[104:107], v[36:39], a[64:67], v[104:107]
    ds_read_b64_tr_b16 v[52:53], v17 offset:4096
    ds_read_b64_tr_b16 v[54:55], v17 offset:4608
    v_mfma_f32_16x16x32_bf16 v[108:111], v[36:39], a[68:71], v[108:111]
    buffer_load_dwordx4 v77, s[24:27], s81 offen offset:1024 lds
    s_waitcnt lgkmcnt(4)
    v_mfma_f32_16x16x32_bf16 v[112:115], v[40:43], a[64:67], v[112:115]
    ds_read_b64_tr_b16 v[56:57], v190 offset:4096
    ds_read_b64_tr_b16 v[58:59], v190 offset:4608
    v_mfma_f32_16x16x32_bf16 v[116:119], v[40:43], a[68:71], v[116:119]
    ds_read_b128 v[144:147], v149 offset:512
    v_mfma_f32_16x16x32_bf16 v[120:123], v[44:47], a[64:67], v[120:123]
    ds_read_b64_tr_b16 v[60:61], v191 offset:4096
    ds_read_b64_tr_b16 v[62:63], v191 offset:4608
    v_mfma_f32_16x16x32_bf16 v[124:127], v[44:47], a[68:71], v[124:127]
    buffer_load_dwordx4 v78, s[24:27], s81 offen offset:2048 lds
    s_waitcnt lgkmcnt(5)
    v_mfma_f32_16x16x32_bf16 v[96:99], v[48:51], a[72:75], v[96:99]
    s_waitcnt vmcnt(17)
    s_barrier
    ds_read_b64_tr_b16 v[32:33], v16 offset:8192
    ds_read_b64_tr_b16 v[34:35], v16 offset:8704
    v_mfma_f32_16x16x32_bf16 v[100:103], v[48:51], a[76:79], v[100:103]
    ds_read_b128 a[144:147], v12 offset:8192
    ds_read_b128 a[148:151], v13 offset:8192
    buffer_load_dwordx4 v79, s[24:27], s81 offen offset:3072 lds
    s_waitcnt lgkmcnt(6)
    v_mfma_f32_16x16x32_bf16 v[88:91], v[48:51], v[144:147], v[88:91]
    v_mfma_f32_16x16x32_bf16 v[80:83], v[144:147], v[144:147], v[80:83]
    v_mfma_f32_16x16x32_bf16 v[104:107], v[52:55], a[72:75], v[104:107]
    ds_read_b64_tr_b16 v[36:37], v17 offset:8192
    ds_read_b64_tr_b16 v[38:39], v17 offset:8704
    v_mfma_f32_16x16x32_bf16 v[108:111], v[52:55], a[76:79], v[108:111]
    s_add_u32 m0, s55, 40960
    s_add_u32 s1, s53, 198656
    ds_read_b128 a[152:155], v14 offset:8192
    ds_read_b128 a[156:159], v15 offset:8192
    s_waitcnt lgkmcnt(8)
    v_mfma_f32_16x16x32_bf16 v[112:115], v[56:59], a[72:75], v[112:115]
    ds_read_b64_tr_b16 v[40:41], v190 offset:8192
    ds_read_b64_tr_b16 v[42:43], v190 offset:8704
    v_mfma_f32_16x16x32_bf16 v[116:119], v[56:59], a[76:79], v[116:119]
    ds_read_b128 v[72:75], v150 offset:512
    buffer_load_dwordx4 v8, s[20:23], s1 offen offset:0 lds
    v_mfma_f32_16x16x32_bf16 v[120:123], v[60:63], a[72:75], v[120:123]
    ds_read_b64_tr_b16 v[44:45], v191 offset:8192
    ds_read_b64_tr_b16 v[46:47], v191 offset:8704
    v_mfma_f32_16x16x32_bf16 v[124:127], v[60:63], a[76:79], v[124:127]
    s_waitcnt lgkmcnt(7)
    v_mfma_f32_16x16x32_bf16 v[96:99], v[32:35], a[80:83], v[96:99]
    ds_read_b64_tr_b16 v[48:49], v16 offset:12288
    ds_read_b64_tr_b16 v[50:51], v16 offset:12800
    v_mfma_f32_16x16x32_bf16 v[100:103], v[32:35], a[84:87], v[100:103]
    buffer_load_dwordx4 v9, s[20:23], s1 offen offset:1024 lds
    s_waitcnt lgkmcnt(7)
    s_add_u32 m0, s54, 8192
    s_add_u32 s0, s0, 128
    s_and_b32 s0, s0, 1023
    s_add_u32 s81, s73, s0
    s_waitcnt lgkmcnt(4)
    v_mfma_f32_16x16x32_bf16 v[88:91], v[32:35], v[72:75], v[88:91]
    v_mfma_f32_16x16x32_bf16 v[80:83], v[72:75], v[72:75], v[80:83]
    v_mfma_f32_16x16x32_bf16 v[104:107], v[36:39], a[80:83], v[104:107]
    ds_read_b64_tr_b16 v[52:53], v17 offset:12288
    ds_read_b64_tr_b16 v[54:55], v17 offset:12800
    v_mfma_f32_16x16x32_bf16 v[108:111], v[36:39], a[84:87], v[108:111]
    buffer_load_dwordx4 v76, s[24:27], s81 offen offset:0 lds
    s_waitcnt lgkmcnt(4)
    v_mfma_f32_16x16x32_bf16 v[112:115], v[40:43], a[80:83], v[112:115]
    ds_read_b64_tr_b16 v[56:57], v190 offset:12288
    ds_read_b64_tr_b16 v[58:59], v190 offset:12800
    v_mfma_f32_16x16x32_bf16 v[116:119], v[40:43], a[84:87], v[116:119]
    ds_read_b128 v[144:147], v151 offset:512
    v_mfma_f32_16x16x32_bf16 v[120:123], v[44:47], a[80:83], v[120:123]
    ds_read_b64_tr_b16 v[60:61], v191 offset:12288
    ds_read_b64_tr_b16 v[62:63], v191 offset:12800
    v_mfma_f32_16x16x32_bf16 v[124:127], v[44:47], a[84:87], v[124:127]
    buffer_load_dwordx4 v77, s[24:27], s81 offen offset:1024 lds
    s_waitcnt lgkmcnt(5)
    v_mfma_f32_16x16x32_bf16 v[96:99], v[48:51], a[88:91], v[96:99]
    buffer_load_dwordx4 v78, s[24:27], s81 offen offset:2048 lds
    s_waitcnt vmcnt(17)
    s_barrier
    ds_read_b64_tr_b16 v[32:33], v16 offset:16384
    ds_read_b64_tr_b16 v[34:35], v16 offset:16896
    v_mfma_f32_16x16x32_bf16 v[100:103], v[48:51], a[92:95], v[100:103]
    ds_read_b128 a[176:179], v12 offset:12288
    ds_read_b128 a[180:183], v13 offset:12288
    buffer_load_dwordx4 v79, s[24:27], s81 offen offset:3072 lds
    s_waitcnt lgkmcnt(6)
    v_mfma_f32_16x16x32_bf16 v[88:91], v[48:51], v[144:147], v[88:91]
    v_mfma_f32_16x16x32_bf16 v[80:83], v[144:147], v[144:147], v[80:83]
    v_mfma_f32_16x16x32_bf16 v[104:107], v[52:55], a[88:91], v[104:107]
    ds_read_b64_tr_b16 v[36:37], v17 offset:16384
    ds_read_b64_tr_b16 v[38:39], v17 offset:16896
    v_mfma_f32_16x16x32_bf16 v[108:111], v[52:55], a[92:95], v[108:111]
    s_add_u32 m0, s55, 0
    s_add_u32 s1, s53, 395264
    ds_read_b128 a[184:187], v14 offset:12288
    ds_read_b128 a[188:191], v15 offset:12288
    s_waitcnt lgkmcnt(8)
    v_mfma_f32_16x16x32_bf16 v[112:115], v[56:59], a[88:91], v[112:115]
    ds_read_b64_tr_b16 v[40:41], v190 offset:16384
    ds_read_b64_tr_b16 v[42:43], v190 offset:16896
    v_mfma_f32_16x16x32_bf16 v[116:119], v[56:59], a[92:95], v[116:119]
    ds_read_b128 v[72:75], v148 offset:768
    buffer_load_dwordx4 v8, s[20:23], s1 offen offset:0 lds
    s_waitcnt vmcnt(15)
    s_waitcnt lgkmcnt(3)
    ds_read_b128 a[192:195], v12 offset:0
    ds_read_b128 a[196:199], v13 offset:0
    v_mfma_f32_16x16x32_bf16 v[120:123], v[60:63], a[88:91], v[120:123]
    ds_read_b64_tr_b16 v[44:45], v191 offset:16384
    ds_read_b64_tr_b16 v[46:47], v191 offset:16896
    v_mfma_f32_16x16x32_bf16 v[124:127], v[60:63], a[92:95], v[124:127]
    buffer_load_dwordx4 v9, s[20:23], s1 offen offset:1024 lds
    ds_read_b128 a[200:203], v14 offset:0
    ds_read_b128 a[204:207], v15 offset:0
    s_add_u32 m0, s54, 12288
    s_add_u32 s81, s52, s0
    v_mfma_f32_16x16x32_bf16 v[96:99], v[32:35], a[96:99], v[96:99]
    ds_read_b64_tr_b16 v[48:49], v16 offset:20480
    ds_read_b64_tr_b16 v[50:51], v16 offset:20992
    v_mfma_f32_16x16x32_bf16 v[100:103], v[32:35], a[100:103], v[100:103]
    s_waitcnt vmcnt(8)
    s_waitcnt lgkmcnt(2)
    ds_read_b128 a[224:227], v12 offset:4096
    ds_read_b128 a[228:231], v13 offset:4096
    buffer_load_dwordx4 v76, s[24:27], s81 offen offset:0 lds
    v_mfma_f32_16x16x32_bf16 v[88:91], v[32:35], v[72:75], v[88:91]
    v_mfma_f32_16x16x32_bf16 v[80:83], v[72:75], v[72:75], v[80:83]
    v_mfma_f32_16x16x32_bf16 v[104:107], v[36:39], a[96:99], v[104:107]
    ds_read_b64_tr_b16 v[52:53], v17 offset:20480
    ds_read_b64_tr_b16 v[54:55], v17 offset:20992
    v_mfma_f32_16x16x32_bf16 v[108:111], v[36:39], a[100:103], v[108:111]
    ds_read_b128 a[232:235], v14 offset:4096
    ds_read_b128 a[236:239], v15 offset:4096
    buffer_load_dwordx4 v77, s[24:27], s81 offen offset:1024 lds
    v_mfma_f32_16x16x32_bf16 v[112:115], v[40:43], a[96:99], v[112:115]
    ds_read_b64_tr_b16 v[56:57], v190 offset:20480
    ds_read_b64_tr_b16 v[58:59], v190 offset:20992
    v_mfma_f32_16x16x32_bf16 v[116:119], v[40:43], a[100:103], v[116:119]
    ds_read_b128 v[144:147], v149 offset:768
    v_mfma_f32_16x16x32_bf16 v[120:123], v[44:47], a[96:99], v[120:123]
    ds_read_b64_tr_b16 v[60:61], v191 offset:20480
    ds_read_b64_tr_b16 v[62:63], v191 offset:20992
    v_mfma_f32_16x16x32_bf16 v[124:127], v[44:47], a[100:103], v[124:127]
    buffer_load_dwordx4 v78, s[24:27], s81 offen offset:2048 lds
    s_waitcnt lgkmcnt(7)
    v_mfma_f32_16x16x32_bf16 v[96:99], v[48:51], a[104:107], v[96:99]
    s_barrier
    ds_read_b64_tr_b16 v[32:33], v16 offset:24576
    ds_read_b64_tr_b16 v[34:35], v16 offset:25088
    v_mfma_f32_16x16x32_bf16 v[100:103], v[48:51], a[108:111], v[100:103]
    s_waitcnt lgkmcnt(7)
    buffer_load_dwordx4 v79, s[24:27], s81 offen offset:3072 lds
    s_waitcnt lgkmcnt(4)
    v_mfma_f32_16x16x32_bf16 v[88:91], v[48:51], v[144:147], v[88:91]
    v_mfma_f32_16x16x32_bf16 v[80:83], v[144:147], v[144:147], v[80:83]
    v_mfma_f32_16x16x32_bf16 v[104:107], v[52:55], a[104:107], v[104:107]
    ds_read_b64_tr_b16 v[36:37], v17 offset:24576
    ds_read_b64_tr_b16 v[38:39], v17 offset:25088
    v_mfma_f32_16x16x32_bf16 v[108:111], v[52:55], a[108:111], v[108:111]
    s_add_u32 m0, s55, 8192
    s_add_u32 s1, s53, 591872
    s_waitcnt lgkmcnt(4)
    v_mfma_f32_16x16x32_bf16 v[112:115], v[56:59], a[104:107], v[112:115]
    ds_read_b64_tr_b16 v[40:41], v190 offset:24576
    ds_read_b64_tr_b16 v[42:43], v190 offset:25088
    v_mfma_f32_16x16x32_bf16 v[116:119], v[56:59], a[108:111], v[116:119]
    ds_read_b128 v[72:75], v150 offset:768
    buffer_load_dwordx4 v8, s[20:23], s1 offen offset:0 lds
    v_mfma_f32_16x16x32_bf16 v[120:123], v[60:63], a[104:107], v[120:123]
    ds_read_b64_tr_b16 v[44:45], v191 offset:24576
    ds_read_b64_tr_b16 v[46:47], v191 offset:25088
    v_mfma_f32_16x16x32_bf16 v[124:127], v[60:63], a[108:111], v[124:127]
    s_waitcnt vmcnt(7)
    ds_read_b128 a[208:211], v12 offset:8192
    ds_read_b128 a[212:215], v13 offset:8192
    s_waitcnt lgkmcnt(7)
    v_mfma_f32_16x16x32_bf16 v[96:99], v[32:35], a[112:115], v[96:99]
    ds_read_b64_tr_b16 v[48:49], v16 offset:28672
    ds_read_b64_tr_b16 v[50:51], v16 offset:29184
    v_mfma_f32_16x16x32_bf16 v[100:103], v[32:35], a[116:119], v[100:103]
    buffer_load_dwordx4 v9, s[20:23], s1 offen offset:1024 lds
    ds_read_b128 a[216:219], v14 offset:8192
    ds_read_b128 a[220:223], v15 offset:8192
    s_add_u32 m0, s54, 0
    s_add_u32 s0, s0, 128
    s_and_b32 s0, s0, 1023
    s_add_u32 s81, s73, s0
    s_waitcnt lgkmcnt(8)
    v_mfma_f32_16x16x32_bf16 v[88:91], v[32:35], v[72:75], v[88:91]
    v_mfma_f32_16x16x32_bf16 v[80:83], v[72:75], v[72:75], v[80:83]
    v_mfma_f32_16x16x32_bf16 v[104:107], v[36:39], a[112:115], v[104:107]
    ds_read_b64_tr_b16 v[52:53], v17 offset:28672
    ds_read_b64_tr_b16 v[54:55], v17 offset:29184
    v_mfma_f32_16x16x32_bf16 v[108:111], v[36:39], a[116:119], v[108:111]
    buffer_load_dwordx4 v76, s[24:27], s81 offen offset:0 lds
    s_waitcnt lgkmcnt(8)
    v_mfma_f32_16x16x32_bf16 v[112:115], v[40:43], a[112:115], v[112:115]
    ds_read_b64_tr_b16 v[56:57], v190 offset:28672
    ds_read_b64_tr_b16 v[58:59], v190 offset:29184
    v_mfma_f32_16x16x32_bf16 v[116:119], v[40:43], a[116:119], v[116:119]
    ds_read_b128 v[144:147], v151 offset:768
    v_mfma_f32_16x16x32_bf16 v[120:123], v[44:47], a[112:115], v[120:123]
    ds_read_b64_tr_b16 v[60:61], v191 offset:28672
    ds_read_b64_tr_b16 v[62:63], v191 offset:29184
    v_mfma_f32_16x16x32_bf16 v[124:127], v[44:47], a[116:119], v[124:127]
    s_waitcnt lgkmcnt(7)
    buffer_load_dwordx4 v77, s[24:27], s81 offen offset:1024 lds
    s_waitcnt lgkmcnt(5)
    v_mfma_f32_16x16x32_bf16 v[96:99], v[48:51], a[120:123], v[96:99]
    v_mfma_f32_16x16x32_bf16 v[100:103], v[48:51], a[124:127], v[100:103]
    s_waitcnt lgkmcnt(2)
    v_mfma_f32_16x16x32_bf16 v[88:91], v[48:51], v[144:147], v[88:91]
    v_mfma_f32_16x16x32_bf16 v[80:83], v[144:147], v[144:147], v[80:83]
    v_mfma_f32_16x16x32_bf16 v[104:107], v[52:55], a[120:123], v[104:107]
    v_mfma_f32_16x16x32_bf16 v[108:111], v[52:55], a[124:127], v[108:111]
    buffer_load_dwordx4 v78, s[24:27], s81 offen offset:2048 lds
    s_waitcnt lgkmcnt(0)
    v_mfma_f32_16x16x32_bf16 v[112:115], v[56:59], a[120:123], v[112:115]
    v_mfma_f32_16x16x32_bf16 v[116:119], v[56:59], a[124:127], v[116:119]
    v_mfma_f32_16x16x32_bf16 v[120:123], v[60:63], a[120:123], v[120:123]
    v_mfma_f32_16x16x32_bf16 v[124:127], v[60:63], a[124:127], v[124:127]
    buffer_load_dwordx4 v79, s[24:27], s81 offen offset:3072 lds
    v_and_b32 v10, 48, v1
    v_add_u32 v10, 151808, v10
    s_lshl_b32 s58, s4, 6
    v_add_u32 v3, s58, v10
    s_mov_b32 exec_lo, 0x00010001
    s_mov_b32 exec_hi, 0x00010001
    ds_write_b128 v3, v[88:91] offset:512
    s_mov_b64 exec, -1
    s_waitcnt lgkmcnt(0)
    s_barrier
    v_cmp_ne_u32 vcc, s11, v30
    s_cbranch_vccnz .slow_a_3
.back_a_4:
    v_cmp_ne_u32 vcc, s13, v31
    s_nop 0
    s_cmp_eq_u64 vcc, 0
    s_cselect_b32 s12, 1, 0
    s_mov_b32 s64, 0xaaaaaaaa
    s_mov_b32 s65, 0xaaaaaaaa
    s_mov_b32 s66, 0xcccccccc
    s_mov_b32 s67, 0xcccccccc
    s_mov_b32 s68, 0xf0000f
    s_mov_b32 s69, 0xf0000f00
    s_mov_b32 s76, 0xffff
    s_mov_b32 s77, 0x0
    v_cndmask_b32 v187, 0, v80, s[76:77]
    v_cndmask_b32 v80, v80, v81, s[64:65]
    v_cndmask_b32 v82, v82, v83, s[64:65]
    v_cndmask_b32 v80, v80, v82, s[66:67]
    v_cndmask_b32 v80, 0, v80, s[68:69]
    v_mov_b32 v81, v187
    v_mov_b32 v82, v80
    s_nop 0
    v_permlane32_swap_b32 v187, v81
    v_permlane32_swap_b32 v80, v82
    v_add_f32 v187, v187, v81
    v_add_f32 v80, v80, v82
    v_mov_b32 v81, v187
    v_mov_b32 v82, v80
    s_nop 0
    v_permlane16_swap_b32 v187, v81
    v_permlane16_swap_b32 v80, v82
    v_add_f32 v187, v187, v81
    v_add_f32 v80, v80, v82
    s_add_u32 m0, s55, 16384
    s_add_u32 s1, s53, 788480
    s_waitcnt vmcnt(6)
    ds_read_b128 a[240:243], v12 offset:12288
    ds_read_b128 a[244:247], v13 offset:12288
    v_mul_f32 v182, 3137339392, v187
    v_mul_f32 v81, 989855744, v80
    v_fma_f32 v81, -v182, v182, v81
    v_max_f32 v81, 0, v81
    v_add_f32 v81, 925353388, v81
    v_rsq_f32 v183, v81
    s_lshl_b32 s58, s4, 6
    v_xor_b32 v56, s58, v10
    v_xor_b32 v57, 64, v56
    v_xor_b32 v58, 128, v56
    v_xor_b32 v59, 192, v56
    ds_read_b128 v[32:35], v56 offset:512
    ds_read_b128 v[36:39], v57 offset:512
    ds_read_b128 v[40:43], v58 offset:512
    ds_read_b128 v[44:47], v59 offset:512
    s_waitcnt lgkmcnt(3)
    v_pk_fma_f32 v[96:97], v[32:33], v[24:25], v[96:97] op_sel_hi:[1,0,1]
    v_pk_fma_f32 v[98:99], v[34:35], v[24:25], v[98:99] op_sel_hi:[1,0,1]
    v_pk_fma_f32 v[100:101], v[32:33], v[26:27], v[100:101] op_sel_hi:[1,0,1]
    v_pk_fma_f32 v[102:103], v[34:35], v[26:27], v[102:103] op_sel_hi:[1,0,1]
    s_waitcnt lgkmcnt(2)
    v_pk_fma_f32 v[104:105], v[36:37], v[24:25], v[104:105] op_sel_hi:[1,0,1]
    v_pk_fma_f32 v[106:107], v[38:39], v[24:25], v[106:107] op_sel_hi:[1,0,1]
    v_pk_fma_f32 v[108:109], v[36:37], v[26:27], v[108:109] op_sel_hi:[1,0,1]
    v_pk_fma_f32 v[110:111], v[38:39], v[26:27], v[110:111] op_sel_hi:[1,0,1]
    buffer_load_dwordx4 v8, s[20:23], s1 offen offset:0 lds
    ds_read_b128 a[248:251], v14 offset:12288
    ds_read_b128 a[252:255], v15 offset:12288
    s_waitcnt lgkmcnt(3)
    v_pk_fma_f32 v[112:113], v[40:41], v[24:25], v[112:113] op_sel_hi:[1,0,1]
    v_pk_fma_f32 v[114:115], v[42:43], v[24:25], v[114:115] op_sel_hi:[1,0,1]
    v_pk_fma_f32 v[116:117], v[40:41], v[26:27], v[116:117] op_sel_hi:[1,0,1]
    v_pk_fma_f32 v[118:119], v[42:43], v[26:27], v[118:119] op_sel_hi:[1,0,1]
    s_waitcnt lgkmcnt(2)
    v_pk_fma_f32 v[120:121], v[44:45], v[24:25], v[120:121] op_sel_hi:[1,0,1]
    v_pk_fma_f32 v[122:123], v[46:47], v[24:25], v[122:123] op_sel_hi:[1,0,1]
    v_pk_fma_f32 v[124:125], v[44:45], v[26:27], v[124:125] op_sel_hi:[1,0,1]
    v_pk_fma_f32 v[126:127], v[46:47], v[26:27], v[126:127] op_sel_hi:[1,0,1]
    buffer_load_dwordx4 v9, s[20:23], s1 offen offset:1024 lds
    s_add_u32 m0, s54, 4096
    s_add_u32 s81, s52, s0
    v_pk_mul_f32 v[96:97], v[96:97], v[24:25] op_sel:[0,1] op_sel_hi:[1,1]
    v_pk_mul_f32 v[98:99], v[98:99], v[24:25] op_sel:[0,1] op_sel_hi:[1,1]
    v_pk_mul_f32 v[100:101], v[100:101], v[26:27] op_sel:[0,1] op_sel_hi:[1,1]
    v_pk_mul_f32 v[102:103], v[102:103], v[26:27] op_sel:[0,1] op_sel_hi:[1,1]
    v_pk_mul_f32 v[104:105], v[104:105], v[24:25] op_sel:[0,1] op_sel_hi:[1,1]
    v_pk_mul_f32 v[106:107], v[106:107], v[24:25] op_sel:[0,1] op_sel_hi:[1,1]
    v_pk_mul_f32 v[108:109], v[108:109], v[26:27] op_sel:[0,1] op_sel_hi:[1,1]
    v_pk_mul_f32 v[110:111], v[110:111], v[26:27] op_sel:[0,1] op_sel_hi:[1,1]
    v_pk_mul_f32 v[112:113], v[112:113], v[24:25] op_sel:[0,1] op_sel_hi:[1,1]
    v_pk_mul_f32 v[114:115], v[114:115], v[24:25] op_sel:[0,1] op_sel_hi:[1,1]
    v_pk_mul_f32 v[116:117], v[116:117], v[26:27] op_sel:[0,1] op_sel_hi:[1,1]
    v_pk_mul_f32 v[118:119], v[118:119], v[26:27] op_sel:[0,1] op_sel_hi:[1,1]
    v_pk_mul_f32 v[120:121], v[120:121], v[24:25] op_sel:[0,1] op_sel_hi:[1,1]
    v_pk_mul_f32 v[122:123], v[122:123], v[24:25] op_sel:[0,1] op_sel_hi:[1,1]
    v_pk_mul_f32 v[124:125], v[124:125], v[26:27] op_sel:[0,1] op_sel_hi:[1,1]
    v_pk_mul_f32 v[126:127], v[126:127], v[26:27] op_sel:[0,1] op_sel_hi:[1,1]
    s_waitcnt lgkmcnt(0)
    buffer_load_dwordx4 v76, s[24:27], s81 offen offset:0 lds
    v_mov_b32_dpp v92, v88 row_newbcast:0 row_mask:0xf bank_mask:0xf
    v_mov_b32_dpp v93, v89 row_newbcast:0 row_mask:0xf bank_mask:0xf
    v_mov_b32_dpp v94, v90 row_newbcast:0 row_mask:0xf bank_mask:0xf
    v_mov_b32_dpp v95, v91 row_newbcast:0 row_mask:0xf bank_mask:0xf
    v_pk_fma_f32 v[88:89], v[92:93], v[182:183], v[88:89] op_sel_hi:[1,0,1]
    v_pk_fma_f32 v[90:91], v[94:95], v[182:183], v[90:91] op_sel_hi:[1,0,1]
    v_pk_mul_f32 v[88:89], v[88:89], v[182:183] op_sel:[0,1] op_sel_hi:[1,1]
    v_pk_mul_f32 v[90:91], v[90:91], v[182:183] op_sel:[0,1] op_sel_hi:[1,1]
    v_cvt_pk_bf16_f32 v88, v88, v89
    v_cvt_pk_bf16_f32 v89, v90, v91
    ds_write_b64 v180, v[88:89]
    s_waitcnt vmcnt(3)
    ds_read_b128 v[192:195], v12 offset:0
    ds_read_b128 v[196:199], v13 offset:0
    buffer_load_dwordx4 v77, s[24:27], s81 offen offset:1024 lds
    v_cvt_pk_bf16_f32 v96, v96, v97
    v_cvt_pk_bf16_f32 v97, v98, v99
    v_cvt_pk_bf16_f32 v98, v100, v101
    v_cvt_pk_bf16_f32 v99, v102, v103
    v_cvt_pk_bf16_f32 v100, v104, v105
    v_cvt_pk_bf16_f32 v101, v106, v107
    v_cvt_pk_bf16_f32 v102, v108, v109
    v_cvt_pk_bf16_f32 v103, v110, v111
    v_cvt_pk_bf16_f32 v104, v112, v113
    v_cvt_pk_bf16_f32 v105, v114, v115
    v_cvt_pk_bf16_f32 v106, v116, v117
    v_cvt_pk_bf16_f32 v107, v118, v119
    v_cvt_pk_bf16_f32 v108, v120, v121
    v_cvt_pk_bf16_f32 v109, v122, v123
    v_cvt_pk_bf16_f32 v110, v124, v125
    v_cvt_pk_bf16_f32 v111, v126, v127
    ds_read_b128 v[200:203], v14 offset:0
    ds_read_b128 v[204:207], v15 offset:0
    buffer_load_dwordx4 v78, s[24:27], s81 offen offset:2048 lds
    s_xor_b32 s58, s4, 0
    v_lshl_add_u32 v56, s58, 5, v178
    s_xor_b32 s58, s4, 1
    v_lshl_add_u32 v57, s58, 5, v178
    s_xor_b32 s58, s4, 2
    v_lshl_add_u32 v58, s58, 5, v178
    s_xor_b32 s58, s4, 3
    v_lshl_add_u32 v59, s58, 5, v178
    ds_write_b64 v56, v[96:97] offset:0
    ds_write_b64 v56, v[98:99] offset:2304
    ds_write_b64 v57, v[100:101] offset:0
    ds_write_b64 v57, v[102:103] offset:2304
    ds_write_b64 v58, v[104:105] offset:0
    ds_write_b64 v58, v[106:107] offset:2304
    ds_write_b64 v59, v[108:109] offset:0
    ds_write_b64 v59, v[110:111] offset:2304
    s_waitcnt lgkmcnt(8)
    buffer_load_dwordx4 v79, s[24:27], s81 offen offset:3072 lds
    v_xor_b32 v116, 0, v19
    v_xor_b32 v117, 64, v19
    v_xor_b32 v118, 128, v19
    v_xor_b32 v119, 192, v19
    s_barrier
    ds_read_b64_tr_b16 v[32:33], v16 offset:32768
    ds_read_b64_tr_b16 v[34:35], v16 offset:33280
    ds_read_b64_tr_b16 v[36:37], v17 offset:32768
    ds_read_b64_tr_b16 v[38:39], v17 offset:33280
    ds_read_b64_tr_b16 v[40:41], v190 offset:32768
    ds_read_b64_tr_b16 v[42:43], v190 offset:33280
    ds_read_b64_tr_b16 v[44:45], v191 offset:32768
    ds_read_b64_tr_b16 v[46:47], v191 offset:33280
    ds_read_b128 v[72:75], v116 offset:0
    s_waitcnt lgkmcnt(5)
    v_mfma_f32_16x16x32_bf16 v[128:131], v[32:35], a[0:3], 0
    ds_read_b64_tr_b16 v[48:49], v16 offset:36864
    ds_read_b64_tr_b16 v[50:51], v16 offset:37376
    v_mfma_f32_16x16x32_bf16 v[132:135], v[32:35], a[4:7], 0
    s_add_u32 m0, s55, 24576
    s_add_u32 s1, s53, 985088
    s_waitcnt lgkmcnt(2)
    v_mfma_f32_16x16x32_bf16 v[88:91], v[32:35], v[72:75], 0
    v_mfma_f32_16x16x32_bf16 v[136:139], v[36:39], a[0:3], 0
    ds_read_b64_tr_b16 v[52:53], v17 offset:36864
    ds_read_b64_tr_b16 v[54:55], v17 offset:37376
    v_mfma_f32_16x16x32_bf16 v[140:143], v[36:39], a[4:7], 0
    buffer_load_dwordx4 v8, s[20:23], s1 offen offset:0 lds
    v_mfma_f32_16x16x32_bf16 v[144:147], v[40:43], a[0:3], 0
    ds_read_b64_tr_b16 v[56:57], v190 offset:36864
    ds_read_b64_tr_b16 v[58:59], v190 offset:37376
    v_mfma_f32_16x16x32_bf16 v[148:151], v[40:43], a[4:7], 0
    ds_read_b128 v[112:115], v117 offset:0
    v_mfma_f32_16x16x32_bf16 v[152:155], v[44:47], a[0:3], 0
    ds_read_b64_tr_b16 v[60:61], v191 offset:36864
    ds_read_b64_tr_b16 v[62:63], v191 offset:37376
    v_mfma_f32_16x16x32_bf16 v[156:159], v[44:47], a[4:7], 0
    buffer_load_dwordx4 v9, s[20:23], s1 offen offset:1024 lds
    s_add_u32 m0, s54, 8192
    s_add_u32 s0, s0, 128
    s_and_b32 s0, s0, 1023
    s_add_u32 s81, s73, s0
    s_waitcnt lgkmcnt(5)
    v_mfma_f32_16x16x32_bf16 v[128:131], v[48:51], a[8:11], v[128:131]
    s_barrier
    ds_read_b64_tr_b16 v[32:33], v16 offset:40960
    ds_read_b64_tr_b16 v[34:35], v16 offset:41472
    v_mfma_f32_16x16x32_bf16 v[132:135], v[48:51], a[12:15], v[132:135]
    buffer_load_dwordx4 v76, s[24:27], s81 offen offset:0 lds
    s_waitcnt lgkmcnt(4)
    v_mfma_f32_16x16x32_bf16 v[88:91], v[48:51], v[112:115], v[88:91]
    v_mfma_f32_16x16x32_bf16 v[136:139], v[52:55], a[8:11], v[136:139]
    ds_read_b64_tr_b16 v[36:37], v17 offset:40960
    ds_read_b64_tr_b16 v[38:39], v17 offset:41472
    v_mfma_f32_16x16x32_bf16 v[140:143], v[52:55], a[12:15], v[140:143]
    s_waitcnt lgkmcnt(4)
    v_mfma_f32_16x16x32_bf16 v[144:147], v[56:59], a[8:11], v[144:147]
    ds_read_b64_tr_b16 v[40:41], v190 offset:40960
    ds_read_b64_tr_b16 v[42:43], v190 offset:41472
    v_mfma_f32_16x16x32_bf16 v[148:151], v[56:59], a[12:15], v[148:151]
    ds_read_b128 v[72:75], v118 offset:0
    buffer_load_dwordx4 v77, s[24:27], s81 offen offset:1024 lds
    v_mfma_f32_16x16x32_bf16 v[152:155], v[60:63], a[8:11], v[152:155]
    ds_read_b64_tr_b16 v[44:45], v191 offset:40960
    ds_read_b64_tr_b16 v[46:47], v191 offset:41472
    v_mfma_f32_16x16x32_bf16 v[156:159], v[60:63], a[12:15], v[156:159]
    s_waitcnt lgkmcnt(5)
    v_mfma_f32_16x16x32_bf16 v[128:131], v[32:35], a[16:19], v[128:131]
    ds_read_b64_tr_b16 v[48:49], v16 offset:45056
    ds_read_b64_tr_b16 v[50:51], v16 offset:45568
    v_mfma_f32_16x16x32_bf16 v[132:135], v[32:35], a[20:23], v[132:135]
    buffer_load_dwordx4 v78, s[24:27], s81 offen offset:2048 lds
    s_waitcnt lgkmcnt(4)
    v_mfma_f32_16x16x32_bf16 v[88:91], v[32:35], v[72:75], v[88:91]
    v_mfma_f32_16x16x32_bf16 v[136:139], v[36:39], a[16:19], v[136:139]
    ds_read_b64_tr_b16 v[52:53], v17 offset:45056
    ds_read_b64_tr_b16 v[54:55], v17 offset:45568
    v_mfma_f32_16x16x32_bf16 v[140:143], v[36:39], a[20:23], v[140:143]
    buffer_load_dwordx4 v79, s[24:27], s81 offen offset:3072 lds
    s_waitcnt lgkmcnt(4)
    v_mfma_f32_16x16x32_bf16 v[144:147], v[40:43], a[16:19], v[144:147]
    ds_read_b64_tr_b16 v[56:57], v190 offset:45056
    ds_read_b64_tr_b16 v[58:59], v190 offset:45568
    v_mfma_f32_16x16x32_bf16 v[148:151], v[40:43], a[20:23], v[148:151]
    ds_read_b128 v[112:115], v119 offset:0
    s_waitcnt vmcnt(6)
    ds_read_b128 v[224:227], v12 offset:4096
    ds_read_b128 v[228:231], v13 offset:4096
    s_add_u32 m0, s54, 12288
    s_add_u32 s81, s52, s0
    v_mfma_f32_16x16x32_bf16 v[152:155], v[44:47], a[16:19], v[152:155]
    ds_read_b64_tr_b16 v[60:61], v191 offset:45056
    ds_read_b64_tr_b16 v[62:63], v191 offset:45568
    v_mfma_f32_16x16x32_bf16 v[156:159], v[44:47], a[20:23], v[156:159]
    ds_read_b128 v[232:235], v14 offset:4096
    ds_read_b128 v[236:239], v15 offset:4096
    buffer_load_dwordx4 v76, s[24:27], s81 offen offset:0 lds
    s_waitcnt lgkmcnt(9)
    v_mfma_f32_16x16x32_bf16 v[128:131], v[48:51], a[24:27], v[128:131]
    s_barrier
    ds_read_b64_tr_b16 v[32:33], v16 offset:0
    ds_read_b64_tr_b16 v[34:35], v16 offset:512
    v_mfma_f32_16x16x32_bf16 v[132:135], v[48:51], a[28:31], v[132:135]
    buffer_load_dwordx4 v77, s[24:27], s81 offen offset:1024 lds
    s_waitcnt lgkmcnt(8)
    v_mfma_f32_16x16x32_bf16 v[88:91], v[48:51], v[112:115], v[88:91]
    v_mfma_f32_16x16x32_bf16 v[136:139], v[52:55], a[24:27], v[136:139]
    ds_read_b64_tr_b16 v[36:37], v17 offset:0
    ds_read_b64_tr_b16 v[38:39], v17 offset:512
    v_mfma_f32_16x16x32_bf16 v[140:143], v[52:55], a[28:31], v[140:143]
    s_waitcnt lgkmcnt(4)
    v_mfma_f32_16x16x32_bf16 v[144:147], v[56:59], a[24:27], v[144:147]
    ds_read_b64_tr_b16 v[40:41], v190 offset:0
    ds_read_b64_tr_b16 v[42:43], v190 offset:512
    v_mfma_f32_16x16x32_bf16 v[148:151], v[56:59], a[28:31], v[148:151]
    ds_read_b128 v[72:75], v116 offset:256
    buffer_load_dwordx4 v78, s[24:27], s81 offen offset:2048 lds
    v_mfma_f32_16x16x32_bf16 v[152:155], v[60:63], a[24:27], v[152:155]
    ds_read_b64_tr_b16 v[44:45], v191 offset:0
    ds_read_b64_tr_b16 v[46:47], v191 offset:512
    v_mfma_f32_16x16x32_bf16 v[156:159], v[60:63], a[28:31], v[156:159]
    s_waitcnt lgkmcnt(5)
    v_mfma_f32_16x16x32_bf16 v[128:131], v[32:35], a[32:35], v[128:131]
    ds_read_b64_tr_b16 v[48:49], v16 offset:4096
    ds_read_b64_tr_b16 v[50:51], v16 offset:4608
    v_mfma_f32_16x16x32_bf16 v[132:135], v[32:35], a[36:39], v[132:135]
    buffer_load_dwordx4 v79, s[24:27], s81 offen offset:3072 lds
    s_waitcnt lgkmcnt(4)
    v_mfma_f32_16x16x32_bf16 v[88:91], v[32:35], v[72:75], v[88:91]
    v_mfma_f32_16x16x32_bf16 v[136:139], v[36:39], a[32:35], v[136:139]
    ds_read_b64_tr_b16 v[52:53], v17 offset:4096
    ds_read_b64_tr_b16 v[54:55], v17 offset:4608
    v_mfma_f32_16x16x32_bf16 v[140:143], v[36:39], a[36:39], v[140:143]
    s_add_u32 m0, s55, 32768
    s_add_u32 s1, s53, 1181696
    s_waitcnt lgkmcnt(4)
    v_mfma_f32_16x16x32_bf16 v[144:147], v[40:43], a[32:35], v[144:147]
    ds_read_b64_tr_b16 v[56:57], v190 offset:4096
    ds_read_b64_tr_b16 v[58:59], v190 offset:4608
    v_mfma_f32_16x16x32_bf16 v[148:151], v[40:43], a[36:39], v[148:151]
    ds_read_b128 v[112:115], v117 offset:256
    buffer_load_dwordx4 v8, s[20:23], s1 offen offset:0 lds
    v_mfma_f32_16x16x32_bf16 v[152:155], v[44:47], a[32:35], v[152:155]
    ds_read_b64_tr_b16 v[60:61], v191 offset:4096
    ds_read_b64_tr_b16 v[62:63], v191 offset:4608
    v_mfma_f32_16x16x32_bf16 v[156:159], v[44:47], a[36:39], v[156:159]
    s_waitcnt lgkmcnt(5)
    v_mfma_f32_16x16x32_bf16 v[128:131], v[48:51], a[40:43], v[128:131]
    s_barrier
    ds_read_b64_tr_b16 v[32:33], v16 offset:8192
    ds_read_b64_tr_b16 v[34:35], v16 offset:8704
    v_mfma_f32_16x16x32_bf16 v[132:135], v[48:51], a[44:47], v[132:135]
    buffer_load_dwordx4 v9, s[20:23], s1 offen offset:1024 lds
    s_add_u32 m0, s54, 0
    s_add_u32 s0, s0, 128
    s_and_b32 s0, s0, 1023
    s_add_u32 s81, s73, s0
    s_waitcnt lgkmcnt(4)
    v_mfma_f32_16x16x32_bf16 v[88:91], v[48:51], v[112:115], v[88:91]
    v_mfma_f32_16x16x32_bf16 v[136:139], v[52:55], a[40:43], v[136:139]
    ds_read_b64_tr_b16 v[36:37], v17 offset:8192
    ds_read_b64_tr_b16 v[38:39], v17 offset:8704
    v_mfma_f32_16x16x32_bf16 v[140:143], v[52:55], a[44:47], v[140:143]
    buffer_load_dwordx4 v76, s[24:27], s81 offen offset:0 lds
    s_waitcnt lgkmcnt(4)
    v_mfma_f32_16x16x32_bf16 v[144:147], v[56:59], a[40:43], v[144:147]
    ds_read_b64_tr_b16 v[40:41], v190 offset:8192
    ds_read_b64_tr_b16 v[42:43], v190 offset:8704
    v_mfma_f32_16x16x32_bf16 v[148:151], v[56:59], a[44:47], v[148:151]
    ds_read_b128 v[72:75], v118 offset:256
    v_mfma_f32_16x16x32_bf16 v[152:155], v[60:63], a[40:43], v[152:155]
    ds_read_b64_tr_b16 v[44:45], v191 offset:8192
    ds_read_b64_tr_b16 v[46:47], v191 offset:8704
    v_mfma_f32_16x16x32_bf16 v[156:159], v[60:63], a[44:47], v[156:159]
    buffer_load_dwordx4 v77, s[24:27], s81 offen offset:1024 lds
    s_waitcnt lgkmcnt(5)
    v_mfma_f32_16x16x32_bf16 v[128:131], v[32:35], a[48:51], v[128:131]
    ds_read_b64_tr_b16 v[48:49], v16 offset:12288
    ds_read_b64_tr_b16 v[50:51], v16 offset:12800
    v_mfma_f32_16x16x32_bf16 v[132:135], v[32:35], a[52:55], v[132:135]
    s_waitcnt vmcnt(8)
    ds_read_b128 v[208:211], v12 offset:8192
    ds_read_b128 v[212:215], v13 offset:8192
    s_waitcnt lgkmcnt(6)
    v_mfma_f32_16x16x32_bf16 v[88:91], v[32:35], v[72:75], v[88:91]
    v_mfma_f32_16x16x32_bf16 v[136:139], v[36:39], a[48:51], v[136:139]
    ds_read_b64_tr_b16 v[52:53], v17 offset:12288
    ds_read_b64_tr_b16 v[54:55], v17 offset:12800
    v_mfma_f32_16x16x32_bf16 v[140:143], v[36:39], a[52:55], v[140:143]
    ds_read_b128 v[216:219], v14 offset:8192
    ds_read_b128 v[220:223], v15 offset:8192
    buffer_load_dwordx4 v78, s[24:27], s81 offen offset:2048 lds
    s_waitcnt lgkmcnt(8)
    v_mfma_f32_16x16x32_bf16 v[144:147], v[40:43], a[48:51], v[144:147]
    ds_read_b64_tr_b16 v[56:57], v190 offset:12288
    ds_read_b64_tr_b16 v[58:59], v190 offset:12800
    v_mfma_f32_16x16x32_bf16 v[148:151], v[40:43], a[52:55], v[148:151]
    ds_read_b128 v[112:115], v119 offset:256
    v_mfma_f32_16x16x32_bf16 v[152:155], v[44:47], a[48:51], v[152:155]
    ds_read_b64_tr_b16 v[60:61], v191 offset:12288
    ds_read_b64_tr_b16 v[62:63], v191 offset:12800
    v_mfma_f32_16x16x32_bf16 v[156:159], v[44:47], a[52:55], v[156:159]
    buffer_load_dwordx4 v79, s[24:27], s81 offen offset:3072 lds
    s_waitcnt lgkmcnt(7)
    v_mfma_f32_16x16x32_bf16 v[128:131], v[48:51], a[56:59], v[128:131]
    s_barrier
    ds_read_b64_tr_b16 v[32:33], v16 offset:16384
    ds_read_b64_tr_b16 v[34:35], v16 offset:16896
    v_mfma_f32_16x16x32_bf16 v[132:135], v[48:51], a[60:63], v[132:135]
    s_add_u32 m0, s55, 40960
    s_add_u32 s1, s53, 1378304
    s_waitcnt vmcnt(6)
    s_waitcnt lgkmcnt(7)
    ds_read_b128 v[240:243], v12 offset:12288
    ds_read_b128 v[244:247], v13 offset:12288
    s_waitcnt lgkmcnt(6)
    v_mfma_f32_16x16x32_bf16 v[88:91], v[48:51], v[112:115], v[88:91]
    v_mfma_f32_16x16x32_bf16 v[136:139], v[52:55], a[56:59], v[136:139]
    ds_read_b64_tr_b16 v[36:37], v17 offset:16384
    ds_read_b64_tr_b16 v[38:39], v17 offset:16896
    v_mfma_f32_16x16x32_bf16 v[140:143], v[52:55], a[60:63], v[140:143]
    buffer_load_dwordx4 v8, s[20:23], s1 offen offset:0 lds
    ds_read_b128 v[248:251], v14 offset:12288
    ds_read_b128 v[252:255], v15 offset:12288
    s_waitcnt lgkmcnt(8)
    v_mfma_f32_16x16x32_bf16 v[144:147], v[56:59], a[56:59], v[144:147]
    ds_read_b64_tr_b16 v[40:41], v190 offset:16384
    ds_read_b64_tr_b16 v[42:43], v190 offset:16896
    v_mfma_f32_16x16x32_bf16 v[148:151], v[56:59], a[60:63], v[148:151]
    ds_read_b128 v[72:75], v116 offset:512
    buffer_load_dwordx4 v9, s[20:23], s1 offen offset:1024 lds
    s_add_u32 m0, s54, 4096
    s_add_u32 s81, s52, s0
    v_mfma_f32_16x16x32_bf16 v[152:155], v[60:63], a[56:59], v[152:155]
    ds_read_b64_tr_b16 v[44:45], v191 offset:16384
    ds_read_b64_tr_b16 v[46:47], v191 offset:16896
    v_mfma_f32_16x16x32_bf16 v[156:159], v[60:63], a[60:63], v[156:159]
    s_waitcnt lgkmcnt(7)
    v_mfma_f32_16x16x32_bf16 v[128:131], v[32:35], a[64:67], v[128:131]
    ds_read_b64_tr_b16 v[48:49], v16 offset:20480
    ds_read_b64_tr_b16 v[50:51], v16 offset:20992
    v_mfma_f32_16x16x32_bf16 v[132:135], v[32:35], a[68:71], v[132:135]
    s_waitcnt lgkmcnt(7)
    buffer_load_dwordx4 v76, s[24:27], s81 offen offset:0 lds
    s_waitcnt lgkmcnt(4)
    v_mfma_f32_16x16x32_bf16 v[88:91], v[32:35], v[72:75], v[88:91]
    v_mfma_f32_16x16x32_bf16 v[136:139], v[36:39], a[64:67], v[136:139]
    ds_read_b64_tr_b16 v[52:53], v17 offset:20480
    ds_read_b64_tr_b16 v[54:55], v17 offset:20992
    v_mfma_f32_16x16x32_bf16 v[140:143], v[36:39], a[68:71], v[140:143]
    s_waitcnt lgkmcnt(4)
    v_mfma_f32_16x16x32_bf16 v[144:147], v[40:43], a[64:67], v[144:147]
    ds_read_b64_tr_b16 v[56:57], v190 offset:20480
    ds_read_b64_tr_b16 v[58:59], v190 offset:20992
    v_mfma_f32_16x16x32_bf16 v[148:151], v[40:43], a[68:71], v[148:151]
    ds_read_b128 v[112:115], v117 offset:512
    buffer_load_dwordx4 v77, s[24:27], s81 offen offset:1024 lds
    v_mfma_f32_16x16x32_bf16 v[152:155], v[44:47], a[64:67], v[152:155]
    ds_read_b64_tr_b16 v[60:61], v191 offset:20480
    ds_read_b64_tr_b16 v[62:63], v191 offset:20992
    v_mfma_f32_16x16x32_bf16 v[156:159], v[44:47], a[68:71], v[156:159]
    s_waitcnt lgkmcnt(5)
    v_mfma_f32_16x16x32_bf16 v[128:131], v[48:51], a[72:75], v[128:131]
    s_barrier
    ds_read_b64_tr_b16 v[32:33], v16 offset:24576
    ds_read_b64_tr_b16 v[34:35], v16 offset:25088
    v_mfma_f32_16x16x32_bf16 v[132:135], v[48:51], a[76:79], v[132:135]
    buffer_load_dwordx4 v78, s[24:27], s81 offen offset:2048 lds
    s_waitcnt lgkmcnt(4)
    v_mfma_f32_16x16x32_bf16 v[88:91], v[48:51], v[112:115], v[88:91]
    v_mfma_f32_16x16x32_bf16 v[136:139], v[52:55], a[72:75], v[136:139]
    ds_read_b64_tr_b16 v[36:37], v17 offset:24576
    ds_read_b64_tr_b16 v[38:39], v17 offset:25088
    v_mfma_f32_16x16x32_bf16 v[140:143], v[52:55], a[76:79], v[140:143]
    s_waitcnt lgkmcnt(4)
    v_mfma_f32_16x16x32_bf16 v[144:147], v[56:59], a[72:75], v[144:147]
    ds_read_b64_tr_b16 v[40:41], v190 offset:24576
    ds_read_b64_tr_b16 v[42:43], v190 offset:25088
    v_mfma_f32_16x16x32_bf16 v[148:151], v[56:59], a[76:79], v[148:151]
    ds_read_b128 v[72:75], v118 offset:512
    buffer_load_dwordx4 v79, s[24:27], s81 offen offset:3072 lds
    v_mfma_f32_16x16x32_bf16 v[152:155], v[60:63], a[72:75], v[152:155]
    ds_read_b64_tr_b16 v[44:45], v191 offset:24576
    ds_read_b64_tr_b16 v[46:47], v191 offset:25088
    v_mfma_f32_16x16x32_bf16 v[156:159], v[60:63], a[76:79], v[156:159]
    s_add_u32 m0, s54, 8192
    s_add_u32 s0, s0, 128
    s_and_b32 s0, s0, 1023
    s_add_u32 s81, s73, s0
    s_waitcnt lgkmcnt(5)
    v_mfma_f32_16x16x32_bf16 v[128:131], v[32:35], a[80:83], v[128:131]
    ds_read_b64_tr_b16 v[48:49], v16 offset:28672
    ds_read_b64_tr_b16 v[50:51], v16 offset:29184
    v_mfma_f32_16x16x32_bf16 v[132:135], v[32:35], a[84:87], v[132:135]
    buffer_load_dwordx4 v76, s[24:27], s81 offen offset:0 lds
    s_waitcnt lgkmcnt(4)
    v_mfma_f32_16x16x32_bf16 v[88:91], v[32:35], v[72:75], v[88:91]
    v_mfma_f32_16x16x32_bf16 v[136:139], v[36:39], a[80:83], v[136:139]
    ds_read_b64_tr_b16 v[52:53], v17 offset:28672
    ds_read_b64_tr_b16 v[54:55], v17 offset:29184
    v_mfma_f32_16x16x32_bf16 v[140:143], v[36:39], a[84:87], v[140:143]
    buffer_load_dwordx4 v77, s[24:27], s81 offen offset:1024 lds
    s_waitcnt lgkmcnt(4)
    v_mfma_f32_16x16x32_bf16 v[144:147], v[40:43], a[80:83], v[144:147]
    ds_read_b64_tr_b16 v[56:57], v190 offset:28672
    ds_read_b64_tr_b16 v[58:59], v190 offset:29184
    v_mfma_f32_16x16x32_bf16 v[148:151], v[40:43], a[84:87], v[148:151]
    ds_read_b128 v[112:115], v119 offset:512
    s_waitcnt vmcnt(8)
    ds_read_b128 a[0:3], v12 offset:0
    ds_read_b128 a[4:7], v13 offset:0
    v_mfma_f32_16x16x32_bf16 v[152:155], v[44:47], a[80:83], v[152:155]
    ds_read_b64_tr_b16 v[60:61], v191 offset:28672
    ds_read_b64_tr_b16 v[62:63], v191 offset:29184
    v_mfma_f32_16x16x32_bf16 v[156:159], v[44:47], a[84:87], v[156:159]
    ds_read_b128 a[8:11], v14 offset:0
    ds_read_b128 a[12:15], v15 offset:0
    buffer_load_dwordx4 v78, s[24:27], s81 offen offset:2048 lds
    s_waitcnt lgkmcnt(9)
    v_mfma_f32_16x16x32_bf16 v[128:131], v[48:51], a[88:91], v[128:131]
    s_barrier
    ds_read_b64_tr_b16 v[32:33], v16 offset:32768
    ds_read_b64_tr_b16 v[34:35], v16 offset:33280
    v_mfma_f32_16x16x32_bf16 v[132:135], v[48:51], a[92:95], v[132:135]
    buffer_load_dwordx4 v79, s[24:27], s81 offen offset:3072 lds
    s_waitcnt lgkmcnt(8)
    v_mfma_f32_16x16x32_bf16 v[88:91], v[48:51], v[112:115], v[88:91]
    v_mfma_f32_16x16x32_bf16 v[136:139], v[52:55], a[88:91], v[136:139]
    ds_read_b64_tr_b16 v[36:37], v17 offset:32768
    ds_read_b64_tr_b16 v[38:39], v17 offset:33280
    v_mfma_f32_16x16x32_bf16 v[140:143], v[52:55], a[92:95], v[140:143]
    s_waitcnt lgkmcnt(4)
    s_add_u32 m0, s54, 12288
    s_add_u32 s81, s52, s0
    v_mfma_f32_16x16x32_bf16 v[144:147], v[56:59], a[88:91], v[144:147]
    ds_read_b64_tr_b16 v[40:41], v190 offset:32768
    ds_read_b64_tr_b16 v[42:43], v190 offset:33280
    v_mfma_f32_16x16x32_bf16 v[148:151], v[56:59], a[92:95], v[148:151]
    ds_read_b128 v[72:75], v116 offset:768
    buffer_load_dwordx4 v76, s[24:27], s81 offen offset:0 lds
    v_mfma_f32_16x16x32_bf16 v[152:155], v[60:63], a[88:91], v[152:155]
    ds_read_b64_tr_b16 v[44:45], v191 offset:32768
    ds_read_b64_tr_b16 v[46:47], v191 offset:33280
    v_mfma_f32_16x16x32_bf16 v[156:159], v[60:63], a[92:95], v[156:159]
    s_waitcnt lgkmcnt(5)
    v_mfma_f32_16x16x32_bf16 v[128:131], v[32:35], a[96:99], v[128:131]
    ds_read_b64_tr_b16 v[48:49], v16 offset:36864
    ds_read_b64_tr_b16 v[50:51], v16 offset:37376
    v_mfma_f32_16x16x32_bf16 v[132:135], v[32:35], a[100:103], v[132:135]
    buffer_load_dwordx4 v77, s[24:27], s81 offen offset:1024 lds
    s_waitcnt lgkmcnt(4)
    v_mfma_f32_16x16x32_bf16 v[88:91], v[32:35], v[72:75], v[88:91]
    v_mfma_f32_16x16x32_bf16 v[136:139], v[36:39], a[96:99], v[136:139]
    ds_read_b64_tr_b16 v[52:53], v17 offset:36864
    ds_read_b64_tr_b16 v[54:55], v17 offset:37376
    v_mfma_f32_16x16x32_bf16 v[140:143], v[36:39], a[100:103], v[140:143]
    buffer_load_dwordx4 v78, s[24:27], s81 offen offset:2048 lds
    s_waitcnt lgkmcnt(4)
    v_mfma_f32_16x16x32_bf16 v[144:147], v[40:43], a[96:99], v[144:147]
    ds_read_b64_tr_b16 v[56:57], v190 offset:36864
    ds_read_b64_tr_b16 v[58:59], v190 offset:37376
    v_mfma_f32_16x16x32_bf16 v[148:151], v[40:43], a[100:103], v[148:151]
    ds_read_b128 v[112:115], v117 offset:768
    v_mfma_f32_16x16x32_bf16 v[152:155], v[44:47], a[96:99], v[152:155]
    ds_read_b64_tr_b16 v[60:61], v191 offset:36864
    ds_read_b64_tr_b16 v[62:63], v191 offset:37376
    v_mfma_f32_16x16x32_bf16 v[156:159], v[44:47], a[100:103], v[156:159]
    buffer_load_dwordx4 v79, s[24:27], s81 offen offset:3072 lds
    s_waitcnt lgkmcnt(5)
    v_mfma_f32_16x16x32_bf16 v[128:131], v[48:51], a[104:107], v[128:131]
    s_waitcnt vmcnt(12)
    s_barrier
    ds_read_b64_tr_b16 v[32:33], v16 offset:40960
    ds_read_b64_tr_b16 v[34:35], v16 offset:41472
    v_mfma_f32_16x16x32_bf16 v[132:135], v[48:51], a[108:111], v[132:135]
    s_waitcnt vmcnt(8)
    ds_read_b128 a[32:35], v12 offset:4096
    ds_read_b128 a[36:39], v13 offset:4096
    v_add_u32 v76, 0, v87
    v_add_u32 v77, 7168, v87
    v_add_u32 v78, 14336, v87
    v_add_u32 v79, 21504, v87
    s_waitcnt lgkmcnt(6)
    v_mfma_f32_16x16x32_bf16 v[88:91], v[48:51], v[112:115], v[88:91]
    v_mfma_f32_16x16x32_bf16 v[136:139], v[52:55], a[104:107], v[136:139]
    ds_read_b64_tr_b16 v[36:37], v17 offset:40960
    ds_read_b64_tr_b16 v[38:39], v17 offset:41472
    v_mfma_f32_16x16x32_bf16 v[140:143], v[52:55], a[108:111], v[140:143]
    ds_read_b128 a[40:43], v14 offset:4096
    ds_read_b128 a[44:47], v15 offset:4096
    s_add_u32 m0, s54, 0
    s_add_u32 s81, s74, 0
    s_waitcnt lgkmcnt(8)
    v_mfma_f32_16x16x32_bf16 v[144:147], v[56:59], a[104:107], v[144:147]
    ds_read_b64_tr_b16 v[40:41], v190 offset:40960
    ds_read_b64_tr_b16 v[42:43], v190 offset:41472
    v_mfma_f32_16x16x32_bf16 v[148:151], v[56:59], a[108:111], v[148:151]
    ds_read_b128 v[72:75], v118 offset:768
    buffer_load_dwordx4 v76, s[32:35], s81 offen offset:0 lds
    v_mfma_f32_16x16x32_bf16 v[152:155], v[60:63], a[104:107], v[152:155]
    ds_read_b64_tr_b16 v[44:45], v191 offset:40960
    ds_read_b64_tr_b16 v[46:47], v191 offset:41472
    v_mfma_f32_16x16x32_bf16 v[156:159], v[60:63], a[108:111], v[156:159]
    s_waitcnt lgkmcnt(7)
    v_mfma_f32_16x16x32_bf16 v[128:131], v[32:35], a[112:115], v[128:131]
    ds_read_b64_tr_b16 v[48:49], v16 offset:45056
    ds_read_b64_tr_b16 v[50:51], v16 offset:45568
    v_mfma_f32_16x16x32_bf16 v[132:135], v[32:35], a[116:119], v[132:135]
    s_waitcnt vmcnt(5)
    s_waitcnt lgkmcnt(7)
    ds_read_b128 a[16:19], v12 offset:8192
    ds_read_b128 a[20:23], v13 offset:8192
    buffer_load_dwordx4 v77, s[32:35], s81 offen offset:1024 lds
    s_waitcnt lgkmcnt(6)
    v_mfma_f32_16x16x32_bf16 v[88:91], v[32:35], v[72:75], v[88:91]
    v_mfma_f32_16x16x32_bf16 v[136:139], v[36:39], a[112:115], v[136:139]
    ds_read_b64_tr_b16 v[52:53], v17 offset:45056
    ds_read_b64_tr_b16 v[54:55], v17 offset:45568
    v_mfma_f32_16x16x32_bf16 v[140:143], v[36:39], a[116:119], v[140:143]
    ds_read_b128 a[24:27], v14 offset:8192
    ds_read_b128 a[28:31], v15 offset:8192
    buffer_load_dwordx4 v78, s[32:35], s81 offen offset:2048 lds
    s_waitcnt lgkmcnt(8)
    v_mfma_f32_16x16x32_bf16 v[144:147], v[40:43], a[112:115], v[144:147]
    ds_read_b64_tr_b16 v[56:57], v190 offset:45056
    ds_read_b64_tr_b16 v[58:59], v190 offset:45568
    v_mfma_f32_16x16x32_bf16 v[148:151], v[40:43], a[116:119], v[148:151]
    ds_read_b128 v[112:115], v119 offset:768
    v_mfma_f32_16x16x32_bf16 v[152:155], v[44:47], a[112:115], v[152:155]
    ds_read_b64_tr_b16 v[60:61], v191 offset:45056
    ds_read_b64_tr_b16 v[62:63], v191 offset:45568
    v_mfma_f32_16x16x32_bf16 v[156:159], v[44:47], a[116:119], v[156:159]
    buffer_load_dwordx4 v79, s[32:35], s81 offen offset:3072 lds
    s_waitcnt lgkmcnt(7)
    v_mfma_f32_16x16x32_bf16 v[128:131], v[48:51], a[120:123], v[128:131]
    v_mfma_f32_16x16x32_bf16 v[132:135], v[48:51], a[124:127], v[132:135]
    s_waitcnt lgkmcnt(5)
    s_add_u32 m0, s54, 4096
    s_add_u32 s81, s74, 32768
    s_waitcnt lgkmcnt(2)
    v_mfma_f32_16x16x32_bf16 v[88:91], v[48:51], v[112:115], v[88:91]
    v_mfma_f32_16x16x32_bf16 v[136:139], v[52:55], a[120:123], v[136:139]
    v_mfma_f32_16x16x32_bf16 v[140:143], v[52:55], a[124:127], v[140:143]
    buffer_load_dwordx4 v76, s[32:35], s81 offen offset:0 lds
    s_waitcnt lgkmcnt(0)
    v_mfma_f32_16x16x32_bf16 v[144:147], v[56:59], a[120:123], v[144:147]
    v_mfma_f32_16x16x32_bf16 v[148:151], v[56:59], a[124:127], v[148:151]
    v_mfma_f32_16x16x32_bf16 v[152:155], v[60:63], a[120:123], v[152:155]
    v_mfma_f32_16x16x32_bf16 v[156:159], v[60:63], a[124:127], v[156:159]
    buffer_load_dwordx4 v77, s[32:35], s81 offen offset:1024 lds
    v_and_b32 v10, 48, v1
    v_add_u32 v10, 151808, v10
    s_lshl_b32 s58, s4, 6
    v_add_u32 v3, s58, v10
    s_mov_b32 exec_lo, 0x00010001
    s_mov_b32 exec_hi, 0x00010001
    ds_write_b128 v3, v[88:91] offset:0
    s_mov_b64 exec, -1
    s_waitcnt lgkmcnt(0)
    s_barrier
    v_mov_b32_dpp v92, v88 row_newbcast:0 row_mask:0xf bank_mask:0xf
    v_mov_b32_dpp v93, v89 row_newbcast:0 row_mask:0xf bank_mask:0xf
    v_mov_b32_dpp v94, v90 row_newbcast:0 row_mask:0xf bank_mask:0xf
    v_mov_b32_dpp v95, v91 row_newbcast:0 row_mask:0xf bank_mask:0xf
    v_pk_fma_f32 v[88:89], v[92:93], v[182:183], v[88:89] op_sel_hi:[1,0,1]
    v_pk_fma_f32 v[90:91], v[94:95], v[182:183], v[90:91] op_sel_hi:[1,0,1]
    v_pk_mul_f32 v[88:89], v[88:89], v[182:183] op_sel:[0,1] op_sel_hi:[1,1]
    v_pk_mul_f32 v[90:91], v[90:91], v[182:183] op_sel:[0,1] op_sel_hi:[1,1]
    ds_write_b128 v181, v[88:91]
    s_lshl_b32 s58, s4, 6
    v_xor_b32 v56, s58, v10
    v_xor_b32 v57, 64, v56
    v_xor_b32 v58, 128, v56
    v_xor_b32 v59, 192, v56
    ds_read_b128 v[32:35], v56 offset:0
    ds_read_b128 v[36:39], v57 offset:0
    ds_read_b128 v[40:43], v58 offset:0
    ds_read_b128 v[44:47], v59 offset:0
    s_waitcnt lgkmcnt(3)
    v_pk_fma_f32 v[128:129], v[32:33], v[24:25], v[128:129] op_sel_hi:[1,0,1]
    v_pk_fma_f32 v[130:131], v[34:35], v[24:25], v[130:131] op_sel_hi:[1,0,1]
    v_pk_fma_f32 v[132:133], v[32:33], v[26:27], v[132:133] op_sel_hi:[1,0,1]
    v_pk_fma_f32 v[134:135], v[34:35], v[26:27], v[134:135] op_sel_hi:[1,0,1]
    s_waitcnt lgkmcnt(2)
    v_pk_fma_f32 v[136:137], v[36:37], v[24:25], v[136:137] op_sel_hi:[1,0,1]
    v_pk_fma_f32 v[138:139], v[38:39], v[24:25], v[138:139] op_sel_hi:[1,0,1]
    v_pk_fma_f32 v[140:141], v[36:37], v[26:27], v[140:141] op_sel_hi:[1,0,1]
    v_pk_fma_f32 v[142:143], v[38:39], v[26:27], v[142:143] op_sel_hi:[1,0,1]
    s_waitcnt vmcnt(6)
    ds_read_b128 a[48:51], v12 offset:12288
    ds_read_b128 a[52:55], v13 offset:12288
    buffer_load_dwordx4 v78, s[32:35], s81 offen offset:2048 lds
    s_waitcnt lgkmcnt(3)
    v_pk_fma_f32 v[144:145], v[40:41], v[24:25], v[144:145] op_sel_hi:[1,0,1]
    v_pk_fma_f32 v[146:147], v[42:43], v[24:25], v[146:147] op_sel_hi:[1,0,1]
    v_pk_fma_f32 v[148:149], v[40:41], v[26:27], v[148:149] op_sel_hi:[1,0,1]
    v_pk_fma_f32 v[150:151], v[42:43], v[26:27], v[150:151] op_sel_hi:[1,0,1]
    s_waitcnt lgkmcnt(2)
    v_pk_fma_f32 v[152:153], v[44:45], v[24:25], v[152:153] op_sel_hi:[1,0,1]
    v_pk_fma_f32 v[154:155], v[46:47], v[24:25], v[154:155] op_sel_hi:[1,0,1]
    v_pk_fma_f32 v[156:157], v[44:45], v[26:27], v[156:157] op_sel_hi:[1,0,1]
    v_pk_fma_f32 v[158:159], v[46:47], v[26:27], v[158:159] op_sel_hi:[1,0,1]
    ds_read_b128 a[56:59], v14 offset:12288
    ds_read_b128 a[60:63], v15 offset:12288
    buffer_load_dwordx4 v79, s[32:35], s81 offen offset:3072 lds
    v_pk_mul_f32 v[128:129], v[128:129], v[24:25] op_sel:[0,1] op_sel_hi:[1,1]
    v_pk_mul_f32 v[130:131], v[130:131], v[24:25] op_sel:[0,1] op_sel_hi:[1,1]
    v_pk_mul_f32 v[132:133], v[132:133], v[26:27] op_sel:[0,1] op_sel_hi:[1,1]
    v_pk_mul_f32 v[134:135], v[134:135], v[26:27] op_sel:[0,1] op_sel_hi:[1,1]
    v_pk_mul_f32 v[136:137], v[136:137], v[24:25] op_sel:[0,1] op_sel_hi:[1,1]
    v_pk_mul_f32 v[138:139], v[138:139], v[24:25] op_sel:[0,1] op_sel_hi:[1,1]
    v_pk_mul_f32 v[140:141], v[140:141], v[26:27] op_sel:[0,1] op_sel_hi:[1,1]
    v_pk_mul_f32 v[142:143], v[142:143], v[26:27] op_sel:[0,1] op_sel_hi:[1,1]
    v_pk_mul_f32 v[144:145], v[144:145], v[24:25] op_sel:[0,1] op_sel_hi:[1,1]
    v_pk_mul_f32 v[146:147], v[146:147], v[24:25] op_sel:[0,1] op_sel_hi:[1,1]
    v_pk_mul_f32 v[148:149], v[148:149], v[26:27] op_sel:[0,1] op_sel_hi:[1,1]
    v_pk_mul_f32 v[150:151], v[150:151], v[26:27] op_sel:[0,1] op_sel_hi:[1,1]
    v_pk_mul_f32 v[152:153], v[152:153], v[24:25] op_sel:[0,1] op_sel_hi:[1,1]
    v_pk_mul_f32 v[154:155], v[154:155], v[24:25] op_sel:[0,1] op_sel_hi:[1,1]
    v_pk_mul_f32 v[156:157], v[156:157], v[26:27] op_sel:[0,1] op_sel_hi:[1,1]
    v_pk_mul_f32 v[158:159], v[158:159], v[26:27] op_sel:[0,1] op_sel_hi:[1,1]
    s_add_u32 m0, s54, 8192
    s_add_u32 s81, s74, 65536
    s_xor_b32 s58, s4, 0
    v_lshl_add_u32 v56, s58, 6, v179
    s_xor_b32 s58, s4, 1
    v_lshl_add_u32 v57, s58, 6, v179
    s_xor_b32 s58, s4, 2
    v_lshl_add_u32 v58, s58, 6, v179
    s_xor_b32 s58, s4, 3
    v_lshl_add_u32 v59, s58, 6, v179
    ds_write_b128 v56, v[128:131] offset:0
    ds_write_b128 v56, v[132:135] offset:4352
    ds_write_b128 v57, v[136:139] offset:0
    ds_write_b128 v57, v[140:143] offset:4352
    ds_write_b128 v58, v[144:147] offset:0
    ds_write_b128 v58, v[148:151] offset:4352
    ds_write_b128 v59, v[152:155] offset:0
    ds_write_b128 v59, v[156:159] offset:4352
    v_and_b32 v2, 31, v1
    s_lshl_b32 s59, s3, 5
    v_add_u32 v2, s59, v2
    v_mov_b32 v187, v2
    v_cmp_le_u32 s[64:65], 2, v2
    v_cmp_le_u32 s[66:67], 4, v2
    v_cmp_le_u32 s[68:69], 6, v2
    v_cmp_le_u32 s[70:71], 8, v2
    v_cmp_le_u32 s[76:77], 10, v2
    v_cmp_le_u32 s[78:79], 12, v2
    s_waitcnt lgkmcnt(8)
    buffer_load_dwordx4 v76, s[32:35], s81 offen offset:0 lds
    s_waitcnt lgkmcnt(0)
    s_barrier
    ds_read_b128 v[32:35], v176 offset:2016
    ds_read_b128 v[36:39], v176 offset:2032
    ds_read_b128 v[40:43], v176 offset:1728
    ds_read_b128 v[44:47], v176 offset:1744
    ds_read_b128 v[48:51], v176 offset:1440
    ds_read_b128 v[52:55], v176 offset:1456
    ds_read_b128 v[56:59], v176 offset:1152
    ds_read_b128 v[60:63], v176 offset:1168
    s_waitcnt lgkmcnt(4)
    v_dot2_f32_bf16 v128, v160, v32, 0
    v_dot2_f32_bf16 v129, v160, v40, 0
    v_dot2_f32_bf16 v128, v161, v33, v128
    v_dot2_f32_bf16 v129, v161, v41, v129
    v_dot2_f32_bf16 v128, v162, v34, v128
    v_dot2_f32_bf16 v129, v162, v42, v129
    v_dot2_f32_bf16 v128, v163, v35, v128
    v_dot2_f32_bf16 v129, v163, v43, v129
    v_dot2_f32_bf16 v128, v164, v36, v128
    v_dot2_f32_bf16 v129, v164, v44, v129
    v_dot2_f32_bf16 v128, v165, v37, v128
    v_dot2_f32_bf16 v129, v165, v45, v129
    v_dot2_f32_bf16 v128, v166, v38, v128
    v_dot2_f32_bf16 v129, v166, v46, v129
    v_dot2_f32_bf16 v128, v167, v39, v128
    v_dot2_f32_bf16 v129, v167, v47, v129
    buffer_load_dwordx4 v77, s[32:35], s81 offen offset:1024 lds
    ds_read_b128 v[64:67], v176 offset:864
    ds_read_b128 v[68:71], v176 offset:880
    ds_read_b128 v[112:115], v176 offset:576
    ds_read_b128 v[116:119], v176 offset:592
    s_waitcnt lgkmcnt(4)
    v_dot2_f32_bf16 v130, v160, v48, 0
    v_dot2_f32_bf16 v131, v160, v56, 0
    v_dot2_f32_bf16 v130, v161, v49, v130
    v_dot2_f32_bf16 v131, v161, v57, v131
    v_dot2_f32_bf16 v130, v162, v50, v130
    v_dot2_f32_bf16 v131, v162, v58, v131
    v_dot2_f32_bf16 v130, v163, v51, v130
    v_dot2_f32_bf16 v131, v163, v59, v131
    v_dot2_f32_bf16 v130, v164, v52, v130
    v_dot2_f32_bf16 v131, v164, v60, v131
    v_dot2_f32_bf16 v130, v165, v53, v130
    v_dot2_f32_bf16 v131, v165, v61, v131
    v_dot2_f32_bf16 v130, v166, v54, v130
    v_dot2_f32_bf16 v131, v166, v62, v131
    v_dot2_f32_bf16 v130, v167, v55, v130
    v_dot2_f32_bf16 v131, v167, v63, v131
    buffer_load_dwordx4 v78, s[32:35], s81 offen offset:2048 lds
    ds_read_b128 v[32:35], v176 offset:288
    ds_read_b128 v[36:39], v176 offset:304
    ds_read_b128 v[40:43], v176 offset:0
    ds_read_b128 v[44:47], v176 offset:16
    s_waitcnt lgkmcnt(4)
    v_dot2_f32_bf16 v132, v160, v64, 0
    v_dot2_f32_bf16 v133, v160, v112, 0
    v_dot2_f32_bf16 v132, v161, v65, v132
    v_dot2_f32_bf16 v133, v161, v113, v133
    v_dot2_f32_bf16 v132, v162, v66, v132
    v_dot2_f32_bf16 v133, v162, v114, v133
    v_dot2_f32_bf16 v132, v163, v67, v132
    v_dot2_f32_bf16 v133, v163, v115, v133
    v_dot2_f32_bf16 v132, v164, v68, v132
    v_dot2_f32_bf16 v133, v164, v116, v133
    v_dot2_f32_bf16 v132, v165, v69, v132
    v_dot2_f32_bf16 v133, v165, v117, v133
    v_dot2_f32_bf16 v132, v166, v70, v132
    v_dot2_f32_bf16 v133, v166, v118, v133
    v_dot2_f32_bf16 v132, v167, v71, v132
    v_dot2_f32_bf16 v133, v167, v119, v133
    buffer_load_dwordx4 v79, s[32:35], s81 offen offset:3072 lds
    s_waitcnt lgkmcnt(0)
    v_dot2_f32_bf16 v134, v160, v32, 0
    v_dot2_f32_bf16 v135, v160, v40, 0
    v_dot2_f32_bf16 v134, v161, v33, v134
    v_dot2_f32_bf16 v135, v161, v41, v135
    v_dot2_f32_bf16 v134, v162, v34, v134
    v_dot2_f32_bf16 v135, v162, v42, v135
    v_dot2_f32_bf16 v134, v163, v35, v134
    v_dot2_f32_bf16 v135, v163, v43, v135
    v_dot2_f32_bf16 v134, v164, v36, v134
    v_dot2_f32_bf16 v135, v164, v44, v135
    v_dot2_f32_bf16 v134, v165, v37, v134
    v_dot2_f32_bf16 v135, v165, v45, v135
    v_dot2_f32_bf16 v134, v166, v38, v134
    v_dot2_f32_bf16 v135, v166, v46, v135
    v_dot2_f32_bf16 v134, v167, v39, v134
    v_dot2_f32_bf16 v135, v167, v47, v135
    s_add_u32 m0, s54, 12288
    s_add_u32 s81, s74, 98304
    ds_read_b128 v[32:35], v177 offset:3808
    ds_read_b128 v[36:39], v177 offset:3824
    ds_read_b128 v[40:43], v177 offset:3840
    ds_read_b128 v[44:47], v177 offset:3856
    ds_read_b128 v[48:51], v177 offset:3264
    ds_read_b128 v[52:55], v177 offset:3280
    ds_read_b128 v[56:59], v177 offset:3296
    ds_read_b128 v[60:63], v177 offset:3312
    v_cmp_le_u32 vcc, 14, v187
    v_cndmask_b32 v129, v184, v129, s[64:65]
    v_cndmask_b32 v130, v184, v130, s[66:67]
    v_cndmask_b32 v131, v184, v131, s[68:69]
    v_cndmask_b32 v132, v184, v132, s[70:71]
    v_cndmask_b32 v133, v184, v133, s[76:77]
    v_cndmask_b32 v134, v184, v134, s[78:79]
    v_cndmask_b32 v135, v184, v135, vcc
    v_max3_f32 v136, v128, v129, v130
    v_max3_f32 v137, v131, v132, v133
    v_max3_f32 v136, v136, v134, v135
    v_max_f32 v136, v136, v137
    v_mul_f32 v136, v136, v185
    v_fma_f32 v128, v128, v185, -v136
    v_fma_f32 v129, v129, v185, -v136
    v_fma_f32 v130, v130, v185, -v136
    v_fma_f32 v131, v131, v185, -v136
    v_fma_f32 v132, v132, v185, -v136
    v_fma_f32 v133, v133, v185, -v136
    v_fma_f32 v134, v134, v185, -v136
    v_fma_f32 v135, v135, v185, -v136
    v_exp_f32 v128, v128
    v_exp_f32 v129, v129
    v_exp_f32 v130, v130
    v_exp_f32 v131, v131
    v_exp_f32 v132, v132
    v_exp_f32 v133, v133
    v_exp_f32 v134, v134
    v_exp_f32 v135, v135
    v_pk_add_f32 v[136:137], v[128:129], v[130:131]
    v_pk_add_f32 v[138:139], v[132:133], v[134:135]
    v_pk_add_f32 v[136:137], v[136:137], v[138:139]
    v_add_f32 v136, v136, v137
    v_rcp_f32 v136, v136
    buffer_load_dwordx4 v76, s[32:35], s81 offen offset:0 lds
    v_and_b32 v84, 15, v1
    v_lshlrev_b32 v84, 7, v84
    s_lshl_b32 s58, s10, 2
    s_add_u32 s58, s58, s4
    s_lshl_b32 s58, s58, 11
    s_add_u32 s58, s58, 65536
    v_add_u32 v84, s58, v84
    buffer_load_dword v85, v84, s[28:31], 0 offen sc1
    v_and_b32 v2, 31, v1
    s_cmp_eq_u32 s10, 7
    s_cselect_b32 s58, 15, 63
    s_cselect_b32 s59, 2147483648, 0
    v_cmp_lt_u32 vcc, s58, v2
    v_or_b32 v9, s59, v28
    v_mov_b32 v3, 2147483648
    v_cndmask_b32 v8, v28, v3, vcc
    s_mul_i32 s62, s10, 393216
    s_mul_i32 s58, s4, 98304
    s_add_u32 s62, s62, s58
    s_add_u32 s62, s62, 1048576
    s_mov_b32 s56, s62
    s_add_u32 s83, s62, 98304
    s_mul_i32 s58, s8, 12288
    s_add_u32 s62, s62, s58
    ds_read_b128 v[112:115], v177 offset:2720
    ds_read_b128 v[116:119], v177 offset:2736
    ds_read_b128 v[120:123], v177 offset:2752
    ds_read_b128 v[124:127], v177 offset:2768
    s_waitcnt lgkmcnt(8)
    v_pk_mul_f32 v[140:141], v[32:33], v[128:129] op_sel_hi:[1,0]
    v_pk_mul_f32 v[142:143], v[34:35], v[128:129] op_sel_hi:[1,0]
    v_pk_mul_f32 v[144:145], v[36:37], v[128:129] op_sel_hi:[1,0]
    v_pk_mul_f32 v[146:147], v[38:39], v[128:129] op_sel_hi:[1,0]
    v_pk_mul_f32 v[148:149], v[40:41], v[128:129] op_sel_hi:[1,0]
    v_pk_mul_f32 v[150:151], v[42:43], v[128:129] op_sel_hi:[1,0]
    v_pk_mul_f32 v[152:153], v[44:45], v[128:129] op_sel_hi:[1,0]
    v_pk_mul_f32 v[154:155], v[46:47], v[128:129] op_sel_hi:[1,0]
    buffer_load_dwordx4 v77, s[32:35], s81 offen offset:1024 lds
    ds_read_b128 v[32:35], v177 offset:2176
    ds_read_b128 v[36:39], v177 offset:2192
    ds_read_b128 v[40:43], v177 offset:2208
    ds_read_b128 v[44:47], v177 offset:2224
    s_waitcnt lgkmcnt(8)
    v_pk_fma_f32 v[140:141], v[48:49], v[128:129], v[140:141] op_sel:[0,1,0] op_sel_hi:[1,1,1]
    v_pk_fma_f32 v[142:143], v[50:51], v[128:129], v[142:143] op_sel:[0,1,0] op_sel_hi:[1,1,1]
    v_pk_fma_f32 v[144:145], v[52:53], v[128:129], v[144:145] op_sel:[0,1,0] op_sel_hi:[1,1,1]
    v_pk_fma_f32 v[146:147], v[54:55], v[128:129], v[146:147] op_sel:[0,1,0] op_sel_hi:[1,1,1]
    v_pk_fma_f32 v[148:149], v[56:57], v[128:129], v[148:149] op_sel:[0,1,0] op_sel_hi:[1,1,1]
    v_pk_fma_f32 v[150:151], v[58:59], v[128:129], v[150:151] op_sel:[0,1,0] op_sel_hi:[1,1,1]
    v_pk_fma_f32 v[152:153], v[60:61], v[128:129], v[152:153] op_sel:[0,1,0] op_sel_hi:[1,1,1]
    v_pk_fma_f32 v[154:155], v[62:63], v[128:129], v[154:155] op_sel:[0,1,0] op_sel_hi:[1,1,1]
    buffer_load_dwordx4 v78, s[32:35], s81 offen offset:2048 lds
    ds_read_b128 v[48:51], v177 offset:1632
    ds_read_b128 v[52:55], v177 offset:1648
    ds_read_b128 v[56:59], v177 offset:1664
    ds_read_b128 v[60:63], v177 offset:1680
    s_waitcnt lgkmcnt(8)
    v_pk_fma_f32 v[140:141], v[112:113], v[130:131], v[140:141] op_sel_hi:[1,0,1]
    v_pk_fma_f32 v[142:143], v[114:115], v[130:131], v[142:143] op_sel_hi:[1,0,1]
    v_pk_fma_f32 v[144:145], v[116:117], v[130:131], v[144:145] op_sel_hi:[1,0,1]
    v_pk_fma_f32 v[146:147], v[118:119], v[130:131], v[146:147] op_sel_hi:[1,0,1]
    v_pk_fma_f32 v[148:149], v[120:121], v[130:131], v[148:149] op_sel_hi:[1,0,1]
    v_pk_fma_f32 v[150:151], v[122:123], v[130:131], v[150:151] op_sel_hi:[1,0,1]
    v_pk_fma_f32 v[152:153], v[124:125], v[130:131], v[152:153] op_sel_hi:[1,0,1]
    v_pk_fma_f32 v[154:155], v[126:127], v[130:131], v[154:155] op_sel_hi:[1,0,1]
    buffer_load_dwordx4 v79, s[32:35], s81 offen offset:3072 lds
    ds_read_b128 v[112:115], v177 offset:1088
    ds_read_b128 v[116:119], v177 offset:1104
    ds_read_b128 v[120:123], v177 offset:1120
    ds_read_b128 v[124:127], v177 offset:1136
    s_waitcnt lgkmcnt(8)
    v_pk_fma_f32 v[140:141], v[32:33], v[130:131], v[140:141] op_sel:[0,1,0] op_sel_hi:[1,1,1]
    v_pk_fma_f32 v[142:143], v[34:35], v[130:131], v[142:143] op_sel:[0,1,0] op_sel_hi:[1,1,1]
    v_pk_fma_f32 v[144:145], v[36:37], v[130:131], v[144:145] op_sel:[0,1,0] op_sel_hi:[1,1,1]
    v_pk_fma_f32 v[146:147], v[38:39], v[130:131], v[146:147] op_sel:[0,1,0] op_sel_hi:[1,1,1]
    v_pk_fma_f32 v[148:149], v[40:41], v[130:131], v[148:149] op_sel:[0,1,0] op_sel_hi:[1,1,1]
    v_pk_fma_f32 v[150:151], v[42:43], v[130:131], v[150:151] op_sel:[0,1,0] op_sel_hi:[1,1,1]
    v_pk_fma_f32 v[152:153], v[44:45], v[130:131], v[152:153] op_sel:[0,1,0] op_sel_hi:[1,1,1]
    v_pk_fma_f32 v[154:155], v[46:47], v[130:131], v[154:155] op_sel:[0,1,0] op_sel_hi:[1,1,1]
    ds_read_b128 v[32:35], v177 offset:544
    ds_read_b128 v[36:39], v177 offset:560
    ds_read_b128 v[40:43], v177 offset:576
    ds_read_b128 v[44:47], v177 offset:592
    s_waitcnt lgkmcnt(8)
    v_pk_fma_f32 v[140:141], v[48:49], v[132:133], v[140:141] op_sel_hi:[1,0,1]
    v_pk_fma_f32 v[142:143], v[50:51], v[132:133], v[142:143] op_sel_hi:[1,0,1]
    v_pk_fma_f32 v[144:145], v[52:53], v[132:133], v[144:145] op_sel_hi:[1,0,1]
    v_pk_fma_f32 v[146:147], v[54:55], v[132:133], v[146:147] op_sel_hi:[1,0,1]
    v_pk_fma_f32 v[148:149], v[56:57], v[132:133], v[148:149] op_sel_hi:[1,0,1]
    v_pk_fma_f32 v[150:151], v[58:59], v[132:133], v[150:151] op_sel_hi:[1,0,1]
    v_pk_fma_f32 v[152:153], v[60:61], v[132:133], v[152:153] op_sel_hi:[1,0,1]
    v_pk_fma_f32 v[154:155], v[62:63], v[132:133], v[154:155] op_sel_hi:[1,0,1]
    ds_read_b128 v[48:51], v177 offset:0
    ds_read_b128 v[52:55], v177 offset:16
    ds_read_b128 v[56:59], v177 offset:32
    ds_read_b128 v[60:63], v177 offset:48
    s_waitcnt lgkmcnt(8)
    v_pk_fma_f32 v[140:141], v[112:113], v[132:133], v[140:141] op_sel:[0,1,0] op_sel_hi:[1,1,1]
    v_pk_fma_f32 v[142:143], v[114:115], v[132:133], v[142:143] op_sel:[0,1,0] op_sel_hi:[1,1,1]
    v_pk_fma_f32 v[144:145], v[116:117], v[132:133], v[144:145] op_sel:[0,1,0] op_sel_hi:[1,1,1]
    v_pk_fma_f32 v[146:147], v[118:119], v[132:133], v[146:147] op_sel:[0,1,0] op_sel_hi:[1,1,1]
    v_pk_fma_f32 v[148:149], v[120:121], v[132:133], v[148:149] op_sel:[0,1,0] op_sel_hi:[1,1,1]
    v_pk_fma_f32 v[150:151], v[122:123], v[132:133], v[150:151] op_sel:[0,1,0] op_sel_hi:[1,1,1]
    v_pk_fma_f32 v[152:153], v[124:125], v[132:133], v[152:153] op_sel:[0,1,0] op_sel_hi:[1,1,1]
    v_pk_fma_f32 v[154:155], v[126:127], v[132:133], v[154:155] op_sel:[0,1,0] op_sel_hi:[1,1,1]
    s_waitcnt lgkmcnt(4)
    v_pk_fma_f32 v[140:141], v[32:33], v[134:135], v[140:141] op_sel_hi:[1,0,1]
    v_pk_fma_f32 v[142:143], v[34:35], v[134:135], v[142:143] op_sel_hi:[1,0,1]
    v_pk_fma_f32 v[144:145], v[36:37], v[134:135], v[144:145] op_sel_hi:[1,0,1]
    v_pk_fma_f32 v[146:147], v[38:39], v[134:135], v[146:147] op_sel_hi:[1,0,1]
    v_pk_fma_f32 v[148:149], v[40:41], v[134:135], v[148:149] op_sel_hi:[1,0,1]
    v_pk_fma_f32 v[150:151], v[42:43], v[134:135], v[150:151] op_sel_hi:[1,0,1]
    v_pk_fma_f32 v[152:153], v[44:45], v[134:135], v[152:153] op_sel_hi:[1,0,1]
    v_pk_fma_f32 v[154:155], v[46:47], v[134:135], v[154:155] op_sel_hi:[1,0,1]
    s_waitcnt lgkmcnt(0)
    v_pk_fma_f32 v[140:141], v[48:49], v[134:135], v[140:141] op_sel:[0,1,0] op_sel_hi:[1,1,1]
    v_pk_fma_f32 v[142:143], v[50:51], v[134:135], v[142:143] op_sel:[0,1,0] op_sel_hi:[1,1,1]
    v_pk_fma_f32 v[144:145], v[52:53], v[134:135], v[144:145] op_sel:[0,1,0] op_sel_hi:[1,1,1]
    v_pk_fma_f32 v[146:147], v[54:55], v[134:135], v[146:147] op_sel:[0,1,0] op_sel_hi:[1,1,1]
    v_pk_fma_f32 v[148:149], v[56:57], v[134:135], v[148:149] op_sel:[0,1,0] op_sel_hi:[1,1,1]
    v_pk_fma_f32 v[150:151], v[58:59], v[134:135], v[150:151] op_sel:[0,1,0] op_sel_hi:[1,1,1]
    v_pk_fma_f32 v[152:153], v[60:61], v[134:135], v[152:153] op_sel:[0,1,0] op_sel_hi:[1,1,1]
    v_pk_fma_f32 v[154:155], v[62:63], v[134:135], v[154:155] op_sel:[0,1,0] op_sel_hi:[1,1,1]
    v_pk_mul_f32 v[140:141], v[140:141], v[136:137] op_sel_hi:[1,0]
    v_pk_mul_f32 v[142:143], v[142:143], v[136:137] op_sel_hi:[1,0]
    v_pk_mul_f32 v[144:145], v[144:145], v[136:137] op_sel_hi:[1,0]
    v_pk_mul_f32 v[146:147], v[146:147], v[136:137] op_sel_hi:[1,0]
    v_pk_mul_f32 v[148:149], v[148:149], v[136:137] op_sel_hi:[1,0]
    v_pk_mul_f32 v[150:151], v[150:151], v[136:137] op_sel_hi:[1,0]
    v_pk_mul_f32 v[152:153], v[152:153], v[136:137] op_sel_hi:[1,0]
    v_pk_mul_f32 v[154:155], v[154:155], v[136:137] op_sel_hi:[1,0]
    v_cvt_pk_bf16_f32 v96, v140, v141
    v_cvt_pk_bf16_f32 v97, v142, v143
    v_cvt_pk_bf16_f32 v98, v144, v145
    v_cvt_pk_bf16_f32 v99, v146, v147
    v_cvt_pk_bf16_f32 v100, v148, v149
    v_cvt_pk_bf16_f32 v101, v150, v151
    v_cvt_pk_bf16_f32 v102, v152, v153
    v_cvt_pk_bf16_f32 v103, v154, v155
    s_cmp_eq_u32 s12, 0
    s_cbranch_scc1 .sc1_a_5
    buffer_store_dwordx4 v[96:99], v186, s[28:31], s80 offen offset:0
    buffer_store_dwordx4 v[100:103], v186, s[28:31], s80 offen offset:512
.back_a_6:
    s_waitcnt vmcnt(5)
    s_mov_b32 s57, 0
.loop_a_7:
    v_cmp_ne_u32 vcc, s11, v85
    s_cbranch_vccz .ok_a_8
    s_add_u32 s57, s57, 1
    s_cmp_gt_u32 s57, 200000
    s_cbranch_scc1 .Lfail_3
    s_sleep 2
    buffer_load_dword v85, v84, s[28:31], 0 offen sc1
    s_waitcnt vmcnt(0)
    s_branch .loop_a_7
.ok_a_8:
    buffer_load_dwordx4 a[64:67], v8, s[28:31], s62 offen offset:0 sc1
    buffer_load_dwordx4 a[68:71], v9, s[28:31], s62 offen offset:1024 sc1
    buffer_load_dwordx4 a[72:75], v9, s[28:31], s62 offen offset:2048 sc1
    s_add_u32 s62, s62, 3072
    buffer_load_dwordx4 a[76:79], v8, s[28:31], s62 offen offset:0 sc1
    s_and_b32 s58, s4, 2
    s_sub_u32 s58, 1, s58
    v_lshl_add_u32 v176, s58, 6, v176
    v_lshl_add_u32 v177, s58, 7, v177
    v_lshl_add_u32 v186, s58, 12, v186
    ds_read_b128 v[32:35], v176 offset:2016
    ds_read_b128 v[36:39], v176 offset:2032
    ds_read_b128 v[40:43], v176 offset:1728
    ds_read_b128 v[44:47], v176 offset:1744
    ds_read_b128 v[48:51], v176 offset:1440
    ds_read_b128 v[52:55], v176 offset:1456
    ds_read_b128 v[56:59], v176 offset:1152
    ds_read_b128 v[60:63], v176 offset:1168
    s_waitcnt lgkmcnt(4)
    v_dot2_f32_bf16 v128, v168, v32, 0
    v_dot2_f32_bf16 v129, v168, v40, 0
    v_dot2_f32_bf16 v128, v169, v33, v128
    v_dot2_f32_bf16 v129, v169, v41, v129
    v_dot2_f32_bf16 v128, v170, v34, v128
    v_dot2_f32_bf16 v129, v170, v42, v129
    v_dot2_f32_bf16 v128, v171, v35, v128
    v_dot2_f32_bf16 v129, v171, v43, v129
    v_dot2_f32_bf16 v128, v172, v36, v128
    v_dot2_f32_bf16 v129, v172, v44, v129
    v_dot2_f32_bf16 v128, v173, v37, v128
    v_dot2_f32_bf16 v129, v173, v45, v129
    v_dot2_f32_bf16 v128, v174, v38, v128
    v_dot2_f32_bf16 v129, v174, v46, v129
    v_dot2_f32_bf16 v128, v175, v39, v128
    v_dot2_f32_bf16 v129, v175, v47, v129
    buffer_load_dwordx4 a[80:83], v9, s[28:31], s62 offen offset:1024 sc1
    ds_read_b128 v[64:67], v176 offset:864
    ds_read_b128 v[68:71], v176 offset:880
    ds_read_b128 v[112:115], v176 offset:576
    ds_read_b128 v[116:119], v176 offset:592
    s_waitcnt lgkmcnt(4)
    v_dot2_f32_bf16 v130, v168, v48, 0
    v_dot2_f32_bf16 v131, v168, v56, 0
    v_dot2_f32_bf16 v130, v169, v49, v130
    v_dot2_f32_bf16 v131, v169, v57, v131
    v_dot2_f32_bf16 v130, v170, v50, v130
    v_dot2_f32_bf16 v131, v170, v58, v131
    v_dot2_f32_bf16 v130, v171, v51, v130
    v_dot2_f32_bf16 v131, v171, v59, v131
    v_dot2_f32_bf16 v130, v172, v52, v130
    v_dot2_f32_bf16 v131, v172, v60, v131
    v_dot2_f32_bf16 v130, v173, v53, v130
    v_dot2_f32_bf16 v131, v173, v61, v131
    v_dot2_f32_bf16 v130, v174, v54, v130
    v_dot2_f32_bf16 v131, v174, v62, v131
    v_dot2_f32_bf16 v130, v175, v55, v130
    v_dot2_f32_bf16 v131, v175, v63, v131
    buffer_load_dwordx4 a[84:87], v9, s[28:31], s62 offen offset:2048 sc1
    ds_read_b128 v[32:35], v176 offset:288
    ds_read_b128 v[36:39], v176 offset:304
    ds_read_b128 v[40:43], v176 offset:0
    ds_read_b128 v[44:47], v176 offset:16
    s_waitcnt lgkmcnt(4)
    v_dot2_f32_bf16 v132, v168, v64, 0
    v_dot2_f32_bf16 v133, v168, v112, 0
    v_dot2_f32_bf16 v132, v169, v65, v132
    v_dot2_f32_bf16 v133, v169, v113, v133
    v_dot2_f32_bf16 v132, v170, v66, v132
    v_dot2_f32_bf16 v133, v170, v114, v133
    v_dot2_f32_bf16 v132, v171, v67, v132
    v_dot2_f32_bf16 v133, v171, v115, v133
    v_dot2_f32_bf16 v132, v172, v68, v132
    v_dot2_f32_bf16 v133, v172, v116, v133
    v_dot2_f32_bf16 v132, v173, v69, v132
    v_dot2_f32_bf16 v133, v173, v117, v133
    v_dot2_f32_bf16 v132, v174, v70, v132
    v_dot2_f32_bf16 v133, v174, v118, v133
    v_dot2_f32_bf16 v132, v175, v71, v132
    v_dot2_f32_bf16 v133, v175, v119, v133
    s_add_u32 s62, s62, 3072
    buffer_load_dwordx4 a[88:91], v8, s[28:31], s62 offen offset:0 sc1
    s_waitcnt lgkmcnt(0)
    v_dot2_f32_bf16 v134, v168, v32, 0
    v_dot2_f32_bf16 v135, v168, v40, 0
    v_dot2_f32_bf16 v134, v169, v33, v134
    v_dot2_f32_bf16 v135, v169, v41, v135
    v_dot2_f32_bf16 v134, v170, v34, v134
    v_dot2_f32_bf16 v135, v170, v42, v135
    v_dot2_f32_bf16 v134, v171, v35, v134
    v_dot2_f32_bf16 v135, v171, v43, v135
    v_dot2_f32_bf16 v134, v172, v36, v134
    v_dot2_f32_bf16 v135, v172, v44, v135
    v_dot2_f32_bf16 v134, v173, v37, v134
    v_dot2_f32_bf16 v135, v173, v45, v135
    v_dot2_f32_bf16 v134, v174, v38, v134
    v_dot2_f32_bf16 v135, v174, v46, v135
    v_dot2_f32_bf16 v134, v175, v39, v134
    v_dot2_f32_bf16 v135, v175, v47, v135
    buffer_load_dwordx4 a[92:95], v9, s[28:31], s62 offen offset:1024 sc1
    ds_read_b128 v[32:35], v177 offset:3808
    ds_read_b128 v[36:39], v177 offset:3824
    ds_read_b128 v[40:43], v177 offset:3840
    ds_read_b128 v[44:47], v177 offset:3856
    ds_read_b128 v[48:51], v177 offset:3264
    ds_read_b128 v[52:55], v177 offset:3280
    ds_read_b128 v[56:59], v177 offset:3296
    ds_read_b128 v[60:63], v177 offset:3312
    v_cmp_le_u32 vcc, 14, v187
    v_cndmask_b32 v129, v184, v129, s[64:65]
    v_cndmask_b32 v130, v184, v130, s[66:67]
    v_cndmask_b32 v131, v184, v131, s[68:69]
    v_cndmask_b32 v132, v184, v132, s[70:71]
    v_cndmask_b32 v133, v184, v133, s[76:77]
    v_cndmask_b32 v134, v184, v134, s[78:79]
    v_cndmask_b32 v135, v184, v135, vcc
    v_max3_f32 v136, v128, v129, v130
    v_max3_f32 v137, v131, v132, v133
    v_max3_f32 v136, v136, v134, v135
    v_max_f32 v136, v136, v137
    v_mul_f32 v136, v136, v185
    v_fma_f32 v128, v128, v185, -v136
    v_fma_f32 v129, v129, v185, -v136
    v_fma_f32 v130, v130, v185, -v136
    v_fma_f32 v131, v131, v185, -v136
    v_fma_f32 v132, v132, v185, -v136
    v_fma_f32 v133, v133, v185, -v136
    v_fma_f32 v134, v134, v185, -v136
    v_fma_f32 v135, v135, v185, -v136
    v_exp_f32 v128, v128
    v_exp_f32 v129, v129
    v_exp_f32 v130, v130
    v_exp_f32 v131, v131
    v_exp_f32 v132, v132
    v_exp_f32 v133, v133
    v_exp_f32 v134, v134
    v_exp_f32 v135, v135
    v_pk_add_f32 v[136:137], v[128:129], v[130:131]
    v_pk_add_f32 v[138:139], v[132:133], v[134:135]
    v_pk_add_f32 v[136:137], v[136:137], v[138:139]
    v_add_f32 v136, v136, v137
    v_rcp_f32 v136, v136
    buffer_load_dwordx4 a[96:99], v9, s[28:31], s62 offen offset:2048 sc1
    ds_read_b128 v[112:115], v177 offset:2720
    ds_read_b128 v[116:119], v177 offset:2736
    ds_read_b128 v[120:123], v177 offset:2752
    ds_read_b128 v[124:127], v177 offset:2768
    s_waitcnt lgkmcnt(8)
    v_pk_mul_f32 v[140:141], v[32:33], v[128:129] op_sel_hi:[1,0]
    v_pk_mul_f32 v[142:143], v[34:35], v[128:129] op_sel_hi:[1,0]
    v_pk_mul_f32 v[144:145], v[36:37], v[128:129] op_sel_hi:[1,0]
    v_pk_mul_f32 v[146:147], v[38:39], v[128:129] op_sel_hi:[1,0]
    v_pk_mul_f32 v[148:149], v[40:41], v[128:129] op_sel_hi:[1,0]
    v_pk_mul_f32 v[150:151], v[42:43], v[128:129] op_sel_hi:[1,0]
    v_pk_mul_f32 v[152:153], v[44:45], v[128:129] op_sel_hi:[1,0]
    v_pk_mul_f32 v[154:155], v[46:47], v[128:129] op_sel_hi:[1,0]
    s_add_u32 s62, s62, 3072
    buffer_load_dwordx4 a[100:103], v8, s[28:31], s62 offen offset:0 sc1
    ds_read_b128 v[32:35], v177 offset:2176
    ds_read_b128 v[36:39], v177 offset:2192
    ds_read_b128 v[40:43], v177 offset:2208
    ds_read_b128 v[44:47], v177 offset:2224
    s_waitcnt lgkmcnt(8)
    v_pk_fma_f32 v[140:141], v[48:49], v[128:129], v[140:141] op_sel:[0,1,0] op_sel_hi:[1,1,1]
    v_pk_fma_f32 v[142:143], v[50:51], v[128:129], v[142:143] op_sel:[0,1,0] op_sel_hi:[1,1,1]
    v_pk_fma_f32 v[144:145], v[52:53], v[128:129], v[144:145] op_sel:[0,1,0] op_sel_hi:[1,1,1]
    v_pk_fma_f32 v[146:147], v[54:55], v[128:129], v[146:147] op_sel:[0,1,0] op_sel_hi:[1,1,1]
    v_pk_fma_f32 v[148:149], v[56:57], v[128:129], v[148:149] op_sel:[0,1,0] op_sel_hi:[1,1,1]
    v_pk_fma_f32 v[150:151], v[58:59], v[128:129], v[150:151] op_sel:[0,1,0] op_sel_hi:[1,1,1]
    v_pk_fma_f32 v[152:153], v[60:61], v[128:129], v[152:153] op_sel:[0,1,0] op_sel_hi:[1,1,1]
    v_pk_fma_f32 v[154:155], v[62:63], v[128:129], v[154:155] op_sel:[0,1,0] op_sel_hi:[1,1,1]
    buffer_load_dwordx4 a[104:107], v9, s[28:31], s62 offen offset:1024 sc1
    ds_read_b128 v[48:51], v177 offset:1632
    ds_read_b128 v[52:55], v177 offset:1648
    ds_read_b128 v[56:59], v177 offset:1664
    ds_read_b128 v[60:63], v177 offset:1680
    s_waitcnt lgkmcnt(8)
    v_pk_fma_f32 v[140:141], v[112:113], v[130:131], v[140:141] op_sel_hi:[1,0,1]
    v_pk_fma_f32 v[142:143], v[114:115], v[130:131], v[142:143] op_sel_hi:[1,0,1]
    v_pk_fma_f32 v[144:145], v[116:117], v[130:131], v[144:145] op_sel_hi:[1,0,1]
    v_pk_fma_f32 v[146:147], v[118:119], v[130:131], v[146:147] op_sel_hi:[1,0,1]
    v_pk_fma_f32 v[148:149], v[120:121], v[130:131], v[148:149] op_sel_hi:[1,0,1]
    v_pk_fma_f32 v[150:151], v[122:123], v[130:131], v[150:151] op_sel_hi:[1,0,1]
    v_pk_fma_f32 v[152:153], v[124:125], v[130:131], v[152:153] op_sel_hi:[1,0,1]
    v_pk_fma_f32 v[154:155], v[126:127], v[130:131], v[154:155] op_sel_hi:[1,0,1]
    buffer_load_dwordx4 a[108:111], v9, s[28:31], s62 offen offset:2048 sc1
    ds_read_b128 v[112:115], v177 offset:1088
    ds_read_b128 v[116:119], v177 offset:1104
    ds_read_b128 v[120:123], v177 offset:1120
    ds_read_b128 v[124:127], v177 offset:1136
    s_waitcnt lgkmcnt(8)
    v_pk_fma_f32 v[140:141], v[32:33], v[130:131], v[140:141] op_sel:[0,1,0] op_sel_hi:[1,1,1]
    v_pk_fma_f32 v[142:143], v[34:35], v[130:131], v[142:143] op_sel:[0,1,0] op_sel_hi:[1,1,1]
    v_pk_fma_f32 v[144:145], v[36:37], v[130:131], v[144:145] op_sel:[0,1,0] op_sel_hi:[1,1,1]
    v_pk_fma_f32 v[146:147], v[38:39], v[130:131], v[146:147] op_sel:[0,1,0] op_sel_hi:[1,1,1]
    v_pk_fma_f32 v[148:149], v[40:41], v[130:131], v[148:149] op_sel:[0,1,0] op_sel_hi:[1,1,1]
    v_pk_fma_f32 v[150:151], v[42:43], v[130:131], v[150:151] op_sel:[0,1,0] op_sel_hi:[1,1,1]
    v_pk_fma_f32 v[152:153], v[44:45], v[130:131], v[152:153] op_sel:[0,1,0] op_sel_hi:[1,1,1]
    v_pk_fma_f32 v[154:155], v[46:47], v[130:131], v[154:155] op_sel:[0,1,0] op_sel_hi:[1,1,1]
    s_add_u32 s62, s62, 3072
    s_cmp_eq_u32 s62, s83
    s_cselect_b32 s62, s56, s62
    buffer_load_dwordx4 a[112:115], v8, s[28:31], s62 offen offset:0 sc1
    ds_read_b128 v[32:35], v177 offset:544
    ds_read_b128 v[36:39], v177 offset:560
    ds_read_b128 v[40:43], v177 offset:576
    ds_read_b128 v[44:47], v177 offset:592
    s_waitcnt lgkmcnt(8)
    v_pk_fma_f32 v[140:141], v[48:49], v[132:133], v[140:141] op_sel_hi:[1,0,1]
    v_pk_fma_f32 v[142:143], v[50:51], v[132:133], v[142:143] op_sel_hi:[1,0,1]
    v_pk_fma_f32 v[144:145], v[52:53], v[132:133], v[144:145] op_sel_hi:[1,0,1]
    v_pk_fma_f32 v[146:147], v[54:55], v[132:133], v[146:147] op_sel_hi:[1,0,1]
    v_pk_fma_f32 v[148:149], v[56:57], v[132:133], v[148:149] op_sel_hi:[1,0,1]
    v_pk_fma_f32 v[150:151], v[58:59], v[132:133], v[150:151] op_sel_hi:[1,0,1]
    v_pk_fma_f32 v[152:153], v[60:61], v[132:133], v[152:153] op_sel_hi:[1,0,1]
    v_pk_fma_f32 v[154:155], v[62:63], v[132:133], v[154:155] op_sel_hi:[1,0,1]
    buffer_load_dwordx4 a[116:119], v9, s[28:31], s62 offen offset:1024 sc1
    ds_read_b128 v[48:51], v177 offset:0
    ds_read_b128 v[52:55], v177 offset:16
    ds_read_b128 v[56:59], v177 offset:32
    ds_read_b128 v[60:63], v177 offset:48
    s_waitcnt lgkmcnt(8)
    v_pk_fma_f32 v[140:141], v[112:113], v[132:133], v[140:141] op_sel:[0,1,0] op_sel_hi:[1,1,1]
    v_pk_fma_f32 v[142:143], v[114:115], v[132:133], v[142:143] op_sel:[0,1,0] op_sel_hi:[1,1,1]
    v_pk_fma_f32 v[144:145], v[116:117], v[132:133], v[144:145] op_sel:[0,1,0] op_sel_hi:[1,1,1]
    v_pk_fma_f32 v[146:147], v[118:119], v[132:133], v[146:147] op_sel:[0,1,0] op_sel_hi:[1,1,1]
    v_pk_fma_f32 v[148:149], v[120:121], v[132:133], v[148:149] op_sel:[0,1,0] op_sel_hi:[1,1,1]
    v_pk_fma_f32 v[150:151], v[122:123], v[132:133], v[150:151] op_sel:[0,1,0] op_sel_hi:[1,1,1]
    v_pk_fma_f32 v[152:153], v[124:125], v[132:133], v[152:153] op_sel:[0,1,0] op_sel_hi:[1,1,1]
    v_pk_fma_f32 v[154:155], v[126:127], v[132:133], v[154:155] op_sel:[0,1,0] op_sel_hi:[1,1,1]
    buffer_load_dwordx4 a[120:123], v9, s[28:31], s62 offen offset:2048 sc1
    s_waitcnt lgkmcnt(4)
    v_pk_fma_f32 v[140:141], v[32:33], v[134:135], v[140:141] op_sel_hi:[1,0,1]
    v_pk_fma_f32 v[142:143], v[34:35], v[134:135], v[142:143] op_sel_hi:[1,0,1]
    v_pk_fma_f32 v[144:145], v[36:37], v[134:135], v[144:145] op_sel_hi:[1,0,1]
    v_pk_fma_f32 v[146:147], v[38:39], v[134:135], v[146:147] op_sel_hi:[1,0,1]
    v_pk_fma_f32 v[148:149], v[40:41], v[134:135], v[148:149] op_sel_hi:[1,0,1]
    v_pk_fma_f32 v[150:151], v[42:43], v[134:135], v[150:151] op_sel_hi:[1,0,1]
    v_pk_fma_f32 v[152:153], v[44:45], v[134:135], v[152:153] op_sel_hi:[1,0,1]
    v_pk_fma_f32 v[154:155], v[46:47], v[134:135], v[154:155] op_sel_hi:[1,0,1]
    s_add_u32 s62, s62, 3072
    buffer_load_dwordx4 a[124:127], v8, s[28:31], s62 offen offset:0 sc1
    s_waitcnt lgkmcnt(0)
    v_pk_fma_f32 v[140:141], v[48:49], v[134:135], v[140:141] op_sel:[0,1,0] op_sel_hi:[1,1,1]
    v_pk_fma_f32 v[142:143], v[50:51], v[134:135], v[142:143] op_sel:[0,1,0] op_sel_hi:[1,1,1]
    v_pk_fma_f32 v[144:145], v[52:53], v[134:135], v[144:145] op_sel:[0,1,0] op_sel_hi:[1,1,1]
    v_pk_fma_f32 v[146:147], v[54:55], v[134:135], v[146:147] op_sel:[0,1,0] op_sel_hi:[1,1,1]
    v_pk_fma_f32 v[148:149], v[56:57], v[134:135], v[148:149] op_sel:[0,1,0] op_sel_hi:[1,1,1]
    v_pk_fma_f32 v[150:151], v[58:59], v[134:135], v[150:151] op_sel:[0,1,0] op_sel_hi:[1,1,1]
    v_pk_fma_f32 v[152:153], v[60:61], v[134:135], v[152:153] op_sel:[0,1,0] op_sel_hi:[1,1,1]
    v_pk_fma_f32 v[154:155], v[62:63], v[134:135], v[154:155] op_sel:[0,1,0] op_sel_hi:[1,1,1]
    v_pk_mul_f32 v[140:141], v[140:141], v[136:137] op_sel_hi:[1,0]
    v_pk_mul_f32 v[142:143], v[142:143], v[136:137] op_sel_hi:[1,0]
    v_pk_mul_f32 v[144:145], v[144:145], v[136:137] op_sel_hi:[1,0]
    v_pk_mul_f32 v[146:147], v[146:147], v[136:137] op_sel_hi:[1,0]
    v_pk_mul_f32 v[148:149], v[148:149], v[136:137] op_sel_hi:[1,0]
    v_pk_mul_f32 v[150:151], v[150:151], v[136:137] op_sel_hi:[1,0]
    v_pk_mul_f32 v[152:153], v[152:153], v[136:137] op_sel_hi:[1,0]
    v_pk_mul_f32 v[154:155], v[154:155], v[136:137] op_sel_hi:[1,0]
    v_cvt_pk_bf16_f32 v104, v140, v141
    v_cvt_pk_bf16_f32 v105, v142, v143
    v_cvt_pk_bf16_f32 v106, v144, v145
    v_cvt_pk_bf16_f32 v107, v146, v147
    v_cvt_pk_bf16_f32 v108, v148, v149
    v_cvt_pk_bf16_f32 v109, v150, v151
    v_cvt_pk_bf16_f32 v110, v152, v153
    v_cvt_pk_bf16_f32 v111, v154, v155
    s_cmp_eq_u32 s12, 0
    s_cbranch_scc1 .sc1_a_9
    buffer_store_dwordx4 v[104:107], v186, s[28:31], s80 offen offset:0
    buffer_store_dwordx4 v[108:111], v186, s[28:31], s80 offen offset:512
.back_a_10:
    v_lshrrev_b32 v2, 4, v1
    v_bfe_u32 v3, v1, 2, 2
    v_lshrrev_b32 v16, 1, v2
    v_lshl_add_u32 v16, v16, 3, v3
    v_lshlrev_b32 v16, 7, v16
    v_lshrrev_b32 v3, 1, v3
    v_lshl_add_u32 v16, v3, 6, v16
    v_and_b32 v2, 1, v2
    v_lshl_add_u32 v16, v2, 5, v16
    v_and_b32 v2, 3, v1
    v_lshl_add_u32 v16, v2, 3, v16
    v_add_u32 v16, s54, v16
    v_xor_b32 v17, 64, v16
    s_mul_i32 s55, s4, 40960
    s_lshl_b32 s53, s10, 7
    s_mul_i32 s58, s4, 180224
    s_add_u32 s53, s53, s58
    s_waitcnt vmcnt(17)
    v_mfma_f32_32x32x16_bf16 v[96:111], a[64:67], a[128:131], 0
    buffer_load_dwordx4 v[40:43], v9, s[28:31], s62 offen offset:1024 sc1
    v_mfma_f32_32x32x16_bf16 v[112:127], a[64:67], a[160:163], 0
    s_waitcnt vmcnt(17)
    v_mfma_f32_32x32x16_bf16 v[128:143], a[68:71], a[128:131], 0
    buffer_load_dwordx4 v[44:47], v9, s[28:31], s62 offen offset:2048 sc1
    v_mfma_f32_32x32x16_bf16 v[144:159], a[68:71], a[160:163], 0
    s_waitcnt vmcnt(17)
    v_mfma_f32_32x32x16_bf16 v[160:175], a[72:75], a[128:131], 0
    s_add_u32 s62, s62, 3072
    buffer_load_dwordx4 v[48:51], v8, s[28:31], s62 offen offset:0 sc1
    v_mfma_f32_32x32x16_bf16 v[176:191], a[72:75], a[160:163], 0
    s_waitcnt vmcnt(17)
    v_mfma_f32_32x32x16_bf16 v[96:111], a[76:79], a[132:135], v[96:111]
    buffer_load_dwordx4 v[52:55], v9, s[28:31], s62 offen offset:1024 sc1
    v_mfma_f32_32x32x16_bf16 v[112:127], a[76:79], a[164:167], v[112:127]
    s_waitcnt vmcnt(17)
    v_mfma_f32_32x32x16_bf16 v[128:143], a[80:83], a[132:135], v[128:143]
    buffer_load_dwordx4 v[56:59], v9, s[28:31], s62 offen offset:2048 sc1
    v_mfma_f32_32x32x16_bf16 v[144:159], a[80:83], a[164:167], v[144:159]
    s_waitcnt vmcnt(17)
    v_mfma_f32_32x32x16_bf16 v[160:175], a[84:87], a[132:135], v[160:175]
    s_add_u32 s62, s62, 3072
    buffer_load_dwordx4 v[60:63], v8, s[28:31], s62 offen offset:0 sc1
    v_mfma_f32_32x32x16_bf16 v[176:191], a[84:87], a[164:167], v[176:191]
    s_lshl_b32 s58, s9, 1
    s_and_b32 s59, s4, 1
    s_add_u32 s58, s58, s59
    s_mul_i32 s65, s58, 49152
    s_mul_i32 s60, s10, 6
    s_add_u32 s60, s60, 1
    s_cmp_eq_u32 s10, 7
    s_cselect_b32 s60, 0, s60
    s_lshr_b32 s59, s4, 1
    s_add_u32 s64, s60, s59
    s_lshl_b32 s60, s64, 10
    s_add_u32 s65, s65, s60
    s_add_u32 s65, s65, 4194304
    v_and_b32 v2, 31, v1
    s_lshl_b32 s58, s58, 5
    v_add_lshl_u32 v2, v2, s58, 1
    buffer_load_ushort v29, v2, s[44:47], 0 offen
    s_waitcnt vmcnt(18)
    v_mfma_f32_32x32x16_bf16 v[96:111], a[88:91], a[136:139], v[96:111]
    v_mfma_f32_32x32x16_bf16 v[112:127], a[88:91], a[168:171], v[112:127]
    buffer_load_dwordx4 v[64:67], v9, s[28:31], s62 offen offset:1024 sc1
    s_waitcnt vmcnt(18)
    v_mfma_f32_32x32x16_bf16 v[128:143], a[92:95], a[136:139], v[128:143]
    v_mfma_f32_32x32x16_bf16 v[144:159], a[92:95], a[168:171], v[144:159]
    buffer_load_dwordx4 v[68:71], v9, s[28:31], s62 offen offset:2048 sc1
    s_waitcnt vmcnt(18)
    v_mfma_f32_32x32x16_bf16 v[160:175], a[96:99], a[136:139], v[160:175]
    v_mfma_f32_32x32x16_bf16 v[176:191], a[96:99], a[168:171], v[176:191]
    s_add_u32 s62, s62, 3072
    s_cmp_eq_u32 s62, s83
    s_cselect_b32 s62, s56, s62
    buffer_load_dwordx4 a[64:67], v8, s[28:31], s62 offen offset:0 sc1
    v_lshrrev_b32 v2, 3, v0
    v_and_b32 v3, 7, v0
    v_lshlrev_b32 v30, 10, v2
    v_lshl_add_u32 v30, v3, 4, v30
    s_lshl_b32 s58, s9, 16
    s_lshl_b32 s59, s10, 7
    s_add_u32 s58, s58, s59
    v_add_u32 v30, s58, v30
    v_add_u32 v31, 32768, v30
    s_lshl_b32 s58, s9, 2
    s_add_u32 s58, s58, s4
    s_lshl_b32 s58, s58, 14
    s_add_u32 s67, s58, 7340032
    s_waitcnt vmcnt(18)
    v_mfma_f32_32x32x16_bf16 v[96:111], a[100:103], a[140:143], v[96:111]
    buffer_load_dwordx4 a[68:71], v9, s[28:31], s62 offen offset:1024 sc1
    v_mfma_f32_32x32x16_bf16 v[112:127], a[100:103], a[172:175], v[112:127]
    s_waitcnt vmcnt(18)
    v_mfma_f32_32x32x16_bf16 v[128:143], a[104:107], a[140:143], v[128:143]
    buffer_load_dwordx4 a[72:75], v9, s[28:31], s62 offen offset:2048 sc1
    v_mfma_f32_32x32x16_bf16 v[144:159], a[104:107], a[172:175], v[144:159]
    s_waitcnt vmcnt(18)
    v_mfma_f32_32x32x16_bf16 v[160:175], a[108:111], a[140:143], v[160:175]
    s_add_u32 s62, s62, 3072
    buffer_load_dwordx4 a[76:79], v8, s[28:31], s62 offen offset:0 sc1
    v_mfma_f32_32x32x16_bf16 v[176:191], a[108:111], a[172:175], v[176:191]
    s_mov_b32 s68, s65
    s_add_u32 s69, s68, 2048
    s_add_u32 s70, s68, 4096
    s_cmp_eq_u32 s10, 7
    s_cselect_b32 s69, 2147418112, s69
    s_cselect_b32 s70, 2147418112, s70
    s_cselect_b32 s59, s4, 0
    s_cmp_ge_u32 s59, 2
    s_cselect_b32 s68, 2147418112, s68
    s_waitcnt vmcnt(18)
    v_mfma_f32_32x32x16_bf16 v[96:111], a[112:115], a[144:147], v[96:111]
    buffer_load_dwordx4 a[80:83], v9, s[28:31], s62 offen offset:1024 sc1
    v_mfma_f32_32x32x16_bf16 v[112:127], a[112:115], a[176:179], v[112:127]
    s_waitcnt vmcnt(18)
    v_mfma_f32_32x32x16_bf16 v[128:143], a[116:119], a[144:147], v[128:143]
    buffer_load_dwordx4 a[84:87], v9, s[28:31], s62 offen offset:2048 sc1
    v_mfma_f32_32x32x16_bf16 v[144:159], a[116:119], a[176:179], v[144:159]
    s_waitcnt vmcnt(18)
    v_mfma_f32_32x32x16_bf16 v[160:175], a[120:123], a[144:147], v[160:175]
    s_add_u32 s62, s62, 3072
    buffer_load_dwordx4 a[88:91], v8, s[28:31], s62 offen offset:0 sc1
    v_mfma_f32_32x32x16_bf16 v[176:191], a[120:123], a[176:179], v[176:191]
    s_lshl_b32 s71, s9, 7
    s_add_u32 s71, s71, 262144
    s_lshl_b32 s66, s10, 2
    s_add_u32 s66, s66, s4
    s_lshl_b32 s66, s66, 2
    s_add_u32 s66, s66, s71
    s_mul_i32 s72, s9, 96
    s_mul_i32 s59, s4, 11
    s_add_u32 s72, s72, s59
    s_lshl_b32 s72, s72, 10
    s_add_u32 s72, s72, 4194304
    s_add_u32 s75, s72, 49152
    s_waitcnt vmcnt(18)
    v_mfma_f32_32x32x16_bf16 v[96:111], a[124:127], a[148:151], v[96:111]
    buffer_load_dwordx4 a[92:95], v9, s[28:31], s62 offen offset:1024 sc1
    v_mfma_f32_32x32x16_bf16 v[112:127], a[124:127], a[180:183], v[112:127]
    s_waitcnt vmcnt(16)
    v_mfma_f32_32x32x16_bf16 v[128:143], v[40:43], a[148:151], v[128:143]
    buffer_load_dwordx4 a[96:99], v9, s[28:31], s62 offen offset:2048 sc1
    v_mfma_f32_32x32x16_bf16 v[144:159], v[40:43], a[180:183], v[144:159]
    s_waitcnt vmcnt(16)
    v_mfma_f32_32x32x16_bf16 v[160:175], v[44:47], a[148:151], v[160:175]
    s_add_u32 s62, s62, 3072
    buffer_load_dwordx4 a[100:103], v8, s[28:31], s62 offen offset:0 sc1
    v_mfma_f32_32x32x16_bf16 v[176:191], v[44:47], a[180:183], v[176:191]
    v_mov_b32 v2, s11
    v_mov_b32 v3, 0
    v_not_b32 v36, v2
    s_mov_b64 exec, 1
    s_cmp_eq_u32 s12, 0
    s_cbranch_scc1 .sc1_a_11
    buffer_store_dword v2, v3, s[28:31], s63 offen
    buffer_store_dword v36, v3, s[28:31], s66 offen
.back_a_12:
    s_mov_b64 exec, -1
    s_waitcnt vmcnt(18)
    v_mfma_f32_32x32x16_bf16 v[96:111], v[48:51], a[152:155], v[96:111]
    v_mfma_f32_32x32x16_bf16 v[112:127], v[48:51], a[184:187], v[112:127]
    buffer_load_dwordx4 a[104:107], v9, s[28:31], s62 offen offset:1024 sc1
    s_waitcnt vmcnt(18)
    v_mfma_f32_32x32x16_bf16 v[128:143], v[52:55], a[152:155], v[128:143]
    v_mfma_f32_32x32x16_bf16 v[144:159], v[52:55], a[184:187], v[144:159]
    buffer_load_dwordx4 a[108:111], v9, s[28:31], s62 offen offset:2048 sc1
    s_waitcnt vmcnt(18)
    v_mfma_f32_32x32x16_bf16 v[160:175], v[56:59], a[152:155], v[160:175]
    v_mfma_f32_32x32x16_bf16 v[176:191], v[56:59], a[184:187], v[176:191]
    s_add_u32 s62, s62, 3072
    s_cmp_eq_u32 s62, s83
    s_cselect_b32 s62, s56, s62
    buffer_load_dwordx4 a[112:115], v8, s[28:31], s62 offen offset:0 sc1
    s_waitcnt vmcnt(18)
    v_mfma_f32_32x32x16_bf16 v[96:111], v[60:63], a[156:159], v[96:111]
    v_mfma_f32_32x32x16_bf16 v[112:127], v[60:63], a[188:191], v[112:127]
    buffer_load_dwordx4 a[116:119], v9, s[28:31], s62 offen offset:1024 sc1
    s_waitcnt vmcnt(17)
    v_mfma_f32_32x32x16_bf16 v[128:143], v[64:67], a[156:159], v[128:143]
    v_mfma_f32_32x32x16_bf16 v[144:159], v[64:67], a[188:191], v[144:159]
    buffer_load_dwordx4 a[120:123], v9, s[28:31], s62 offen offset:2048 sc1
    s_waitcnt vmcnt(17)
    v_mfma_f32_32x32x16_bf16 v[160:175], v[68:71], a[156:159], v[160:175]
    v_mfma_f32_32x32x16_bf16 v[176:191], v[68:71], a[188:191], v[176:191]
    s_add_u32 s62, s62, 3072
    buffer_load_dwordx4 a[124:127], v8, s[28:31], s62 offen offset:0 sc1
    s_waitcnt vmcnt(17)
    v_mfma_f32_32x32x16_bf16 v[96:111], a[64:67], a[192:195], v[96:111]
    ds_read_b64_tr_b16 a[128:129], v16 offset:0
    ds_read_b64_tr_b16 a[130:131], v16 offset:512
    v_mfma_f32_32x32x16_bf16 v[112:127], a[64:67], a[224:227], v[112:127]
    buffer_load_dwordx4 v[40:43], v9, s[28:31], s62 offen offset:1024 sc1
    ds_read_b64_tr_b16 a[132:133], v17 offset:0
    ds_read_b64_tr_b16 a[134:135], v17 offset:512
    s_waitcnt vmcnt(17)
    v_mfma_f32_32x32x16_bf16 v[128:143], a[68:71], a[192:195], v[128:143]
    ds_read_b64_tr_b16 a[136:137], v16 offset:2048
    ds_read_b64_tr_b16 a[138:139], v16 offset:2560
    v_mfma_f32_32x32x16_bf16 v[144:159], a[68:71], a[224:227], v[144:159]
    buffer_load_dwordx4 v[44:47], v9, s[28:31], s62 offen offset:2048 sc1
    ds_read_b64_tr_b16 a[140:141], v17 offset:2048
    ds_read_b64_tr_b16 a[142:143], v17 offset:2560
    s_waitcnt vmcnt(17)
    v_mfma_f32_32x32x16_bf16 v[160:175], a[72:75], a[192:195], v[160:175]
    ds_read_b64_tr_b16 a[144:145], v16 offset:4096
    ds_read_b64_tr_b16 a[146:147], v16 offset:4608
    v_mfma_f32_32x32x16_bf16 v[176:191], a[72:75], a[224:227], v[176:191]
    s_add_u32 s62, s62, 3072
    buffer_load_dwordx4 v[48:51], v8, s[28:31], s62 offen offset:0 sc1
    ds_read_b64_tr_b16 a[148:149], v17 offset:4096
    ds_read_b64_tr_b16 a[150:151], v17 offset:4608
    s_waitcnt vmcnt(17)
    v_mfma_f32_32x32x16_bf16 v[96:111], a[76:79], a[196:199], v[96:111]
    ds_read_b64_tr_b16 a[152:153], v16 offset:6144
    ds_read_b64_tr_b16 a[154:155], v16 offset:6656
    v_mfma_f32_32x32x16_bf16 v[112:127], a[76:79], a[228:231], v[112:127]
    buffer_load_dwordx4 v[52:55], v9, s[28:31], s62 offen offset:1024 sc1
    ds_read_b64_tr_b16 a[156:157], v17 offset:6144
    ds_read_b64_tr_b16 a[158:159], v17 offset:6656
    s_waitcnt vmcnt(17)
    v_mfma_f32_32x32x16_bf16 v[128:143], a[80:83], a[196:199], v[128:143]
    ds_read_b64_tr_b16 a[160:161], v16 offset:8192
    ds_read_b64_tr_b16 a[162:163], v16 offset:8704
    v_mfma_f32_32x32x16_bf16 v[144:159], a[80:83], a[228:231], v[144:159]
    buffer_load_dwordx4 v[56:59], v9, s[28:31], s62 offen offset:2048 sc1
    ds_read_b64_tr_b16 a[164:165], v17 offset:8192
    ds_read_b64_tr_b16 a[166:167], v17 offset:8704
    s_waitcnt vmcnt(17)
    v_mfma_f32_32x32x16_bf16 v[160:175], a[84:87], a[196:199], v[160:175]
    ds_read_b64_tr_b16 a[168:169], v16 offset:10240
    ds_read_b64_tr_b16 a[170:171], v16 offset:10752
    v_mfma_f32_32x32x16_bf16 v[176:191], a[84:87], a[228:231], v[176:191]
    s_add_u32 s62, s62, 3072
    buffer_load_dwordx4 v[60:63], v8, s[28:31], s62 offen offset:0 sc1
    ds_read_b64_tr_b16 a[172:173], v17 offset:10240
    ds_read_b64_tr_b16 a[174:175], v17 offset:10752
    s_waitcnt vmcnt(17)
    v_mfma_f32_32x32x16_bf16 v[96:111], a[88:91], a[200:203], v[96:111]
    ds_read_b64_tr_b16 a[176:177], v16 offset:12288
    ds_read_b64_tr_b16 a[178:179], v16 offset:12800
    v_mfma_f32_32x32x16_bf16 v[112:127], a[88:91], a[232:235], v[112:127]
    buffer_load_dwordx4 v[64:67], v9, s[28:31], s62 offen offset:1024 sc1
    ds_read_b64_tr_b16 a[180:181], v17 offset:12288
    ds_read_b64_tr_b16 a[182:183], v17 offset:12800
    s_waitcnt vmcnt(17)
    v_mfma_f32_32x32x16_bf16 v[128:143], a[92:95], a[200:203], v[128:143]
    ds_read_b64_tr_b16 a[184:185], v16 offset:14336
    ds_read_b64_tr_b16 a[186:187], v16 offset:14848
    v_mfma_f32_32x32x16_bf16 v[144:159], a[92:95], a[232:235], v[144:159]
    buffer_load_dwordx4 v[68:71], v9, s[28:31], s62 offen offset:2048 sc1
    ds_read_b64_tr_b16 a[188:189], v17 offset:14336
    ds_read_b64_tr_b16 a[190:191], v17 offset:14848
    s_waitcnt vmcnt(17)
    v_mfma_f32_32x32x16_bf16 v[160:175], a[96:99], a[200:203], v[160:175]
    v_mfma_f32_32x32x16_bf16 v[176:191], a[96:99], a[232:235], v[176:191]
    s_add_u32 s62, s62, 3072
    s_cmp_eq_u32 s62, s83
    s_cselect_b32 s62, s56, s62
    buffer_load_dwordx4 a[64:67], v8, s[28:31], s62 offen offset:0 sc1
    s_waitcnt vmcnt(17)
    v_mfma_f32_32x32x16_bf16 v[96:111], a[100:103], a[204:207], v[96:111]
    v_mfma_f32_32x32x16_bf16 v[112:127], a[100:103], a[236:239], v[112:127]
    buffer_load_dwordx4 a[68:71], v9, s[28:31], s62 offen offset:1024 sc1
    s_waitcnt vmcnt(15)
    v_mfma_f32_32x32x16_bf16 v[128:143], a[104:107], a[204:207], v[128:143]
    v_mfma_f32_32x32x16_bf16 v[144:159], a[104:107], a[236:239], v[144:159]
    buffer_load_dwordx4 a[72:75], v9, s[28:31], s62 offen offset:2048 sc1
    s_waitcnt vmcnt(15)
    v_mfma_f32_32x32x16_bf16 v[160:175], a[108:111], a[204:207], v[160:175]
    v_mfma_f32_32x32x16_bf16 v[176:191], a[108:111], a[236:239], v[176:191]
    s_add_u32 s62, s62, 3072
    buffer_load_dwordx4 a[76:79], v8, s[28:31], s62 offen offset:0 sc1
    s_waitcnt vmcnt(15)
    v_mfma_f32_32x32x16_bf16 v[96:111], a[112:115], a[208:211], v[96:111]
    v_mfma_f32_32x32x16_bf16 v[112:127], a[112:115], a[240:243], v[112:127]
    buffer_load_dwordx4 a[80:83], v9, s[28:31], s62 offen offset:1024 sc1
    s_waitcnt vmcnt(15)
    v_mfma_f32_32x32x16_bf16 v[128:143], a[116:119], a[208:211], v[128:143]
    v_mfma_f32_32x32x16_bf16 v[144:159], a[116:119], a[240:243], v[144:159]
    buffer_load_dwordx4 a[84:87], v9, s[28:31], s62 offen offset:2048 sc1
    s_waitcnt vmcnt(15)
    v_mfma_f32_32x32x16_bf16 v[160:175], a[120:123], a[208:211], v[160:175]
    v_mfma_f32_32x32x16_bf16 v[176:191], a[120:123], a[240:243], v[176:191]
    s_add_u32 s62, s62, 3072
    buffer_load_dwordx4 a[88:91], v8, s[28:31], s62 offen offset:0 sc1
    s_waitcnt vmcnt(15)
    v_mfma_f32_32x32x16_bf16 v[96:111], a[124:127], a[212:215], v[96:111]
    v_mfma_f32_32x32x16_bf16 v[112:127], a[124:127], a[244:247], v[112:127]
    buffer_load_dwordx4 a[92:95], v9, s[28:31], s62 offen offset:1024 sc1
    s_waitcnt vmcnt(15)
    v_mfma_f32_32x32x16_bf16 v[128:143], v[40:43], a[212:215], v[128:143]
    v_mfma_f32_32x32x16_bf16 v[144:159], v[40:43], a[244:247], v[144:159]
    buffer_load_dwordx4 a[96:99], v9, s[28:31], s62 offen offset:2048 sc1
    s_waitcnt vmcnt(15)
    v_mfma_f32_32x32x16_bf16 v[160:175], v[44:47], a[212:215], v[160:175]
    v_mfma_f32_32x32x16_bf16 v[176:191], v[44:47], a[244:247], v[176:191]
    s_add_u32 s62, s62, 3072
    buffer_load_dwordx4 a[100:103], v8, s[28:31], s62 offen offset:0 sc1
    s_waitcnt vmcnt(15)
    v_mfma_f32_32x32x16_bf16 v[96:111], v[48:51], a[216:219], v[96:111]
    v_mfma_f32_32x32x16_bf16 v[112:127], v[48:51], a[248:251], v[112:127]
    buffer_load_dwordx4 a[104:107], v9, s[28:31], s62 offen offset:1024 sc1
    s_waitcnt vmcnt(15)
    v_mfma_f32_32x32x16_bf16 v[128:143], v[52:55], a[216:219], v[128:143]
    v_mfma_f32_32x32x16_bf16 v[144:159], v[52:55], a[248:251], v[144:159]
    buffer_load_dwordx4 a[108:111], v9, s[28:31], s62 offen offset:2048 sc1
    s_waitcnt vmcnt(15)
    v_mfma_f32_32x32x16_bf16 v[160:175], v[56:59], a[216:219], v[160:175]
    v_mfma_f32_32x32x16_bf16 v[176:191], v[56:59], a[248:251], v[176:191]
    s_add_u32 s62, s62, 3072
    s_cmp_eq_u32 s62, s83
    s_cselect_b32 s62, s56, s62
    buffer_load_dwordx4 a[112:115], v8, s[28:31], s62 offen offset:0 sc1
    s_lshl_b32 s58, s2, 2
    s_add_u32 s58, s58, s4
    s_cmp_lg_u32 s58, 1023
    s_cbranch_scc1 .nf_a_13
    v_add_u32 v2, 4096, v28
    buffer_load_dwordx4 v[32:35], v2, s[28:31], 0 offen offset:0 sc1
    buffer_load_dwordx4 v[36:39], v2, s[28:31], 0 offen offset:1024 sc1
    s_waitcnt vmcnt(0)
    v_xor_b32 v33, s11, v32
    v_xor_b32 v35, s11, v34
    v_or_b32 v33, v33, v35
    v_xor_b32 v35, s11, v36
    v_or_b32 v33, v33, v35
    v_xor_b32 v35, s11, v38
    v_or_b32 v33, v33, v35
    v_cmp_ne_u32 vcc, 0, v33
    s_cbranch_vccnz .slow_a_14
.back_a_15:
    v_mov_b32 v2, s11
    v_mov_b32 v3, 0
    s_mov_b64 exec, 1
    buffer_store_dword v2, v3, s[28:31], 0 offen sc1
    s_mov_b64 exec, -1
.nf_a_13:
    s_waitcnt vmcnt(15)
    v_mfma_f32_32x32x16_bf16 v[96:111], v[60:63], a[220:223], v[96:111]
    buffer_load_dwordx4 a[116:119], v9, s[28:31], s62 offen offset:1024 sc1
    v_mfma_f32_32x32x16_bf16 v[112:127], v[60:63], a[252:255], v[112:127]
    s_waitcnt vmcnt(15)
    v_mfma_f32_32x32x16_bf16 v[128:143], v[64:67], a[220:223], v[128:143]
    buffer_load_dwordx4 a[120:123], v9, s[28:31], s62 offen offset:2048 sc1
    v_mfma_f32_32x32x16_bf16 v[144:159], v[64:67], a[252:255], v[144:159]
    s_waitcnt vmcnt(15)
    v_mfma_f32_32x32x16_bf16 v[160:175], v[68:71], a[220:223], v[160:175]
    s_add_u32 s62, s62, 3072
    buffer_load_dwordx4 a[124:127], v8, s[28:31], s62 offen offset:0 sc1
    v_mfma_f32_32x32x16_bf16 v[176:191], v[68:71], a[252:255], v[176:191]
    s_waitcnt vmcnt(15)
    v_mfma_f32_32x32x16_bf16 v[96:111], a[64:67], v[192:195], v[96:111]
    buffer_load_dwordx4 v[40:43], v9, s[28:31], s62 offen offset:1024 sc1
    v_mfma_f32_32x32x16_bf16 v[112:127], a[64:67], v[224:227], v[112:127]
    s_waitcnt vmcnt(15)
    v_mfma_f32_32x32x16_bf16 v[128:143], a[68:71], v[192:195], v[128:143]
    buffer_load_dwordx4 v[44:47], v9, s[28:31], s62 offen offset:2048 sc1
    v_mfma_f32_32x32x16_bf16 v[144:159], a[68:71], v[224:227], v[144:159]
    s_waitcnt vmcnt(15)
    v_mfma_f32_32x32x16_bf16 v[160:175], a[72:75], v[192:195], v[160:175]
    s_add_u32 s62, s62, 3072
    buffer_load_dwordx4 v[48:51], v8, s[28:31], s62 offen offset:0 sc1
    v_mfma_f32_32x32x16_bf16 v[176:191], a[72:75], v[224:227], v[176:191]
    s_waitcnt vmcnt(15)
    v_mfma_f32_32x32x16_bf16 v[96:111], a[76:79], v[196:199], v[96:111]
    buffer_load_dwordx4 v[52:55], v9, s[28:31], s62 offen offset:1024 sc1
    v_mfma_f32_32x32x16_bf16 v[112:127], a[76:79], v[228:231], v[112:127]
    s_waitcnt vmcnt(15)
    v_mfma_f32_32x32x16_bf16 v[128:143], a[80:83], v[196:199], v[128:143]
    buffer_load_dwordx4 v[56:59], v9, s[28:31], s62 offen offset:2048 sc1
    v_mfma_f32_32x32x16_bf16 v[144:159], a[80:83], v[228:231], v[144:159]
    s_waitcnt vmcnt(15)
    v_mfma_f32_32x32x16_bf16 v[160:175], a[84:87], v[196:199], v[160:175]
    s_add_u32 s62, s62, 3072
    buffer_load_dwordx4 v[60:63], v8, s[28:31], s62 offen offset:0 sc1
    v_mfma_f32_32x32x16_bf16 v[176:191], a[84:87], v[228:231], v[176:191]
    s_waitcnt vmcnt(15)
    v_mfma_f32_32x32x16_bf16 v[96:111], a[88:91], v[200:203], v[96:111]
    buffer_load_dwordx4 v[64:67], v9, s[28:31], s62 offen offset:1024 sc1
    v_mfma_f32_32x32x16_bf16 v[112:127], a[88:91], v[232:235], v[112:127]
    s_waitcnt vmcnt(15)
    v_mfma_f32_32x32x16_bf16 v[128:143], a[92:95], v[200:203], v[128:143]
    buffer_load_dwordx4 v[68:71], v9, s[28:31], s62 offen offset:2048 sc1
    v_mfma_f32_32x32x16_bf16 v[144:159], a[92:95], v[232:235], v[144:159]
    s_waitcnt vmcnt(15)
    v_mfma_f32_32x32x16_bf16 v[160:175], a[96:99], v[200:203], v[160:175]
    s_add_u32 s62, s62, 3072
    s_cmp_eq_u32 s62, s83
    s_cselect_b32 s62, s56, s62
    buffer_load_dwordx4 a[64:67], v8, s[28:31], s62 offen offset:0 sc1
    v_mfma_f32_32x32x16_bf16 v[176:191], a[96:99], v[232:235], v[176:191]
    s_waitcnt vmcnt(15)
    v_mfma_f32_32x32x16_bf16 v[96:111], a[100:103], v[204:207], v[96:111]
    buffer_load_dwordx4 a[68:71], v9, s[28:31], s62 offen offset:1024 sc1
    v_mfma_f32_32x32x16_bf16 v[112:127], a[100:103], v[236:239], v[112:127]
    s_waitcnt vmcnt(15)
    v_mfma_f32_32x32x16_bf16 v[128:143], a[104:107], v[204:207], v[128:143]
    buffer_load_dwordx4 a[72:75], v9, s[28:31], s62 offen offset:2048 sc1
    v_mfma_f32_32x32x16_bf16 v[144:159], a[104:107], v[236:239], v[144:159]
    s_waitcnt vmcnt(15)
    v_mfma_f32_32x32x16_bf16 v[160:175], a[108:111], v[204:207], v[160:175]
    s_add_u32 s62, s62, 3072
    buffer_load_dwordx4 a[76:79], v8, s[28:31], s62 offen offset:0 sc1
    v_mfma_f32_32x32x16_bf16 v[176:191], a[108:111], v[236:239], v[176:191]
    v_and_b32 v2, 7, v1
    s_lshl_b32 s58, s9, 1
    s_and_b32 s59, s4, 1
    s_add_u32 s58, s58, s59
    s_lshl_b32 s60, s58, 7
    s_add_u32 s60, s60, 131072
    v_lshl_add_u32 v84, v2, 2, s60
    v_and_b32 v2, 15, v1
    s_lshl_b32 s60, s9, 7
    s_add_u32 s60, s60, 196608
    v_lshl_add_u32 v3, v2, 2, s60
    v_cmp_gt_u32 vcc, 32, v1
    s_nop 1
    v_cndmask_b32 v84, v3, v84, vcc
    buffer_load_dword v85, v84, s[28:31], 0 offen sc1
    s_waitcnt vmcnt(16)
    v_mfma_f32_32x32x16_bf16 v[96:111], a[112:115], v[208:211], v[96:111]
    v_mfma_f32_32x32x16_bf16 v[112:127], a[112:115], v[240:243], v[112:127]
    buffer_load_dwordx4 a[80:83], v9, s[28:31], s62 offen offset:1024 sc1
    s_waitcnt vmcnt(16)
    v_mfma_f32_32x32x16_bf16 v[128:143], a[116:119], v[208:211], v[128:143]
    v_mfma_f32_32x32x16_bf16 v[144:159], a[116:119], v[240:243], v[144:159]
    buffer_load_dwordx4 a[84:87], v9, s[28:31], s62 offen offset:2048 sc1
    s_waitcnt vmcnt(16)
    v_mfma_f32_32x32x16_bf16 v[160:175], a[120:123], v[208:211], v[160:175]
    v_mfma_f32_32x32x16_bf16 v[176:191], a[120:123], v[240:243], v[176:191]
    s_add_u32 s62, s62, 3072
    buffer_load_dwordx4 a[88:91], v8, s[28:31], s62 offen offset:0 sc1
    s_waitcnt vmcnt(16)
    v_mfma_f32_32x32x16_bf16 v[96:111], a[124:127], v[212:215], v[96:111]
    v_mfma_f32_32x32x16_bf16 v[112:127], a[124:127], v[244:247], v[112:127]
    buffer_load_dwordx4 a[92:95], v9, s[28:31], s62 offen offset:1024 sc1
    s_waitcnt vmcnt(16)
    v_mfma_f32_32x32x16_bf16 v[128:143], v[40:43], v[212:215], v[128:143]
    v_mfma_f32_32x32x16_bf16 v[144:159], v[40:43], v[244:247], v[144:159]
    buffer_load_dwordx4 a[96:99], v9, s[28:31], s62 offen offset:2048 sc1
    s_waitcnt vmcnt(16)
    v_mfma_f32_32x32x16_bf16 v[160:175], v[44:47], v[212:215], v[160:175]
    v_mfma_f32_32x32x16_bf16 v[176:191], v[44:47], v[244:247], v[176:191]
    s_add_u32 s62, s62, 3072
    buffer_load_dwordx4 a[100:103], v8, s[28:31], s62 offen offset:0 sc1
    s_cmp_le_u32 s4, 0
    s_cselect_b32 s58, 47104, 0
    s_mul_i32 s59, s4, 6144
    s_add_u32 s58, s58, s59
    s_add_u32 s58, s58, 4294961152
    v_add_u32 v10, s58, v28
    s_cmp_le_u32 s4, 1
    s_cselect_b32 s58, 47104, 0
    s_mul_i32 s59, s4, 6144
    s_add_u32 s58, s58, s59
    s_add_u32 s58, s58, 34816
    v_add_u32 v11, s58, v28
    s_cmp_le_u32 s4, 2
    s_cselect_b32 s58, 47104, 0
    s_mul_i32 s59, s4, 6144
    s_add_u32 s58, s58, s59
    s_add_u32 s58, s58, 75776
    v_add_u32 v12, s58, v28
    s_waitcnt vmcnt(16)
    v_mfma_f32_32x32x16_bf16 v[96:111], v[48:51], v[216:219], v[96:111]
    buffer_load_dwordx4 a[104:107], v9, s[28:31], s62 offen offset:1024 sc1
    v_mfma_f32_32x32x16_bf16 v[112:127], v[48:51], v[248:251], v[112:127]
    s_waitcnt vmcnt(16)
    v_mfma_f32_32x32x16_bf16 v[128:143], v[52:55], v[216:219], v[128:143]
    buffer_load_dwordx4 a[108:111], v9, s[28:31], s62 offen offset:2048 sc1
    v_mfma_f32_32x32x16_bf16 v[144:159], v[52:55], v[248:251], v[144:159]
    s_waitcnt vmcnt(16)
    v_mfma_f32_32x32x16_bf16 v[160:175], v[56:59], v[216:219], v[160:175]
    s_add_u32 s62, s62, 3072
    s_cmp_eq_u32 s62, s83
    s_cselect_b32 s62, s56, s62
    buffer_load_dwordx4 a[112:115], v8, s[28:31], s62 offen offset:0 sc1
    v_mfma_f32_32x32x16_bf16 v[176:191], v[56:59], v[248:251], v[176:191]
    v_add_u32 v6, s55, v28
    v_subrev_u32 v7, 6144, v6
    s_cmp_gt_u32 s4, 1
    s_cselect_b64 vcc, -1, 0
    v_cndmask_b32 v4, v7, v6, vcc
    s_cmp_gt_u32 s4, 2
    s_cselect_b64 vcc, -1, 0
    v_cndmask_b32 v5, v7, v6, vcc
    s_waitcnt vmcnt(9) lgkmcnt(0)
    s_barrier
    v_cmp_ne_u32 vcc, s11, v85
    s_cbranch_vccnz .slow_a_16
.back_a_17:
    v_and_b32 v84, 31, v1
    v_lshl_add_u32 v84, v84, 2, s71
    v_lshrrev_b32 v2, 4, v1
    v_bfe_u32 v3, v1, 2, 2
    v_lshrrev_b32 v16, 1, v2
    v_lshl_add_u32 v16, v16, 3, v3
    v_lshlrev_b32 v16, 7, v16
    v_lshrrev_b32 v3, 1, v3
    v_lshl_add_u32 v16, v3, 6, v16
    v_and_b32 v2, 1, v2
    v_lshl_add_u32 v16, v2, 5, v16
    v_and_b32 v2, 3, v1
    v_lshl_add_u32 v16, v2, 3, v16
    v_add_u32 v16, s55, v16
    v_xor_b32 v17, 64, v16
    v_mfma_f32_32x32x16_bf16 v[96:111], v[60:63], v[220:223], v[96:111]
    s_add_u32 s61, s62, 3072
    buffer_load_dwordx4 a[116:119], v8, s[28:31], s61 offen offset:0 sc1
    v_mfma_f32_32x32x16_bf16 v[112:127], v[60:63], v[252:255], v[112:127]
    v_mfma_f32_32x32x16_bf16 v[128:143], v[64:67], v[220:223], v[128:143]
    s_add_u32 s61, s62, 6144
    buffer_load_dwordx4 a[120:123], v8, s[28:31], s61 offen offset:0 sc1
    v_mfma_f32_32x32x16_bf16 v[144:159], v[64:67], v[252:255], v[144:159]
    v_mfma_f32_32x32x16_bf16 v[160:175], v[68:71], v[220:223], v[160:175]
    s_add_u32 s61, s62, 9216
    buffer_load_dwordx4 a[124:127], v8, s[28:31], s61 offen offset:0 sc1
    v_mfma_f32_32x32x16_bf16 v[176:191], v[68:71], v[252:255], v[176:191]
    v_mfma_f32_32x32x16_bf16 v[96:111], a[64:67], a[0:3], v[96:111]
    buffer_load_dwordx4 v[40:43], v9, s[28:31], s62 offen offset:1024 sc1
    v_mfma_f32_32x32x16_bf16 v[112:127], a[64:67], a[32:35], v[112:127]
    v_mfma_f32_32x32x16_bf16 v[128:143], a[68:71], a[0:3], v[128:143]
    s_add_u32 s61, s62, 3072
    buffer_load_dwordx4 v[44:47], v9, s[28:31], s61 offen offset:1024 sc1
    v_mfma_f32_32x32x16_bf16 v[144:159], a[68:71], a[32:35], v[144:159]
    v_mfma_f32_32x32x16_bf16 v[160:175], a[72:75], a[0:3], v[160:175]
    s_add_u32 s61, s62, 6144
    buffer_load_dwordx4 v[48:51], v9, s[28:31], s61 offen offset:1024 sc1
    v_mfma_f32_32x32x16_bf16 v[176:191], a[72:75], a[32:35], v[176:191]
    buffer_load_dwordx4 v[216:219], v28, s[28:31], s68 offen sc1
    buffer_load_dwordx4 v[220:223], v28, s[28:31], s69 offen sc1
    buffer_load_dwordx4 v[224:227], v28, s[28:31], s70 offen sc1
    v_mfma_f32_32x32x16_bf16 v[96:111], a[76:79], a[4:7], v[96:111]
    v_mfma_f32_32x32x16_bf16 v[112:127], a[76:79], a[36:39], v[112:127]
    s_add_u32 s61, s62, 9216
    buffer_load_dwordx4 v[52:55], v9, s[28:31], s61 offen offset:1024 sc1
    s_waitcnt vmcnt(18)
    v_mfma_f32_32x32x16_bf16 v[128:143], a[80:83], a[4:7], v[128:143]
    v_mfma_f32_32x32x16_bf16 v[144:159], a[80:83], a[36:39], v[144:159]
    buffer_load_dwordx4 v[56:59], v9, s[28:31], s62 offen offset:2048 sc1
    s_waitcnt vmcnt(18)
    v_mfma_f32_32x32x16_bf16 v[160:175], a[84:87], a[4:7], v[160:175]
    v_mfma_f32_32x32x16_bf16 v[176:191], a[84:87], a[36:39], v[176:191]
    s_add_u32 s61, s62, 3072
    buffer_load_dwordx4 v[60:63], v9, s[28:31], s61 offen offset:2048 sc1
    buffer_load_dwordx4 v[88:91], v30, s[16:19], 0 offen
    buffer_load_dwordx4 v[92:95], v31, s[16:19], 0 offen
    s_waitcnt vmcnt(20)
    v_mfma_f32_32x32x16_bf16 v[96:111], a[88:91], a[8:11], v[96:111]
    v_mfma_f32_32x32x16_bf16 v[112:127], a[88:91], a[40:43], v[112:127]
    s_add_u32 s61, s62, 6144
    buffer_load_dwordx4 v[64:67], v9, s[28:31], s61 offen offset:2048 sc1
    s_waitcnt vmcnt(20)
    v_mfma_f32_32x32x16_bf16 v[128:143], a[92:95], a[8:11], v[128:143]
    v_mfma_f32_32x32x16_bf16 v[144:159], a[92:95], a[40:43], v[144:159]
    s_add_u32 s61, s62, 9216
    buffer_load_dwordx4 v[68:71], v9, s[28:31], s61 offen offset:2048 sc1
    s_waitcnt vmcnt(20)
    v_mfma_f32_32x32x16_bf16 v[160:175], a[96:99], a[8:11], v[160:175]
    v_mfma_f32_32x32x16_bf16 v[176:191], a[96:99], a[40:43], v[176:191]
    buffer_load_dwordx4 a[192:195], v28, s[28:31], s67 offen offset:0 sc1
    s_waitcnt vmcnt(20)
    v_mfma_f32_32x32x16_bf16 v[96:111], a[100:103], a[12:15], v[96:111]
    v_mfma_f32_32x32x16_bf16 v[112:127], a[100:103], a[44:47], v[112:127]
    buffer_load_dwordx4 a[196:199], v28, s[28:31], s67 offen offset:1024 sc1
    s_waitcnt vmcnt(20)
    v_mfma_f32_32x32x16_bf16 v[128:143], a[104:107], a[12:15], v[128:143]
    v_mfma_f32_32x32x16_bf16 v[144:159], a[104:107], a[44:47], v[144:159]
    buffer_load_dwordx4 a[200:203], v28, s[28:31], s67 offen offset:2048 sc1
    s_waitcnt vmcnt(20)
    v_mfma_f32_32x32x16_bf16 v[160:175], a[108:111], a[12:15], v[160:175]
    v_mfma_f32_32x32x16_bf16 v[176:191], a[108:111], a[44:47], v[176:191]
    buffer_load_dwordx4 a[204:207], v28, s[28:31], s67 offen offset:3072 sc1
    s_waitcnt vmcnt(20)
    v_mfma_f32_32x32x16_bf16 v[96:111], a[112:115], a[16:19], v[96:111]
    v_mfma_f32_32x32x16_bf16 v[112:127], a[112:115], a[48:51], v[112:127]
    s_add_u32 s67, s67, 4096
    buffer_load_dwordx4 a[208:211], v28, s[28:31], s67 offen offset:0 sc1
    s_waitcnt vmcnt(20)
    v_mfma_f32_32x32x16_bf16 v[96:111], a[116:119], a[20:23], v[96:111]
    v_mfma_f32_32x32x16_bf16 v[112:127], a[116:119], a[52:55], v[112:127]
    buffer_load_dwordx4 a[212:215], v28, s[28:31], s67 offen offset:1024 sc1
    s_waitcnt vmcnt(20)
    v_mfma_f32_32x32x16_bf16 v[96:111], a[120:123], a[24:27], v[96:111]
    v_mfma_f32_32x32x16_bf16 v[112:127], a[120:123], a[56:59], v[112:127]
    buffer_load_dwordx4 a[216:219], v28, s[28:31], s67 offen offset:2048 sc1
    s_waitcnt vmcnt(20)
    v_mfma_f32_32x32x16_bf16 v[96:111], a[124:127], a[28:31], v[96:111]
    v_mfma_f32_32x32x16_bf16 v[112:127], a[124:127], a[60:63], v[112:127]
    buffer_load_dwordx4 a[220:223], v28, s[28:31], s67 offen offset:3072 sc1
    s_waitcnt vmcnt(20)
    v_mfma_f32_32x32x16_bf16 v[128:143], v[40:43], a[16:19], v[128:143]
    v_mfma_f32_32x32x16_bf16 v[144:159], v[40:43], a[48:51], v[144:159]
    s_add_u32 s67, s67, 4096
    buffer_load_dwordx4 a[224:227], v28, s[28:31], s67 offen offset:0 sc1
    s_waitcnt vmcnt(20)
    v_mfma_f32_32x32x16_bf16 v[128:143], v[44:47], a[20:23], v[128:143]
    s_nop 6
    s_cmp_eq_u32 s4, 0
    s_cbranch_scc1 .cls_a_18
    ds_write_b128 v6, v[96:99] offset:0
    ds_write_b128 v6, v[100:103] offset:1024
.cls_a_18:
    buffer_load_dwordx4 a[228:231], v28, s[28:31], s67 offen offset:1024 sc1
    v_mfma_f32_32x32x16_bf16 v[144:159], v[44:47], a[52:55], v[144:159]
    s_cmp_eq_u32 s4, 1
    s_cbranch_scc1 .cls_a_19
    ds_write_b128 v4, v[112:115] offset:6144
    ds_write_b128 v4, v[116:119] offset:7168
.cls_a_19:
    buffer_load_dwordx4 a[232:235], v28, s[28:31], s67 offen offset:2048 sc1
    s_waitcnt vmcnt(21)
    v_mfma_f32_32x32x16_bf16 v[128:143], v[48:51], a[24:27], v[128:143]
    s_cmp_eq_u32 s4, 2
    s_cbranch_scc1 .cls_a_20
    ds_write_b128 v5, v[104:107] offset:12288
    ds_write_b128 v5, v[108:111] offset:13312
.cls_a_20:
    buffer_load_dwordx4 a[236:239], v28, s[28:31], s67 offen offset:3072 sc1
    v_mfma_f32_32x32x16_bf16 v[144:159], v[48:51], a[56:59], v[144:159]
    s_cmp_eq_u32 s4, 3
    s_cbranch_scc1 .cls_a_21
    ds_write_b128 v7, v[120:123] offset:18432
    ds_write_b128 v7, v[124:127] offset:19456
.cls_a_21:
    s_add_u32 s67, s67, 4096
    buffer_load_dwordx4 a[240:243], v28, s[28:31], s67 offen offset:0 sc1
    s_waitcnt vmcnt(19)
    v_mfma_f32_32x32x16_bf16 v[128:143], v[52:55], a[28:31], v[128:143]
    v_mfma_f32_32x32x16_bf16 v[144:159], v[52:55], a[60:63], v[144:159]
    buffer_load_dwordx4 a[244:247], v28, s[28:31], s67 offen offset:1024 sc1
    s_waitcnt vmcnt(19)
    v_mfma_f32_32x32x16_bf16 v[160:175], v[56:59], a[16:19], v[160:175]
    v_mfma_f32_32x32x16_bf16 v[176:191], v[56:59], a[48:51], v[176:191]
    buffer_load_dwordx4 a[248:251], v28, s[28:31], s67 offen offset:2048 sc1
    s_waitcnt vmcnt(19)
    v_mfma_f32_32x32x16_bf16 v[160:175], v[60:63], a[20:23], v[160:175]
    s_nop 6
    s_cmp_eq_u32 s4, 0
    s_cbranch_scc1 .cls_a_22
    ds_write_b128 v6, v[128:131] offset:2048
    ds_write_b128 v6, v[132:135] offset:3072
.cls_a_22:
    buffer_load_dwordx4 a[252:255], v28, s[28:31], s67 offen offset:3072 sc1
    v_mfma_f32_32x32x16_bf16 v[176:191], v[60:63], a[52:55], v[176:191]
    s_cmp_eq_u32 s4, 1
    s_cbranch_scc1 .cls_a_23
    ds_write_b128 v4, v[144:147] offset:8192
    ds_write_b128 v4, v[148:151] offset:9216
.cls_a_23:
    s_add_u32 m0, s55, 18432
    s_add_u32 s84, s53, 0
    s_waitcnt vmcnt(17)
    v_mfma_f32_32x32x16_bf16 v[160:175], v[64:67], a[24:27], v[160:175]
    s_cmp_eq_u32 s4, 2
    s_cbranch_scc1 .cls_a_24
    ds_write_b128 v5, v[136:139] offset:14336
    ds_write_b128 v5, v[140:143] offset:15360
.cls_a_24:
    buffer_load_dwordx4 v76, s[36:39], s84 offen offset:0 lds
    v_mfma_f32_32x32x16_bf16 v[176:191], v[64:67], a[56:59], v[176:191]
    s_cmp_eq_u32 s4, 3
    s_cbranch_scc1 .cls_a_25
    ds_write_b128 v7, v[152:155] offset:20480
    ds_write_b128 v7, v[156:159] offset:21504
.cls_a_25:
    buffer_load_dwordx4 v77, s[36:39], s84 offen offset:1024 lds
    s_waitcnt vmcnt(18)
    v_mfma_f32_32x32x16_bf16 v[160:175], v[68:71], a[28:31], v[160:175]
    v_mfma_f32_32x32x16_bf16 v[176:191], v[68:71], a[60:63], v[176:191]
    buffer_load_dwordx4 v78, s[36:39], s84 offen offset:2048 lds
    v_lshlrev_b32 v2, 16, v29
    v_lshlrev_b32 v32, 16, v216
    v_and_b32 v33, 0xffff0000, v216
    v_lshlrev_b32 v34, 16, v217
    v_and_b32 v35, 0xffff0000, v217
    v_lshlrev_b32 v36, 16, v218
    v_and_b32 v37, 0xffff0000, v218
    v_lshlrev_b32 v38, 16, v219
    v_and_b32 v39, 0xffff0000, v219
    v_lshlrev_b32 v40, 16, v220
    v_and_b32 v41, 0xffff0000, v220
    v_lshlrev_b32 v42, 16, v221
    v_and_b32 v43, 0xffff0000, v221
    v_lshlrev_b32 v44, 16, v222
    v_and_b32 v45, 0xffff0000, v222
    v_lshlrev_b32 v46, 16, v223
    v_and_b32 v47, 0xffff0000, v223
    v_lshlrev_b32 v48, 16, v224
    v_and_b32 v49, 0xffff0000, v224
    v_lshlrev_b32 v50, 16, v225
    v_and_b32 v51, 0xffff0000, v225
    v_lshlrev_b32 v52, 16, v226
    v_and_b32 v53, 0xffff0000, v226
    v_lshlrev_b32 v54, 16, v227
    v_and_b32 v55, 0xffff0000, v227
    buffer_load_dwordx4 v79, s[36:39], s84 offen offset:3072 lds
    s_cmp_eq_u32 s4, 0
    s_cbranch_scc1 .cls_a_26
    ds_write_b128 v6, v[160:163] offset:4096
    ds_write_b128 v6, v[164:167] offset:5120
.cls_a_26:
    s_add_u32 m0, s55, 22528
    s_add_u32 s84, s53, 32768
    s_cmp_eq_u32 s4, 1
    s_cbranch_scc1 .cls_a_27
    ds_write_b128 v4, v[176:179] offset:10240
    ds_write_b128 v4, v[180:183] offset:11264
.cls_a_27:
    buffer_load_dwordx4 v76, s[36:39], s84 offen offset:0 lds
    s_cmp_eq_u32 s4, 2
    s_cbranch_scc1 .cls_a_28
    ds_write_b128 v5, v[168:171] offset:16384
    ds_write_b128 v5, v[172:175] offset:17408
.cls_a_28:
    buffer_load_dwordx4 v77, s[36:39], s84 offen offset:1024 lds
    s_cmp_eq_u32 s4, 3
    s_cbranch_scc1 .cls_a_29
    ds_write_b128 v7, v[184:187] offset:22528
    ds_write_b128 v7, v[188:191] offset:23552
.cls_a_29:
    buffer_load_dwordx4 v78, s[36:39], s84 offen offset:2048 lds
    s_cmp_lg_u32 s4, 0
    s_cbranch_scc1 .own_a_31
    v_pk_add_f32 v[192:193], v[96:97], v[2:3] op_sel_hi:[1,0]
    v_pk_add_f32 v[194:195], v[98:99], v[2:3] op_sel_hi:[1,0]
    v_pk_add_f32 v[196:197], v[100:101], v[2:3] op_sel_hi:[1,0]
    v_pk_add_f32 v[198:199], v[102:103], v[2:3] op_sel_hi:[1,0]
    v_pk_add_f32 v[200:201], v[128:129], v[2:3] op_sel_hi:[1,0]
    v_pk_add_f32 v[202:203], v[130:131], v[2:3] op_sel_hi:[1,0]
    v_pk_add_f32 v[204:205], v[132:133], v[2:3] op_sel_hi:[1,0]
    v_pk_add_f32 v[206:207], v[134:135], v[2:3] op_sel_hi:[1,0]
    v_pk_add_f32 v[208:209], v[160:161], v[2:3] op_sel_hi:[1,0]
    v_pk_add_f32 v[210:211], v[162:163], v[2:3] op_sel_hi:[1,0]
    v_pk_add_f32 v[212:213], v[164:165], v[2:3] op_sel_hi:[1,0]
    v_pk_add_f32 v[214:215], v[166:167], v[2:3] op_sel_hi:[1,0]
    s_branch .own_a_30
.own_a_31:
    s_cmp_lg_u32 s4, 1
    s_cbranch_scc1 .own_a_32
    v_pk_add_f32 v[192:193], v[112:113], v[2:3] op_sel_hi:[1,0]
    v_pk_add_f32 v[194:195], v[114:115], v[2:3] op_sel_hi:[1,0]
    v_pk_add_f32 v[196:197], v[116:117], v[2:3] op_sel_hi:[1,0]
    v_pk_add_f32 v[198:199], v[118:119], v[2:3] op_sel_hi:[1,0]
    v_pk_add_f32 v[200:201], v[144:145], v[2:3] op_sel_hi:[1,0]
    v_pk_add_f32 v[202:203], v[146:147], v[2:3] op_sel_hi:[1,0]
    v_pk_add_f32 v[204:205], v[148:149], v[2:3] op_sel_hi:[1,0]
    v_pk_add_f32 v[206:207], v[150:151], v[2:3] op_sel_hi:[1,0]
    v_pk_add_f32 v[208:209], v[176:177], v[2:3] op_sel_hi:[1,0]
    v_pk_add_f32 v[210:211], v[178:179], v[2:3] op_sel_hi:[1,0]
    v_pk_add_f32 v[212:213], v[180:181], v[2:3] op_sel_hi:[1,0]
    v_pk_add_f32 v[214:215], v[182:183], v[2:3] op_sel_hi:[1,0]
    s_branch .own_a_30
.own_a_32:
    s_cmp_lg_u32 s4, 2
    s_cbranch_scc1 .own_a_33
    v_pk_add_f32 v[192:193], v[104:105], v[2:3] op_sel_hi:[1,0]
    v_pk_add_f32 v[194:195], v[106:107], v[2:3] op_sel_hi:[1,0]
    v_pk_add_f32 v[196:197], v[108:109], v[2:3] op_sel_hi:[1,0]
    v_pk_add_f32 v[198:199], v[110:111], v[2:3] op_sel_hi:[1,0]
    v_pk_add_f32 v[200:201], v[136:137], v[2:3] op_sel_hi:[1,0]
    v_pk_add_f32 v[202:203], v[138:139], v[2:3] op_sel_hi:[1,0]
    v_pk_add_f32 v[204:205], v[140:141], v[2:3] op_sel_hi:[1,0]
    v_pk_add_f32 v[206:207], v[142:143], v[2:3] op_sel_hi:[1,0]
    v_pk_add_f32 v[208:209], v[168:169], v[2:3] op_sel_hi:[1,0]
    v_pk_add_f32 v[210:211], v[170:171], v[2:3] op_sel_hi:[1,0]
    v_pk_add_f32 v[212:213], v[172:173], v[2:3] op_sel_hi:[1,0]
    v_pk_add_f32 v[214:215], v[174:175], v[2:3] op_sel_hi:[1,0]
    s_branch .own_a_30
.own_a_33:
    v_pk_add_f32 v[192:193], v[120:121], v[2:3] op_sel_hi:[1,0]
    v_pk_add_f32 v[194:195], v[122:123], v[2:3] op_sel_hi:[1,0]
    v_pk_add_f32 v[196:197], v[124:125], v[2:3] op_sel_hi:[1,0]
    v_pk_add_f32 v[198:199], v[126:127], v[2:3] op_sel_hi:[1,0]
    v_pk_add_f32 v[200:201], v[152:153], v[2:3] op_sel_hi:[1,0]
    v_pk_add_f32 v[202:203], v[154:155], v[2:3] op_sel_hi:[1,0]
    v_pk_add_f32 v[204:205], v[156:157], v[2:3] op_sel_hi:[1,0]
    v_pk_add_f32 v[206:207], v[158:159], v[2:3] op_sel_hi:[1,0]
    v_pk_add_f32 v[208:209], v[184:185], v[2:3] op_sel_hi:[1,0]
    v_pk_add_f32 v[210:211], v[186:187], v[2:3] op_sel_hi:[1,0]
    v_pk_add_f32 v[212:213], v[188:189], v[2:3] op_sel_hi:[1,0]
    v_pk_add_f32 v[214:215], v[190:191], v[2:3] op_sel_hi:[1,0]
.own_a_30:
    buffer_load_dwordx4 v79, s[36:39], s84 offen offset:3072 lds
    s_add_u32 m0, s55, 26624
    s_add_u32 s84, s53, 65536
    s_waitcnt lgkmcnt(0)
    s_barrier
    ds_read_b128 v[96:99], v10 offset:0
    ds_read_b128 v[100:103], v10 offset:1024
    ds_read_b128 v[104:107], v11 offset:0
    ds_read_b128 v[108:111], v11 offset:1024
    ds_read_b128 v[112:115], v12 offset:0
    ds_read_b128 v[116:119], v12 offset:1024
    ds_read_b128 v[120:123], v10 offset:2048
    ds_read_b128 v[124:127], v10 offset:3072
    ds_read_b128 v[128:131], v11 offset:2048
    ds_read_b128 v[132:135], v11 offset:3072
    ds_read_b128 v[136:139], v12 offset:2048
    ds_read_b128 v[140:143], v12 offset:3072
    s_waitcnt lgkmcnt(6)
    ds_read_b128 v[144:147], v10 offset:4096
    ds_read_b128 v[148:151], v10 offset:5120
    ds_read_b128 v[152:155], v11 offset:4096
    ds_read_b128 v[156:159], v11 offset:5120
    ds_read_b128 v[160:163], v12 offset:4096
    ds_read_b128 v[164:167], v12 offset:5120
    buffer_load_dwordx4 v76, s[36:39], s84 offen offset:0 lds
    v_pk_add_f32 v[96:97], v[96:97], v[104:105]
    v_pk_add_f32 v[98:99], v[98:99], v[106:107]
    v_pk_add_f32 v[100:101], v[100:101], v[108:109]
    v_pk_add_f32 v[102:103], v[102:103], v[110:111]
    v_pk_add_f32 v[192:193], v[192:193], v[112:113]
    v_pk_add_f32 v[194:195], v[194:195], v[114:115]
    v_pk_add_f32 v[196:197], v[196:197], v[116:117]
    v_pk_add_f32 v[198:199], v[198:199], v[118:119]
    v_pk_add_f32 v[192:193], v[192:193], v[96:97]
    v_pk_add_f32 v[194:195], v[194:195], v[98:99]
    v_pk_add_f32 v[196:197], v[196:197], v[100:101]
    v_pk_add_f32 v[198:199], v[198:199], v[102:103]
    v_pk_mul_f32 v[192:193], v[192:193], v[32:33]
    v_pk_mul_f32 v[194:195], v[194:195], v[34:35]
    v_pk_mul_f32 v[196:197], v[196:197], v[36:37]
    v_pk_mul_f32 v[198:199], v[198:199], v[38:39]
    v_cvt_pk_bf16_f32 v56, v192, v193
    v_cvt_pk_bf16_f32 v57, v194, v195
    v_cvt_pk_bf16_f32 v58, v196, v197
    v_cvt_pk_bf16_f32 v59, v198, v199
    s_nop 0
    v_permlane32_swap_b32 v56, v58
    v_permlane32_swap_b32 v57, v59
    s_cmp_eq_u32 s12, 0
    s_cbranch_scc1 .sc1_a_35
    buffer_store_dwordx4 v[56:59], v28, s[28:31], s68 offen
.back_a_36:
    s_waitcnt lgkmcnt(8)
    v_pk_add_f32 v[120:121], v[120:121], v[128:129]
    v_pk_add_f32 v[122:123], v[122:123], v[130:131]
    v_pk_add_f32 v[124:125], v[124:125], v[132:133]
    v_pk_add_f32 v[126:127], v[126:127], v[134:135]
    s_waitcnt lgkmcnt(6)
    v_pk_add_f32 v[200:201], v[200:201], v[136:137]
    v_pk_add_f32 v[202:203], v[202:203], v[138:139]
    v_pk_add_f32 v[204:205], v[204:205], v[140:141]
    v_pk_add_f32 v[206:207], v[206:207], v[142:143]
    v_pk_add_f32 v[200:201], v[200:201], v[120:121]
    v_pk_add_f32 v[202:203], v[202:203], v[122:123]
    v_pk_add_f32 v[204:205], v[204:205], v[124:125]
    v_pk_add_f32 v[206:207], v[206:207], v[126:127]
    v_pk_mul_f32 v[200:201], v[200:201], v[40:41]
    v_pk_mul_f32 v[202:203], v[202:203], v[42:43]
    v_pk_mul_f32 v[204:205], v[204:205], v[44:45]
    v_pk_mul_f32 v[206:207], v[206:207], v[46:47]
    v_cvt_pk_bf16_f32 v60, v200, v201
    v_cvt_pk_bf16_f32 v61, v202, v203
    v_cvt_pk_bf16_f32 v62, v204, v205
    v_cvt_pk_bf16_f32 v63, v206, v207
    s_nop 0
    v_permlane32_swap_b32 v60, v62
    v_permlane32_swap_b32 v61, v63
    s_cmp_eq_u32 s12, 0
    s_cbranch_scc1 .sc1_a_37
    buffer_store_dwordx4 v[60:63], v28, s[28:31], s69 offen
.back_a_38:
    s_waitcnt lgkmcnt(2)
    v_pk_add_f32 v[144:145], v[144:145], v[152:153]
    v_pk_add_f32 v[146:147], v[146:147], v[154:155]
    v_pk_add_f32 v[148:149], v[148:149], v[156:157]
    v_pk_add_f32 v[150:151], v[150:151], v[158:159]
    s_waitcnt lgkmcnt(0)
    v_pk_add_f32 v[208:209], v[208:209], v[160:161]
    v_pk_add_f32 v[210:211], v[210:211], v[162:163]
    v_pk_add_f32 v[212:213], v[212:213], v[164:165]
    v_pk_add_f32 v[214:215], v[214:215], v[166:167]
    v_pk_add_f32 v[208:209], v[208:209], v[144:145]
    v_pk_add_f32 v[210:211], v[210:211], v[146:147]
    v_pk_add_f32 v[212:213], v[212:213], v[148:149]
    v_pk_add_f32 v[214:215], v[214:215], v[150:151]
    v_pk_mul_f32 v[208:209], v[208:209], v[48:49]
    v_pk_mul_f32 v[210:211], v[210:211], v[50:51]
    v_pk_mul_f32 v[212:213], v[212:213], v[52:53]
    v_pk_mul_f32 v[214:215], v[214:215], v[54:55]
    v_cvt_pk_bf16_f32 v64, v208, v209
    v_cvt_pk_bf16_f32 v65, v210, v211
    v_cvt_pk_bf16_f32 v66, v212, v213
    v_cvt_pk_bf16_f32 v67, v214, v215
    s_nop 0
    v_permlane32_swap_b32 v64, v66
    v_permlane32_swap_b32 v65, v67
    s_cmp_eq_u32 s12, 0
    s_cbranch_scc1 .sc1_a_39
    buffer_store_dwordx4 v[64:67], v28, s[28:31], s70 offen
.back_a_40:
    s_waitcnt vmcnt(26)
    v_mfma_f32_32x32x16_bf16 v[128:143], a[128:131], a[192:195], 0
    v_mfma_f32_32x32x16_bf16 v[144:159], a[128:131], a[196:199], 0
    buffer_load_dwordx4 v77, s[36:39], s84 offen offset:1024 lds
    s_waitcnt vmcnt(11)
    ds_read_b64_tr_b16 a[64:65], v16 offset:18432
    ds_read_b64_tr_b16 a[66:67], v16 offset:18944
    v_mfma_f32_32x32x16_bf16 v[160:175], a[132:135], a[192:195], 0
    ds_read_b64_tr_b16 a[68:69], v17 offset:18432
    ds_read_b64_tr_b16 a[70:71], v17 offset:18944
    v_mfma_f32_32x32x16_bf16 v[176:191], a[132:135], a[196:199], 0
    buffer_load_dwordx4 v78, s[36:39], s84 offen offset:2048 lds
    v_mfma_f32_32x32x16_bf16 v[128:143], a[136:139], a[200:203], v[128:143]
    v_mfma_f32_32x32x16_bf16 v[144:159], a[136:139], a[204:207], v[144:159]
    buffer_load_dwordx4 v79, s[36:39], s84 offen offset:3072 lds
    s_waitcnt vmcnt(11)
    ds_read_b64_tr_b16 a[72:73], v16 offset:20480
    ds_read_b64_tr_b16 a[74:75], v16 offset:20992
    v_mfma_f32_32x32x16_bf16 v[160:175], a[140:143], a[200:203], v[160:175]
    s_add_u32 m0, s55, 30720
    s_add_u32 s84, s53, 98304
    ds_read_b64_tr_b16 a[76:77], v17 offset:20480
    ds_read_b64_tr_b16 a[78:79], v17 offset:20992
    v_mfma_f32_32x32x16_bf16 v[176:191], a[140:143], a[204:207], v[176:191]
    s_waitcnt vmcnt(3)
    v_mov_b32 v2, s11
    v_mov_b32 v3, 0
    s_mov_b64 exec, 1
    s_cmp_eq_u32 s12, 0
    s_cbranch_scc1 .sc1_a_41
    buffer_store_dword v2, v3, s[28:31], s66 offen
.back_a_42:
    s_mov_b64 exec, -1
    v_mfma_f32_32x32x16_bf16 v[128:143], a[144:147], a[208:211], v[128:143]
    ds_read_b64_tr_b16 a[80:81], v16 offset:22528
    ds_read_b64_tr_b16 a[82:83], v16 offset:23040
    v_mfma_f32_32x32x16_bf16 v[144:159], a[144:147], a[212:215], v[144:159]
    buffer_load_dwordx4 v76, s[36:39], s84 offen offset:0 lds
    ds_read_b64_tr_b16 a[84:85], v17 offset:22528
    ds_read_b64_tr_b16 a[86:87], v17 offset:23040
    v_and_b32 v2, 31, v1
    v_mul_u32_u24 v2, 272, v2
    v_lshrrev_b32 v3, 5, v1
    v_lshl_add_u32 v2, v3, 4, v2
    v_add_u32 v2, s55, v2
    v_mfma_f32_32x32x16_bf16 v[160:175], a[148:151], a[208:211], v[160:175]
    buffer_load_dwordx4 v77, s[36:39], s84 offen offset:1024 lds
    ds_read_b64_tr_b16 a[88:89], v16 offset:24576
    ds_read_b64_tr_b16 a[90:91], v16 offset:25088
    v_lshrrev_b32 v3, 3, v0
    v_mul_u32_u24 v3, 272, v3
    v_and_b32 v4, 7, v0
    v_lshl_add_u32 v3, v4, 5, v3
    v_add_u32 v3, 18432, v3
    v_add_u32 v4, 81920, v3
    v_mfma_f32_32x32x16_bf16 v[176:191], a[148:151], a[212:215], v[176:191]
    buffer_load_dwordx4 v78, s[36:39], s84 offen offset:2048 lds
    ds_read_b64_tr_b16 a[92:93], v17 offset:24576
    ds_read_b64_tr_b16 a[94:95], v17 offset:25088
    v_lshlrev_b32 v112, 16, v88
    v_and_b32 v113, 0xffff0000, v88
    v_lshlrev_b32 v114, 16, v89
    v_and_b32 v115, 0xffff0000, v89
    v_mfma_f32_32x32x16_bf16 v[128:143], a[152:155], a[216:219], v[128:143]
    v_lshlrev_b32 v116, 16, v90
    v_and_b32 v117, 0xffff0000, v90
    v_lshlrev_b32 v118, 16, v91
    v_and_b32 v119, 0xffff0000, v91
    v_mfma_f32_32x32x16_bf16 v[144:159], a[152:155], a[220:223], v[144:159]
    buffer_load_dwordx4 v79, s[36:39], s84 offen offset:3072 lds
    v_lshlrev_b32 v120, 16, v92
    v_and_b32 v121, 0xffff0000, v92
    v_lshlrev_b32 v122, 16, v93
    v_and_b32 v123, 0xffff0000, v93
    v_mfma_f32_32x32x16_bf16 v[160:175], a[156:159], a[216:219], v[160:175]
    s_add_u32 m0, s55, 34816
    s_add_u32 s84, s53, 131072
    v_lshlrev_b32 v124, 16, v94
    v_and_b32 v125, 0xffff0000, v94
    v_lshlrev_b32 v126, 16, v95
    v_and_b32 v127, 0xffff0000, v95
    v_mfma_f32_32x32x16_bf16 v[176:191], a[156:159], a[220:223], v[176:191]
    buffer_load_dwordx4 v76, s[36:39], s84 offen offset:0 lds
    s_waitcnt vmcnt(8)
    ds_read_b64_tr_b16 a[96:97], v16 offset:26624
    ds_read_b64_tr_b16 a[98:99], v16 offset:27136
    v_mfma_f32_32x32x16_bf16 v[128:143], a[160:163], a[224:227], v[128:143]
    ds_read_b64_tr_b16 a[100:101], v17 offset:26624
    ds_read_b64_tr_b16 a[102:103], v17 offset:27136
    v_mfma_f32_32x32x16_bf16 v[144:159], a[160:163], a[228:231], v[144:159]
    buffer_load_dword v85, v84, s[28:31], 0 offen sc1
    v_mfma_f32_32x32x16_bf16 v[160:175], a[164:167], a[224:227], v[160:175]
    v_mfma_f32_32x32x16_bf16 v[176:191], a[164:167], a[228:231], v[176:191]
    buffer_load_dwordx4 v77, s[36:39], s84 offen offset:1024 lds
    s_waitcnt vmcnt(8)
    ds_read_b64_tr_b16 a[104:105], v16 offset:28672
    ds_read_b64_tr_b16 a[106:107], v16 offset:29184
    v_mfma_f32_32x32x16_bf16 v[128:143], a[168:171], a[232:235], v[128:143]
    ds_read_b64_tr_b16 a[108:109], v17 offset:28672
    ds_read_b64_tr_b16 a[110:111], v17 offset:29184
    v_mfma_f32_32x32x16_bf16 v[144:159], a[168:171], a[236:239], v[144:159]
    buffer_load_dwordx4 v78, s[36:39], s84 offen offset:2048 lds
    v_mfma_f32_32x32x16_bf16 v[160:175], a[172:175], a[232:235], v[160:175]
    v_mfma_f32_32x32x16_bf16 v[176:191], a[172:175], a[236:239], v[176:191]
    buffer_load_dwordx4 v79, s[36:39], s84 offen offset:3072 lds
    v_mfma_f32_32x32x16_bf16 v[128:143], a[176:179], a[240:243], v[128:143]
    s_add_u32 m0, s55, 38912
    s_add_u32 s84, s53, 163840
    v_mfma_f32_32x32x16_bf16 v[144:159], a[176:179], a[244:247], v[144:159]
    buffer_load_dwordx4 v76, s[36:39], s84 offen offset:0 lds
    buffer_load_dwordx4 v77, s[36:39], s84 offen offset:1024 lds
    s_waitcnt vmcnt(5)
    s_mov_b32 s57, 0
.loop_a_43:
    v_cmp_ne_u32 vcc, s11, v85
    s_cbranch_vccz .ok_a_44
    s_add_u32 s57, s57, 1
    s_cmp_gt_u32 s57, 200000
    s_cbranch_scc1 .Lfail_5
    s_sleep 2
    buffer_load_dword v85, v84, s[28:31], 0 offen sc1
    s_waitcnt vmcnt(0)
    s_branch .loop_a_43
.ok_a_44:
    buffer_load_dwordx4 a[0:3], v28, s[28:31], s72 offen offset:0 sc1
    buffer_load_dwordx4 a[4:7], v28, s[28:31], s72 offen offset:1024 sc1
    buffer_load_dwordx4 a[8:11], v28, s[28:31], s72 offen offset:2048 sc1
    buffer_load_dwordx4 a[12:15], v28, s[28:31], s72 offen offset:3072 sc1
    s_add_u32 s72, s72, 4096
    buffer_load_dwordx4 a[16:19], v28, s[28:31], s72 offen offset:0 sc1
    buffer_load_dwordx4 a[20:23], v28, s[28:31], s72 offen offset:1024 sc1
    v_mfma_f32_32x32x16_bf16 v[160:175], a[180:183], a[240:243], v[160:175]
    ds_read_b64_tr_b16 a[112:113], v16 offset:30720
    ds_read_b64_tr_b16 a[114:115], v16 offset:31232
    v_mfma_f32_32x32x16_bf16 v[176:191], a[180:183], a[244:247], v[176:191]
    buffer_load_dwordx4 a[24:27], v28, s[28:31], s72 offen offset:2048 sc1
    ds_read_b64_tr_b16 a[116:117], v17 offset:30720
    ds_read_b64_tr_b16 a[118:119], v17 offset:31232
    v_mfma_f32_32x32x16_bf16 v[128:143], a[184:187], a[248:251], v[128:143]
    ds_read_b64_tr_b16 a[120:121], v16 offset:32768
    ds_read_b64_tr_b16 a[122:123], v16 offset:33280
    v_mfma_f32_32x32x16_bf16 v[144:159], a[184:187], a[252:255], v[144:159]
    buffer_load_dwordx4 a[28:31], v28, s[28:31], s72 offen offset:3072 sc1
    ds_read_b64_tr_b16 a[124:125], v17 offset:32768
    ds_read_b64_tr_b16 a[126:127], v17 offset:33280
    v_mfma_f32_32x32x16_bf16 v[160:175], a[188:191], a[248:251], v[160:175]
    s_waitcnt vmcnt(12)
    ds_read_b64_tr_b16 v[40:41], v16 offset:34816
    ds_read_b64_tr_b16 v[42:43], v16 offset:35328
    v_mfma_f32_32x32x16_bf16 v[176:191], a[188:191], a[252:255], v[176:191]
    s_add_u32 s72, s72, 4096
    buffer_load_dwordx4 a[32:35], v28, s[28:31], s72 offen offset:0 sc1
    ds_read_b64_tr_b16 v[44:45], v17 offset:34816
    ds_read_b64_tr_b16 v[46:47], v17 offset:35328
    s_waitcnt vmcnt(11)
    ds_read_b64_tr_b16 v[48:49], v16 offset:36864
    ds_read_b64_tr_b16 v[50:51], v16 offset:37376
    ds_read_b64_tr_b16 v[52:53], v17 offset:36864
    ds_read_b64_tr_b16 v[54:55], v17 offset:37376
    s_waitcnt vmcnt(8) lgkmcnt(14)
    v_mfma_f32_32x32x16_bf16 v[128:143], a[64:67], a[0:3], v[128:143]
    buffer_load_dwordx4 a[36:39], v28, s[28:31], s72 offen offset:1024 sc1
    ds_read_b64_tr_b16 v[56:57], v16 offset:38912
    ds_read_b64_tr_b16 v[58:59], v16 offset:39424
    v_mfma_f32_32x32x16_bf16 v[160:175], a[68:71], a[0:3], v[160:175]
    ds_read_b64_tr_b16 v[60:61], v17 offset:38912
    ds_read_b64_tr_b16 v[62:63], v17 offset:39424
    s_waitcnt vmcnt(8) lgkmcnt(14)
    v_mfma_f32_32x32x16_bf16 v[128:143], a[72:75], a[4:7], v[128:143]
    s_cmp_eq_u32 s4, 3
    s_cselect_b32 s72, 2147418112, s72
    buffer_load_dwordx4 a[40:43], v28, s[28:31], s72 offen offset:2048 sc1
    v_mfma_f32_32x32x16_bf16 v[160:175], a[76:79], a[4:7], v[160:175]
    s_waitcnt vmcnt(8) lgkmcnt(14)
    v_mfma_f32_32x32x16_bf16 v[128:143], a[80:83], a[8:11], v[128:143]
    buffer_load_dwordx4 a[44:47], v28, s[28:31], s75 offen offset:0 sc1
    v_mfma_f32_32x32x16_bf16 v[160:175], a[84:87], a[8:11], v[160:175]
    s_waitcnt vmcnt(8) lgkmcnt(14)
    v_mfma_f32_32x32x16_bf16 v[128:143], a[88:91], a[12:15], v[128:143]
    buffer_load_dwordx4 a[48:51], v28, s[28:31], s75 offen offset:1024 sc1
    v_mfma_f32_32x32x16_bf16 v[160:175], a[92:95], a[12:15], v[160:175]
    s_waitcnt vmcnt(8) lgkmcnt(14)
    v_mfma_f32_32x32x16_bf16 v[128:143], a[96:99], a[16:19], v[128:143]
    buffer_load_dwordx4 a[52:55], v28, s[28:31], s75 offen offset:2048 sc1
    v_mfma_f32_32x32x16_bf16 v[160:175], a[100:103], a[16:19], v[160:175]
    s_waitcnt vmcnt(8) lgkmcnt(14)
    v_mfma_f32_32x32x16_bf16 v[128:143], a[104:107], a[20:23], v[128:143]
    buffer_load_dwordx4 a[56:59], v28, s[28:31], s75 offen offset:3072 sc1
    v_mfma_f32_32x32x16_bf16 v[160:175], a[108:111], a[20:23], v[160:175]
    s_waitcnt vmcnt(8) lgkmcnt(14)
    v_mfma_f32_32x32x16_bf16 v[128:143], a[112:115], a[24:27], v[128:143]
    s_add_u32 s75, s75, 4096
    buffer_load_dwordx4 a[60:63], v28, s[28:31], s75 offen offset:0 sc1
    v_mfma_f32_32x32x16_bf16 v[160:175], a[116:119], a[24:27], v[160:175]
    s_waitcnt vmcnt(8) lgkmcnt(12)
    v_mfma_f32_32x32x16_bf16 v[128:143], a[120:123], a[28:31], v[128:143]
    buffer_load_dwordx4 v[192:195], v28, s[28:31], s75 offen offset:1024 sc1
    v_mfma_f32_32x32x16_bf16 v[160:175], a[124:127], a[28:31], v[160:175]
    s_waitcnt vmcnt(8) lgkmcnt(8)
    v_mfma_f32_32x32x16_bf16 v[128:143], v[40:43], a[32:35], v[128:143]
    buffer_load_dwordx4 v[196:199], v28, s[28:31], s75 offen offset:2048 sc1
    v_mfma_f32_32x32x16_bf16 v[160:175], v[44:47], a[32:35], v[160:175]
    s_waitcnt vmcnt(8) lgkmcnt(4)
    v_mfma_f32_32x32x16_bf16 v[128:143], v[48:51], a[36:39], v[128:143]
    buffer_load_dwordx4 v[200:203], v28, s[28:31], s75 offen offset:3072 sc1
    v_mfma_f32_32x32x16_bf16 v[160:175], v[52:55], a[36:39], v[160:175]
    s_waitcnt vmcnt(8) lgkmcnt(0)
    v_mfma_f32_32x32x16_bf16 v[128:143], v[56:59], a[40:43], v[128:143]
    s_add_u32 s75, s75, 4096
    buffer_load_dwordx4 v[204:207], v28, s[28:31], s75 offen offset:0 sc1
    v_mfma_f32_32x32x16_bf16 v[160:175], v[60:63], a[40:43], v[160:175]
    s_waitcnt vmcnt(8)
    v_mfma_f32_32x32x16_bf16 v[144:159], a[64:67], a[44:47], v[144:159]
    buffer_load_dwordx4 v[208:211], v28, s[28:31], s75 offen offset:1024 sc1
    v_mfma_f32_32x32x16_bf16 v[176:191], a[68:71], a[44:47], v[176:191]
    s_waitcnt vmcnt(8)
    v_mfma_f32_32x32x16_bf16 v[144:159], a[72:75], a[48:51], v[144:159]
    s_cmp_eq_u32 s4, 3
    s_cselect_b32 s75, 2147418112, s75
    buffer_load_dwordx4 v[212:215], v28, s[28:31], s75 offen offset:2048 sc1
    ds_write_b128 v2, v[128:131] offset:18432
    v_mfma_f32_32x32x16_bf16 v[176:191], a[76:79], a[48:51], v[176:191]
    ds_write_b128 v2, v[132:135] offset:18464
    s_waitcnt vmcnt(8)
    v_mfma_f32_32x32x16_bf16 v[144:159], a[80:83], a[52:55], v[144:159]
    ds_write_b128 v2, v[136:139] offset:18496
    v_mfma_f32_32x32x16_bf16 v[176:191], a[84:87], a[52:55], v[176:191]
    ds_write_b128 v2, v[140:143] offset:18528
    s_waitcnt vmcnt(7)
    v_mfma_f32_32x32x16_bf16 v[144:159], a[88:91], a[56:59], v[144:159]
    ds_write_b128 v2, v[160:163] offset:18560
    v_mfma_f32_32x32x16_bf16 v[176:191], a[92:95], a[56:59], v[176:191]
    ds_write_b128 v2, v[164:167] offset:18592
    s_waitcnt vmcnt(6)
    v_mfma_f32_32x32x16_bf16 v[144:159], a[96:99], a[60:63], v[144:159]
    ds_write_b128 v2, v[168:171] offset:18624
    v_mfma_f32_32x32x16_bf16 v[176:191], a[100:103], a[60:63], v[176:191]
    ds_write_b128 v2, v[172:175] offset:18656
    s_waitcnt vmcnt(5)
    v_mfma_f32_32x32x16_bf16 v[144:159], a[104:107], v[192:195], v[144:159]
    v_mfma_f32_32x32x16_bf16 v[176:191], a[108:111], v[192:195], v[176:191]
    s_waitcnt vmcnt(4)
    v_mfma_f32_32x32x16_bf16 v[144:159], a[112:115], v[196:199], v[144:159]
    v_mfma_f32_32x32x16_bf16 v[176:191], a[116:119], v[196:199], v[176:191]
    s_waitcnt vmcnt(3)
    v_mfma_f32_32x32x16_bf16 v[144:159], a[120:123], v[200:203], v[144:159]
    v_mfma_f32_32x32x16_bf16 v[176:191], a[124:127], v[200:203], v[176:191]
    s_waitcnt lgkmcnt(0)
    s_barrier
    ds_read_b128 v[64:67], v3 offset:0
    ds_read_b128 v[68:71], v3 offset:16
    ds_read_b128 v[72:75], v3 offset:40960
    ds_read_b128 v[76:79], v3 offset:40976
    ds_read_b128 v[80:83], v4 offset:0
    ds_read_b128 v[84:87], v4 offset:16
    ds_read_b128 v[88:91], v4 offset:40960
    ds_read_b128 v[92:95], v4 offset:40976
    s_waitcnt vmcnt(2)
    v_mfma_f32_32x32x16_bf16 v[144:159], v[40:43], v[204:207], v[144:159]
    v_mfma_f32_32x32x16_bf16 v[176:191], v[44:47], v[204:207], v[176:191]
    s_waitcnt vmcnt(1)
    v_mfma_f32_32x32x16_bf16 v[144:159], v[48:51], v[208:211], v[144:159]
    v_mfma_f32_32x32x16_bf16 v[176:191], v[52:55], v[208:211], v[176:191]
    s_waitcnt vmcnt(0)
    v_mfma_f32_32x32x16_bf16 v[144:159], v[56:59], v[212:215], v[144:159]
    v_mfma_f32_32x32x16_bf16 v[176:191], v[60:63], v[212:215], v[176:191]
    s_nop 10
    ds_write_b128 v2, v[144:147] offset:27136
    ds_write_b128 v2, v[148:151] offset:27168
    ds_write_b128 v2, v[152:155] offset:27200
    ds_write_b128 v2, v[156:159] offset:27232
    ds_write_b128 v2, v[176:179] offset:27264
    ds_write_b128 v2, v[180:183] offset:27296
    ds_write_b128 v2, v[184:187] offset:27328
    ds_write_b128 v2, v[188:191] offset:27360
    s_waitcnt lgkmcnt(14)
    v_pk_add_f32 v[112:113], v[112:113], v[64:65]
    v_pk_add_f32 v[114:115], v[114:115], v[66:67]
    v_pk_add_f32 v[116:117], v[116:117], v[68:69]
    v_pk_add_f32 v[118:119], v[118:119], v[70:71]
    s_waitcnt lgkmcnt(12)
    v_pk_add_f32 v[112:113], v[112:113], v[72:73]
    v_pk_add_f32 v[114:115], v[114:115], v[74:75]
    v_pk_add_f32 v[116:117], v[116:117], v[76:77]
    v_pk_add_f32 v[118:119], v[118:119], v[78:79]
    s_waitcnt lgkmcnt(10)
    v_pk_add_f32 v[112:113], v[112:113], v[80:81]
    v_pk_add_f32 v[114:115], v[114:115], v[82:83]
    v_pk_add_f32 v[116:117], v[116:117], v[84:85]
    v_pk_add_f32 v[118:119], v[118:119], v[86:87]
    s_waitcnt lgkmcnt(8)
    v_pk_add_f32 v[112:113], v[112:113], v[88:89]
    v_pk_add_f32 v[114:115], v[114:115], v[90:91]
    v_pk_add_f32 v[116:117], v[116:117], v[92:93]
    v_pk_add_f32 v[118:119], v[118:119], v[94:95]
    v_cvt_pk_bf16_f32 v96, v112, v113
    v_cvt_pk_bf16_f32 v97, v114, v115
    v_cvt_pk_bf16_f32 v98, v116, v117
    v_cvt_pk_bf16_f32 v99, v118, v119
    buffer_store_dwordx4 v[96:99], v30, s[40:43], 0 offen sc1
    s_waitcnt lgkmcnt(0)
    s_barrier
    ds_read_b128 v[32:35], v3 offset:8704
    ds_read_b128 v[36:39], v3 offset:8720
    ds_read_b128 v[40:43], v3 offset:49664
    ds_read_b128 v[44:47], v3 offset:49680
    ds_read_b128 v[48:51], v4 offset:8704
    ds_read_b128 v[52:55], v4 offset:8720
    ds_read_b128 v[56:59], v4 offset:49664
    ds_read_b128 v[60:63], v4 offset:49680
    s_waitcnt lgkmcnt(6)
    v_pk_add_f32 v[120:121], v[120:121], v[32:33]
    v_pk_add_f32 v[122:123], v[122:123], v[34:35]
    v_pk_add_f32 v[124:125], v[124:125], v[36:37]
    v_pk_add_f32 v[126:127], v[126:127], v[38:39]
    s_waitcnt lgkmcnt(4)
    v_pk_add_f32 v[120:121], v[120:121], v[40:41]
    v_pk_add_f32 v[122:123], v[122:123], v[42:43]
    v_pk_add_f32 v[124:125], v[124:125], v[44:45]
    v_pk_add_f32 v[126:127], v[126:127], v[46:47]
    s_waitcnt lgkmcnt(2)
    v_pk_add_f32 v[120:121], v[120:121], v[48:49]
    v_pk_add_f32 v[122:123], v[122:123], v[50:51]
    v_pk_add_f32 v[124:125], v[124:125], v[52:53]
    v_pk_add_f32 v[126:127], v[126:127], v[54:55]
    s_waitcnt lgkmcnt(0)
    v_pk_add_f32 v[120:121], v[120:121], v[56:57]
    v_pk_add_f32 v[122:123], v[122:123], v[58:59]
    v_pk_add_f32 v[124:125], v[124:125], v[60:61]
    v_pk_add_f32 v[126:127], v[126:127], v[62:63]
    v_cvt_pk_bf16_f32 v100, v120, v121
    v_cvt_pk_bf16_f32 v101, v122, v123
    v_cvt_pk_bf16_f32 v102, v124, v125
    v_cvt_pk_bf16_f32 v103, v126, v127
    buffer_store_dwordx4 v[100:103], v31, s[40:43], 0 offen sc1
    s_endpgm
.Lrest_z:
    s_waitcnt vmcnt(13)
    v_add_u32 v86, 1, v86
    s_nop 0
    v_readfirstlane_b32 s11, v86
    s_barrier
    s_cmp_lg_u32 s4, 0
    s_cbranch_scc1 .nw0_z_1
    s_mov_b64 exec, 1
    s_lshl_b32 s58, s5, 8
    s_lshl_b32 s59, s6, 3
    s_add_u32 s58, s58, s59
    s_add_u32 s58, s58, 4096
    v_mov_b32 v2, s11
    v_mov_b32 v3, s13
    v_mov_b32 v11, 0
    buffer_store_dwordx2 v[2:3], v11, s[28:31], s58 offen sc1
    s_mov_b64 exec, -1
.nw0_z_1:
    ds_read_b64_tr_b16 v[32:33], v16 offset:0
    ds_read_b64_tr_b16 v[34:35], v16 offset:768
    ds_read_b64_tr_b16 v[36:37], v17 offset:0
    ds_read_b64_tr_b16 v[38:39], v17 offset:768
    ds_read_b64_tr_b16 v[40:41], v18 offset:0
    ds_read_b64_tr_b16 v[42:43], v18 offset:768
    ds_read_b64_tr_b16 v[44:45], v19 offset:0
    ds_read_b64_tr_b16 v[46:47], v19 offset:768
    s_waitcnt lgkmcnt(4)
    v_mfma_f32_16x16x32_bf16 v[96:99], v[32:35], a[0:3], 0
    ds_read_b64_tr_b16 v[48:49], v64 offset:0
    ds_read_b64_tr_b16 v[50:51], v64 offset:768
    v_mfma_f32_16x16x32_bf16 v[100:103], v[32:35], a[4:7], 0
    s_add_u32 m0, s55, 24576
    s_add_u32 s1, s53, 352256
    v_mfma_f32_16x16x32_bf16 v[88:91], v[32:35], v[20:23], 0
    v_mfma_f32_16x16x32_bf16 v[104:107], v[36:39], a[0:3], 0
    ds_read_b64_tr_b16 v[52:53], v65 offset:0
    ds_read_b64_tr_b16 v[54:55], v65 offset:768
    v_mfma_f32_16x16x32_bf16 v[108:111], v[36:39], a[4:7], 0
    buffer_load_dwordx4 v8, s[20:23], s1 offen offset:0 lds
    v_mfma_f32_16x16x32_bf16 v[92:95], v[36:39], v[20:23], 0
    s_waitcnt lgkmcnt(4)
    v_mfma_f32_16x16x32_bf16 v[112:115], v[40:43], a[0:3], 0
    ds_read_b64_tr_b16 v[56:57], v16 offset:6144
    ds_read_b64_tr_b16 v[58:59], v16 offset:6912
    v_mfma_f32_16x16x32_bf16 v[116:119], v[40:43], a[4:7], 0
    v_mfma_f32_16x16x32_bf16 v[120:123], v[44:47], a[0:3], 0
    ds_read_b64_tr_b16 v[60:61], v17 offset:6144
    ds_read_b64_tr_b16 v[62:63], v17 offset:6912
    v_mfma_f32_16x16x32_bf16 v[124:127], v[44:47], a[4:7], 0
    buffer_load_dwordx4 v9, s[20:23], s1 offen offset:1024 lds
    s_waitcnt lgkmcnt(4)
    v_mfma_f32_16x16x32_bf16 v[128:131], v[48:51], a[0:3], 0
    ds_read_b64_tr_b16 v[32:33], v18 offset:6144
    ds_read_b64_tr_b16 v[34:35], v18 offset:6912
    v_mfma_f32_16x16x32_bf16 v[132:135], v[48:51], a[4:7], 0
    v_mfma_f32_16x16x32_bf16 v[136:139], v[52:55], a[0:3], 0
    ds_read_b64_tr_b16 v[36:37], v19 offset:6144
    ds_read_b64_tr_b16 v[38:39], v19 offset:6912
    v_mfma_f32_16x16x32_bf16 v[140:143], v[52:55], a[4:7], 0
    buffer_load_dwordx4 v10, s[20:23], s1 offen offset:2048 lds
    s_waitcnt vmcnt(12)
    ds_read_b128 a[64:67], v80 offset:0
    ds_read_b128 a[68:71], v80 offset:2048
    ds_read_b128 a[72:75], v81 offset:0
    ds_read_b128 a[76:79], v81 offset:2048
    s_waitcnt lgkmcnt(8)
    v_mfma_f32_16x16x32_bf16 v[96:99], v[56:59], a[8:11], v[96:99]
    ds_read_b64_tr_b16 v[40:41], v64 offset:6144
    ds_read_b64_tr_b16 v[42:43], v64 offset:6912
    v_mfma_f32_16x16x32_bf16 v[100:103], v[56:59], a[12:15], v[100:103]
    s_add_u32 m0, s54, 8192
    s_add_u32 s0, s52, 768
    v_mfma_f32_16x16x32_bf16 v[88:91], v[56:59], v[20:23], v[88:91]
    v_mfma_f32_16x16x32_bf16 v[104:107], v[60:63], a[8:11], v[104:107]
    ds_read_b64_tr_b16 v[44:45], v65 offset:6144
    ds_read_b64_tr_b16 v[46:47], v65 offset:6912
    v_mfma_f32_16x16x32_bf16 v[108:111], v[60:63], a[12:15], v[108:111]
    buffer_load_dwordx4 v4, s[16:19], s0 offen offset:0 lds
    v_mfma_f32_16x16x32_bf16 v[92:95], v[60:63], v[20:23], v[92:95]
    s_waitcnt lgkmcnt(8)
    v_mfma_f32_16x16x32_bf16 v[112:115], v[32:35], a[8:11], v[112:115]
    s_waitcnt vmcnt(10)
    s_barrier
    ds_read_b64_tr_b16 v[48:49], v16 offset:12288
    ds_read_b64_tr_b16 v[50:51], v16 offset:13056
    v_mfma_f32_16x16x32_bf16 v[116:119], v[32:35], a[12:15], v[116:119]
    buffer_load_dwordx4 v5, s[16:19], s0 offen offset:1024 lds
    v_mfma_f32_16x16x32_bf16 v[120:123], v[36:39], a[8:11], v[120:123]
    ds_read_b64_tr_b16 v[52:53], v17 offset:12288
    ds_read_b64_tr_b16 v[54:55], v17 offset:13056
    v_mfma_f32_16x16x32_bf16 v[124:127], v[36:39], a[12:15], v[124:127]
    s_waitcnt lgkmcnt(4)
    v_mfma_f32_16x16x32_bf16 v[128:131], v[40:43], a[8:11], v[128:131]
    ds_read_b64_tr_b16 v[56:57], v18 offset:12288
    ds_read_b64_tr_b16 v[58:59], v18 offset:13056
    v_mfma_f32_16x16x32_bf16 v[132:135], v[40:43], a[12:15], v[132:135]
    buffer_load_dwordx4 v6, s[16:19], s0 offen offset:2048 lds
    v_mfma_f32_16x16x32_bf16 v[136:139], v[44:47], a[8:11], v[136:139]
    ds_read_b64_tr_b16 v[60:61], v19 offset:12288
    ds_read_b64_tr_b16 v[62:63], v19 offset:13056
    v_mfma_f32_16x16x32_bf16 v[140:143], v[44:47], a[12:15], v[140:143]
    v_mfma_f32_4x4x4_16b_bf16 v[144:147], a[64:65], a[64:65], v[144:147]
    v_mfma_f32_4x4x4_16b_bf16 v[148:151], a[68:69], a[68:69], v[148:151]
    v_mfma_f32_4x4x4_16b_bf16 v[152:155], a[66:67], a[66:67], v[152:155]
    v_mfma_f32_4x4x4_16b_bf16 v[156:159], a[70:71], a[70:71], v[156:159]
    v_mfma_f32_4x4x4_16b_bf16 v[144:147], a[72:73], a[72:73], v[144:147]
    v_mfma_f32_4x4x4_16b_bf16 v[148:151], a[76:77], a[76:77], v[148:151]
    v_mfma_f32_4x4x4_16b_bf16 v[152:155], a[74:75], a[74:75], v[152:155]
    v_mfma_f32_4x4x4_16b_bf16 v[156:159], a[78:79], a[78:79], v[156:159]
    v_mfma_f32_16x16x32_bf16 v[160:163], v[20:23], a[64:67], v[160:163]
    v_mfma_f32_16x16x32_bf16 v[164:167], v[20:23], a[68:71], v[164:167]
    v_mfma_f32_16x16x32_bf16 v[160:163], v[20:23], a[72:75], v[160:163]
    v_mfma_f32_16x16x32_bf16 v[164:167], v[20:23], a[76:79], v[164:167]
    s_waitcnt lgkmcnt(4)
    v_mfma_f32_16x16x32_bf16 v[96:99], v[48:51], a[16:19], v[96:99]
    ds_read_b64_tr_b16 v[32:33], v64 offset:12288
    ds_read_b64_tr_b16 v[34:35], v64 offset:13056
    v_mfma_f32_16x16x32_bf16 v[100:103], v[48:51], a[20:23], v[100:103]
    buffer_load_dwordx4 v7, s[16:19], s0 offen offset:3072 lds
    v_mfma_f32_16x16x32_bf16 v[88:91], v[48:51], v[20:23], v[88:91]
    v_mfma_f32_16x16x32_bf16 v[104:107], v[52:55], a[16:19], v[104:107]
    ds_read_b64_tr_b16 v[36:37], v65 offset:12288
    ds_read_b64_tr_b16 v[38:39], v65 offset:13056
    v_mfma_f32_16x16x32_bf16 v[108:111], v[52:55], a[20:23], v[108:111]
    s_add_u32 m0, s55, 36864
    s_add_u32 s1, s53, 528384
    v_mfma_f32_16x16x32_bf16 v[92:95], v[52:55], v[20:23], v[92:95]
    s_waitcnt lgkmcnt(4)
    v_mfma_f32_16x16x32_bf16 v[112:115], v[56:59], a[16:19], v[112:115]
    ds_read_b64_tr_b16 v[40:41], v16 offset:18432
    ds_read_b64_tr_b16 v[42:43], v16 offset:19200
    v_mfma_f32_16x16x32_bf16 v[116:119], v[56:59], a[20:23], v[116:119]
    buffer_load_dwordx4 v8, s[20:23], s1 offen offset:0 lds
    v_mfma_f32_16x16x32_bf16 v[120:123], v[60:63], a[16:19], v[120:123]
    ds_read_b64_tr_b16 v[44:45], v17 offset:18432
    ds_read_b64_tr_b16 v[46:47], v17 offset:19200
    v_mfma_f32_16x16x32_bf16 v[124:127], v[60:63], a[20:23], v[124:127]
    s_waitcnt lgkmcnt(4)
    v_mfma_f32_16x16x32_bf16 v[128:131], v[32:35], a[16:19], v[128:131]
    ds_read_b64_tr_b16 v[48:49], v18 offset:18432
    ds_read_b64_tr_b16 v[50:51], v18 offset:19200
    v_mfma_f32_16x16x32_bf16 v[132:135], v[32:35], a[20:23], v[132:135]
    buffer_load_dwordx4 v9, s[20:23], s1 offen offset:1024 lds
    v_mfma_f32_16x16x32_bf16 v[136:139], v[36:39], a[16:19], v[136:139]
    ds_read_b64_tr_b16 v[52:53], v19 offset:18432
    ds_read_b64_tr_b16 v[54:55], v19 offset:19200
    v_mfma_f32_16x16x32_bf16 v[140:143], v[36:39], a[20:23], v[140:143]
    s_waitcnt vmcnt(11)
    ds_read_b128 a[80:83], v80 offset:4096
    ds_read_b128 a[84:87], v80 offset:6144
    ds_read_b128 a[88:91], v81 offset:4096
    ds_read_b128 a[92:95], v81 offset:6144
    s_waitcnt lgkmcnt(8)
    v_mfma_f32_16x16x32_bf16 v[96:99], v[40:43], a[24:27], v[96:99]
    ds_read_b64_tr_b16 v[56:57], v64 offset:18432
    ds_read_b64_tr_b16 v[58:59], v64 offset:19200
    v_mfma_f32_16x16x32_bf16 v[100:103], v[40:43], a[28:31], v[100:103]
    buffer_load_dwordx4 v10, s[20:23], s1 offen offset:2048 lds
    v_mfma_f32_16x16x32_bf16 v[88:91], v[40:43], v[20:23], v[88:91]
    v_mfma_f32_16x16x32_bf16 v[104:107], v[44:47], a[24:27], v[104:107]
    ds_read_b64_tr_b16 v[60:61], v65 offset:18432
    ds_read_b64_tr_b16 v[62:63], v65 offset:19200
    v_mfma_f32_16x16x32_bf16 v[108:111], v[44:47], a[28:31], v[108:111]
    s_add_u32 m0, s54, 12288
    s_add_u32 s0, s52, 896
    v_mfma_f32_16x16x32_bf16 v[92:95], v[44:47], v[20:23], v[92:95]
    s_waitcnt lgkmcnt(8)
    v_mfma_f32_16x16x32_bf16 v[112:115], v[48:51], a[24:27], v[112:115]
    buffer_load_dwordx4 v4, s[16:19], s0 offen offset:0 lds
    buffer_load_dwordx4 v5, s[16:19], s0 offen offset:1024 lds
    buffer_load_dwordx4 v6, s[16:19], s0 offen offset:2048 lds
    buffer_load_dwordx4 v7, s[16:19], s0 offen offset:3072 lds
    s_add_u32 m0, s55, 49152
    s_add_u32 s1, s53, 704512
    s_waitcnt vmcnt(11)
    s_barrier
    ds_read_b64_tr_b16 v[32:33], v16 offset:24576
    ds_read_b64_tr_b16 v[34:35], v16 offset:25344
    v_mfma_f32_16x16x32_bf16 v[116:119], v[48:51], a[28:31], v[116:119]
    buffer_load_dwordx4 v8, s[20:23], s1 offen offset:0 lds
    v_mfma_f32_16x16x32_bf16 v[120:123], v[52:55], a[24:27], v[120:123]
    ds_read_b64_tr_b16 v[36:37], v17 offset:24576
    ds_read_b64_tr_b16 v[38:39], v17 offset:25344
    v_mfma_f32_16x16x32_bf16 v[124:127], v[52:55], a[28:31], v[124:127]
    s_waitcnt lgkmcnt(4)
    v_mfma_f32_16x16x32_bf16 v[128:131], v[56:59], a[24:27], v[128:131]
    ds_read_b64_tr_b16 v[40:41], v18 offset:24576
    ds_read_b64_tr_b16 v[42:43], v18 offset:25344
    v_mfma_f32_16x16x32_bf16 v[132:135], v[56:59], a[28:31], v[132:135]
    buffer_load_dwordx4 v9, s[20:23], s1 offen offset:1024 lds
    v_mfma_f32_16x16x32_bf16 v[136:139], v[60:63], a[24:27], v[136:139]
    ds_read_b64_tr_b16 v[44:45], v19 offset:24576
    ds_read_b64_tr_b16 v[46:47], v19 offset:25344
    v_mfma_f32_16x16x32_bf16 v[140:143], v[60:63], a[28:31], v[140:143]
    v_mfma_f32_4x4x4_16b_bf16 v[144:147], a[80:81], a[80:81], v[144:147]
    v_mfma_f32_4x4x4_16b_bf16 v[148:151], a[84:85], a[84:85], v[148:151]
    v_mfma_f32_4x4x4_16b_bf16 v[152:155], a[82:83], a[82:83], v[152:155]
    v_mfma_f32_4x4x4_16b_bf16 v[156:159], a[86:87], a[86:87], v[156:159]
    v_mfma_f32_4x4x4_16b_bf16 v[144:147], a[88:89], a[88:89], v[144:147]
    v_mfma_f32_4x4x4_16b_bf16 v[148:151], a[92:93], a[92:93], v[148:151]
    v_mfma_f32_4x4x4_16b_bf16 v[152:155], a[90:91], a[90:91], v[152:155]
    v_mfma_f32_4x4x4_16b_bf16 v[156:159], a[94:95], a[94:95], v[156:159]
    v_mfma_f32_16x16x32_bf16 v[160:163], v[20:23], a[80:83], v[160:163]
    v_mfma_f32_16x16x32_bf16 v[164:167], v[20:23], a[84:87], v[164:167]
    v_mfma_f32_16x16x32_bf16 v[160:163], v[20:23], a[88:91], v[160:163]
    v_mfma_f32_16x16x32_bf16 v[164:167], v[20:23], a[92:95], v[164:167]
    s_waitcnt lgkmcnt(4)
    v_mfma_f32_16x16x32_bf16 v[96:99], v[32:35], a[32:35], v[96:99]
    ds_read_b64_tr_b16 v[48:49], v64 offset:24576
    ds_read_b64_tr_b16 v[50:51], v64 offset:25344
    v_mfma_f32_16x16x32_bf16 v[100:103], v[32:35], a[36:39], v[100:103]
    buffer_load_dwordx4 v10, s[20:23], s1 offen offset:2048 lds
    v_mfma_f32_16x16x32_bf16 v[88:91], v[32:35], v[20:23], v[88:91]
    v_mfma_f32_16x16x32_bf16 v[104:107], v[36:39], a[32:35], v[104:107]
    ds_read_b64_tr_b16 v[52:53], v65 offset:24576
    ds_read_b64_tr_b16 v[54:55], v65 offset:25344
    v_mfma_f32_16x16x32_bf16 v[108:111], v[36:39], a[36:39], v[108:111]
    s_add_u32 m0, s55, 0
    s_add_u32 s1, s53, 880640
    v_mfma_f32_16x16x32_bf16 v[92:95], v[36:39], v[20:23], v[92:95]
    s_waitcnt lgkmcnt(4)
    v_mfma_f32_16x16x32_bf16 v[112:115], v[40:43], a[32:35], v[112:115]
    ds_read_b64_tr_b16 v[56:57], v16 offset:30720
    ds_read_b64_tr_b16 v[58:59], v16 offset:31488
    v_mfma_f32_16x16x32_bf16 v[116:119], v[40:43], a[36:39], v[116:119]
    buffer_load_dwordx4 v8, s[20:23], s1 offen offset:0 lds
    v_mfma_f32_16x16x32_bf16 v[120:123], v[44:47], a[32:35], v[120:123]
    ds_read_b64_tr_b16 v[60:61], v17 offset:30720
    ds_read_b64_tr_b16 v[62:63], v17 offset:31488
    v_mfma_f32_16x16x32_bf16 v[124:127], v[44:47], a[36:39], v[124:127]
    s_waitcnt lgkmcnt(4)
    v_mfma_f32_16x16x32_bf16 v[128:131], v[48:51], a[32:35], v[128:131]
    ds_read_b64_tr_b16 v[32:33], v18 offset:30720
    ds_read_b64_tr_b16 v[34:35], v18 offset:31488
    v_mfma_f32_16x16x32_bf16 v[132:135], v[48:51], a[36:39], v[132:135]
    buffer_load_dwordx4 v9, s[20:23], s1 offen offset:1024 lds
    v_mfma_f32_16x16x32_bf16 v[136:139], v[52:55], a[32:35], v[136:139]
    ds_read_b64_tr_b16 v[36:37], v19 offset:30720
    ds_read_b64_tr_b16 v[38:39], v19 offset:31488
    v_mfma_f32_16x16x32_bf16 v[140:143], v[52:55], a[36:39], v[140:143]
    s_waitcnt vmcnt(12)
    ds_read_b128 a[96:99], v80 offset:8192
    ds_read_b128 a[100:103], v80 offset:10240
    ds_read_b128 a[104:107], v81 offset:8192
    ds_read_b128 a[108:111], v81 offset:10240
    s_waitcnt lgkmcnt(8)
    v_mfma_f32_16x16x32_bf16 v[96:99], v[56:59], a[40:43], v[96:99]
    ds_read_b64_tr_b16 v[40:41], v64 offset:30720
    ds_read_b64_tr_b16 v[42:43], v64 offset:31488
    v_mfma_f32_16x16x32_bf16 v[100:103], v[56:59], a[44:47], v[100:103]
    buffer_load_dwordx4 v10, s[20:23], s1 offen offset:2048 lds
    v_mfma_f32_16x16x32_bf16 v[88:91], v[56:59], v[20:23], v[88:91]
    v_mfma_f32_16x16x32_bf16 v[104:107], v[60:63], a[40:43], v[104:107]
    ds_read_b64_tr_b16 v[44:45], v65 offset:30720
    ds_read_b64_tr_b16 v[46:47], v65 offset:31488
    v_mfma_f32_16x16x32_bf16 v[108:111], v[60:63], a[44:47], v[108:111]
    v_mfma_f32_16x16x32_bf16 v[92:95], v[60:63], v[20:23], v[92:95]
    s_waitcnt lgkmcnt(8)
    v_mfma_f32_16x16x32_bf16 v[112:115], v[32:35], a[40:43], v[112:115]
    s_waitcnt vmcnt(10)
    s_barrier
    ds_read_b64_tr_b16 v[48:49], v16 offset:36864
    ds_read_b64_tr_b16 v[50:51], v16 offset:37632
    v_mfma_f32_16x16x32_bf16 v[116:119], v[32:35], a[44:47], v[116:119]
    s_add_u32 m0, s55, 12288
    s_add_u32 s1, s53, 1056768
    v_mfma_f32_16x16x32_bf16 v[120:123], v[36:39], a[40:43], v[120:123]
    ds_read_b64_tr_b16 v[52:53], v17 offset:36864
    ds_read_b64_tr_b16 v[54:55], v17 offset:37632
    v_mfma_f32_16x16x32_bf16 v[124:127], v[36:39], a[44:47], v[124:127]
    buffer_load_dwordx4 v8, s[20:23], s1 offen offset:0 lds
    s_waitcnt lgkmcnt(4)
    v_mfma_f32_16x16x32_bf16 v[128:131], v[40:43], a[40:43], v[128:131]
    ds_read_b64_tr_b16 v[56:57], v18 offset:36864
    ds_read_b64_tr_b16 v[58:59], v18 offset:37632
    v_mfma_f32_16x16x32_bf16 v[132:135], v[40:43], a[44:47], v[132:135]
    v_mfma_f32_16x16x32_bf16 v[136:139], v[44:47], a[40:43], v[136:139]
    ds_read_b64_tr_b16 v[60:61], v19 offset:36864
    ds_read_b64_tr_b16 v[62:63], v19 offset:37632
    v_mfma_f32_16x16x32_bf16 v[140:143], v[44:47], a[44:47], v[140:143]
    buffer_load_dwordx4 v9, s[20:23], s1 offen offset:1024 lds
    v_mfma_f32_4x4x4_16b_bf16 v[144:147], a[96:97], a[96:97], v[144:147]
    v_mfma_f32_4x4x4_16b_bf16 v[148:151], a[100:101], a[100:101], v[148:151]
    v_mfma_f32_4x4x4_16b_bf16 v[152:155], a[98:99], a[98:99], v[152:155]
    v_mfma_f32_4x4x4_16b_bf16 v[156:159], a[102:103], a[102:103], v[156:159]
    v_mfma_f32_4x4x4_16b_bf16 v[144:147], a[104:105], a[104:105], v[144:147]
    v_mfma_f32_4x4x4_16b_bf16 v[148:151], a[108:109], a[108:109], v[148:151]
    v_mfma_f32_4x4x4_16b_bf16 v[152:155], a[106:107], a[106:107], v[152:155]
    v_mfma_f32_4x4x4_16b_bf16 v[156:159], a[110:111], a[110:111], v[156:159]
    v_mfma_f32_16x16x32_bf16 v[160:163], v[20:23], a[96:99], v[160:163]
    v_mfma_f32_16x16x32_bf16 v[164:167], v[20:23], a[100:103], v[164:167]
    v_mfma_f32_16x16x32_bf16 v[160:163], v[20:23], a[104:107], v[160:163]
    v_mfma_f32_16x16x32_bf16 v[164:167], v[20:23], a[108:111], v[164:167]
    s_waitcnt lgkmcnt(4)
    v_mfma_f32_16x16x32_bf16 v[96:99], v[48:51], a[48:51], v[96:99]
    ds_read_b64_tr_b16 v[32:33], v64 offset:36864
    ds_read_b64_tr_b16 v[34:35], v64 offset:37632
    v_mfma_f32_16x16x32_bf16 v[100:103], v[48:51], a[52:55], v[100:103]
    buffer_load_dwordx4 v10, s[20:23], s1 offen offset:2048 lds
    v_mfma_f32_16x16x32_bf16 v[88:91], v[48:51], v[20:23], v[88:91]
    v_mfma_f32_16x16x32_bf16 v[104:107], v[52:55], a[48:51], v[104:107]
    ds_read_b64_tr_b16 v[36:37], v65 offset:36864
    ds_read_b64_tr_b16 v[38:39], v65 offset:37632
    v_mfma_f32_16x16x32_bf16 v[108:111], v[52:55], a[52:55], v[108:111]
    v_mfma_f32_16x16x32_bf16 v[92:95], v[52:55], v[20:23], v[92:95]
    s_waitcnt lgkmcnt(4)
    v_mfma_f32_16x16x32_bf16 v[112:115], v[56:59], a[48:51], v[112:115]
    ds_read_b64_tr_b16 v[40:41], v16 offset:43008
    ds_read_b64_tr_b16 v[42:43], v16 offset:43776
    v_mfma_f32_16x16x32_bf16 v[116:119], v[56:59], a[52:55], v[116:119]
    v_mfma_f32_16x16x32_bf16 v[120:123], v[60:63], a[48:51], v[120:123]
    ds_read_b64_tr_b16 v[44:45], v17 offset:43008
    ds_read_b64_tr_b16 v[46:47], v17 offset:43776
    v_mfma_f32_16x16x32_bf16 v[124:127], v[60:63], a[52:55], v[124:127]
    s_waitcnt lgkmcnt(4)
    v_mfma_f32_16x16x32_bf16 v[128:131], v[32:35], a[48:51], v[128:131]
    ds_read_b64_tr_b16 v[48:49], v18 offset:43008
    ds_read_b64_tr_b16 v[50:51], v18 offset:43776
    v_mfma_f32_16x16x32_bf16 v[132:135], v[32:35], a[52:55], v[132:135]
    v_mfma_f32_16x16x32_bf16 v[136:139], v[36:39], a[48:51], v[136:139]
    ds_read_b64_tr_b16 v[52:53], v19 offset:43008
    ds_read_b64_tr_b16 v[54:55], v19 offset:43776
    v_mfma_f32_16x16x32_bf16 v[140:143], v[36:39], a[52:55], v[140:143]
    s_waitcnt vmcnt(9)
    ds_read_b128 a[112:115], v80 offset:12288
    ds_read_b128 a[116:119], v80 offset:14336
    ds_read_b128 a[120:123], v81 offset:12288
    ds_read_b128 a[124:127], v81 offset:14336
    s_waitcnt lgkmcnt(8)
    v_mfma_f32_16x16x32_bf16 v[96:99], v[40:43], a[56:59], v[96:99]
    ds_read_b64_tr_b16 v[56:57], v64 offset:43008
    ds_read_b64_tr_b16 v[58:59], v64 offset:43776
    v_mfma_f32_16x16x32_bf16 v[100:103], v[40:43], a[60:63], v[100:103]
    v_mfma_f32_16x16x32_bf16 v[88:91], v[40:43], v[20:23], v[88:91]
    v_mfma_f32_16x16x32_bf16 v[104:107], v[44:47], a[56:59], v[104:107]
    ds_read_b64_tr_b16 v[60:61], v65 offset:43008
    ds_read_b64_tr_b16 v[62:63], v65 offset:43776
    v_mfma_f32_16x16x32_bf16 v[108:111], v[44:47], a[60:63], v[108:111]
    v_mfma_f32_16x16x32_bf16 v[92:95], v[44:47], v[20:23], v[92:95]
    s_waitcnt lgkmcnt(8)
    v_mfma_f32_16x16x32_bf16 v[112:115], v[48:51], a[56:59], v[112:115]
    s_waitcnt vmcnt(6)
    s_barrier
    ds_read_b64_tr_b16 v[32:33], v16 offset:49152
    ds_read_b64_tr_b16 v[34:35], v16 offset:49920
    v_mfma_f32_16x16x32_bf16 v[116:119], v[48:51], a[60:63], v[116:119]
    s_add_u32 m0, s55, 24576
    s_add_u32 s1, s53, 1232896
    v_mfma_f32_16x16x32_bf16 v[120:123], v[52:55], a[56:59], v[120:123]
    ds_read_b64_tr_b16 v[36:37], v17 offset:49152
    ds_read_b64_tr_b16 v[38:39], v17 offset:49920
    v_mfma_f32_16x16x32_bf16 v[124:127], v[52:55], a[60:63], v[124:127]
    buffer_load_dwordx4 v8, s[20:23], s1 offen offset:0 lds
    s_waitcnt lgkmcnt(4)
    v_mfma_f32_16x16x32_bf16 v[128:131], v[56:59], a[56:59], v[128:131]
    ds_read_b64_tr_b16 v[40:41], v18 offset:49152
    ds_read_b64_tr_b16 v[42:43], v18 offset:49920
    v_mfma_f32_16x16x32_bf16 v[132:135], v[56:59], a[60:63], v[132:135]
    v_mfma_f32_16x16x32_bf16 v[136:139], v[60:63], a[56:59], v[136:139]
    ds_read_b64_tr_b16 v[44:45], v19 offset:49152
    ds_read_b64_tr_b16 v[46:47], v19 offset:49920
    v_mfma_f32_16x16x32_bf16 v[140:143], v[60:63], a[60:63], v[140:143]
    buffer_load_dwordx4 v9, s[20:23], s1 offen offset:1024 lds
    v_mfma_f32_4x4x4_16b_bf16 v[144:147], a[112:113], a[112:113], v[144:147]
    v_mfma_f32_4x4x4_16b_bf16 v[148:151], a[116:117], a[116:117], v[148:151]
    v_mfma_f32_4x4x4_16b_bf16 v[152:155], a[114:115], a[114:115], v[152:155]
    v_mfma_f32_4x4x4_16b_bf16 v[156:159], a[118:119], a[118:119], v[156:159]
    v_mfma_f32_4x4x4_16b_bf16 v[144:147], a[120:121], a[120:121], v[144:147]
    v_mfma_f32_4x4x4_16b_bf16 v[148:151], a[124:125], a[124:125], v[148:151]
    v_mfma_f32_4x4x4_16b_bf16 v[152:155], a[122:123], a[122:123], v[152:155]
    v_mfma_f32_4x4x4_16b_bf16 v[156:159], a[126:127], a[126:127], v[156:159]
    v_mfma_f32_16x16x32_bf16 v[160:163], v[20:23], a[112:115], v[160:163]
    v_mfma_f32_16x16x32_bf16 v[164:167], v[20:23], a[116:119], v[164:167]
    v_mfma_f32_16x16x32_bf16 v[160:163], v[20:23], a[120:123], v[160:163]
    v_mfma_f32_16x16x32_bf16 v[164:167], v[20:23], a[124:127], v[164:167]
    s_waitcnt lgkmcnt(4)
    v_mfma_f32_16x16x32_bf16 v[96:99], v[32:35], a[64:67], v[96:99]
    ds_read_b64_tr_b16 v[48:49], v64 offset:49152
    ds_read_b64_tr_b16 v[50:51], v64 offset:49920
    v_mfma_f32_16x16x32_bf16 v[100:103], v[32:35], a[68:71], v[100:103]
    buffer_load_dwordx4 v10, s[20:23], s1 offen offset:2048 lds
    v_mfma_f32_16x16x32_bf16 v[88:91], v[32:35], v[20:23], v[88:91]
    v_mfma_f32_16x16x32_bf16 v[104:107], v[36:39], a[64:67], v[104:107]
    ds_read_b64_tr_b16 v[52:53], v65 offset:49152
    ds_read_b64_tr_b16 v[54:55], v65 offset:49920
    v_mfma_f32_16x16x32_bf16 v[108:111], v[36:39], a[68:71], v[108:111]
    v_mfma_f32_16x16x32_bf16 v[92:95], v[36:39], v[20:23], v[92:95]
    s_waitcnt lgkmcnt(4)
    v_mfma_f32_16x16x32_bf16 v[112:115], v[40:43], a[64:67], v[112:115]
    ds_read_b64_tr_b16 v[56:57], v16 offset:55296
    ds_read_b64_tr_b16 v[58:59], v16 offset:56064
    v_mfma_f32_16x16x32_bf16 v[116:119], v[40:43], a[68:71], v[116:119]
    v_mfma_f32_16x16x32_bf16 v[120:123], v[44:47], a[64:67], v[120:123]
    ds_read_b64_tr_b16 v[60:61], v17 offset:55296
    ds_read_b64_tr_b16 v[62:63], v17 offset:56064
    v_mfma_f32_16x16x32_bf16 v[124:127], v[44:47], a[68:71], v[124:127]
    s_waitcnt lgkmcnt(4)
    v_mfma_f32_16x16x32_bf16 v[128:131], v[48:51], a[64:67], v[128:131]
    ds_read_b64_tr_b16 v[32:33], v18 offset:55296
    ds_read_b64_tr_b16 v[34:35], v18 offset:56064
    v_mfma_f32_16x16x32_bf16 v[132:135], v[48:51], a[68:71], v[132:135]
    v_mfma_f32_16x16x32_bf16 v[136:139], v[52:55], a[64:67], v[136:139]
    ds_read_b64_tr_b16 v[36:37], v19 offset:55296
    ds_read_b64_tr_b16 v[38:39], v19 offset:56064
    v_mfma_f32_16x16x32_bf16 v[140:143], v[52:55], a[68:71], v[140:143]
    s_mov_b32 s64, 0xaaaaaaaa
    s_mov_b32 s65, 0xaaaaaaaa
    s_mov_b32 s66, 0xcccccccc
    s_mov_b32 s67, 0xcccccccc
    v_pk_add_f32 v[144:145], v[144:145], v[152:153]
    v_pk_add_f32 v[146:147], v[146:147], v[154:155]
    v_pk_add_f32 v[148:149], v[148:149], v[156:157]
    v_pk_add_f32 v[150:151], v[150:151], v[158:159]
    v_cndmask_b32 v144, v144, v145, s[64:65]
    v_cndmask_b32 v146, v146, v147, s[64:65]
    v_cndmask_b32 v148, v148, v149, s[64:65]
    v_cndmask_b32 v150, v150, v151, s[64:65]
    v_cndmask_b32 v144, v144, v146, s[66:67]
    v_cndmask_b32 v148, v148, v150, s[66:67]
    v_mov_b32 v145, v144
    v_mov_b32 v149, v148
    s_nop 0
    v_permlane32_swap_b32 v144, v145
    v_permlane32_swap_b32 v148, v149
    v_add_f32 v144, v144, v145
    v_add_f32 v148, v148, v149
    v_mov_b32 v145, v144
    v_mov_b32 v149, v148
    s_nop 0
    v_permlane16_swap_b32 v144, v145
    v_permlane16_swap_b32 v148, v149
    v_add_f32 v144, v144, v145
    v_add_f32 v148, v148, v149
    v_mul_f32 v24, 3137339392, v160
    v_mul_f32 v145, 989855744, v144
    v_fma_f32 v145, -v24, v24, v145
    v_max_f32 v145, 0, v145
    v_add_f32 v145, 925353388, v145
    v_rsq_f32 v25, v145
    v_mul_f32 v26, 3137339392, v164
    v_mul_f32 v149, 989855744, v148
    v_fma_f32 v149, -v26, v26, v149
    v_max_f32 v149, 0, v149
    v_add_f32 v149, 925353388, v149
    v_rsq_f32 v27, v149
    v_mul_f32 v31, v25, v25
    v_mul_f32 v30, 3184710632, v25
    v_mul_f32 v30, v30, v31
    v_mul_f32 v31, 3222493025, v25
    v_mul_f32 v73, v27, v27
    v_mul_f32 v72, 3184710632, v27
    v_mul_f32 v72, v72, v73
    v_mul_f32 v73, 3222493025, v27
    s_waitcnt lgkmcnt(4)
    v_mfma_f32_16x16x32_bf16 v[96:99], v[56:59], a[72:75], v[96:99]
    ds_read_b64_tr_b16 v[40:41], v64 offset:55296
    ds_read_b64_tr_b16 v[42:43], v64 offset:56064
    v_mfma_f32_16x16x32_bf16 v[100:103], v[56:59], a[76:79], v[100:103]
    v_mfma_f32_16x16x32_bf16 v[88:91], v[56:59], v[20:23], v[88:91]
    v_mfma_f32_16x16x32_bf16 v[104:107], v[60:63], a[72:75], v[104:107]
    ds_read_b64_tr_b16 v[44:45], v65 offset:55296
    ds_read_b64_tr_b16 v[46:47], v65 offset:56064
    v_mfma_f32_16x16x32_bf16 v[108:111], v[60:63], a[76:79], v[108:111]
    v_mfma_f32_16x16x32_bf16 v[92:95], v[60:63], v[20:23], v[92:95]
    s_waitcnt lgkmcnt(4)
    v_mfma_f32_16x16x32_bf16 v[112:115], v[32:35], a[72:75], v[112:115]
    s_waitcnt vmcnt(6)
    s_barrier
    ds_read_b64_tr_b16 v[48:49], v16 offset:0
    ds_read_b64_tr_b16 v[50:51], v16 offset:768
    v_mfma_f32_16x16x32_bf16 v[116:119], v[32:35], a[76:79], v[116:119]
    s_add_u32 m0, s55, 36864
    s_add_u32 s1, s56, 0
    v_mfma_f32_16x16x32_bf16 v[120:123], v[36:39], a[72:75], v[120:123]
    ds_read_b64_tr_b16 v[52:53], v17 offset:0
    ds_read_b64_tr_b16 v[54:55], v17 offset:768
    v_mfma_f32_16x16x32_bf16 v[124:127], v[36:39], a[76:79], v[124:127]
    buffer_load_dwordx4 v8, s[20:23], s1 offen offset:0 lds
    s_waitcnt lgkmcnt(4)
    v_mfma_f32_16x16x32_bf16 v[128:131], v[40:43], a[72:75], v[128:131]
    ds_read_b64_tr_b16 v[56:57], v18 offset:0
    ds_read_b64_tr_b16 v[58:59], v18 offset:768
    v_mfma_f32_16x16x32_bf16 v[132:135], v[40:43], a[76:79], v[132:135]
    v_mfma_f32_16x16x32_bf16 v[136:139], v[44:47], a[72:75], v[136:139]
    ds_read_b64_tr_b16 v[60:61], v19 offset:0
    ds_read_b64_tr_b16 v[62:63], v19 offset:768
    v_mfma_f32_16x16x32_bf16 v[140:143], v[44:47], a[76:79], v[140:143]
    buffer_load_dwordx4 v9, s[20:23], s1 offen offset:1024 lds
    s_waitcnt lgkmcnt(4)
    v_mfma_f32_16x16x32_bf16 v[96:99], v[48:51], a[80:83], v[96:99]
    ds_read_b64_tr_b16 v[32:33], v64 offset:0
    ds_read_b64_tr_b16 v[34:35], v64 offset:768
    v_mfma_f32_16x16x32_bf16 v[100:103], v[48:51], a[84:87], v[100:103]
    v_mfma_f32_16x16x32_bf16 v[88:91], v[48:51], v[20:23], v[88:91]
    v_mfma_f32_16x16x32_bf16 v[104:107], v[52:55], a[80:83], v[104:107]
    ds_read_b64_tr_b16 v[36:37], v65 offset:0
    ds_read_b64_tr_b16 v[38:39], v65 offset:768
    v_mfma_f32_16x16x32_bf16 v[108:111], v[52:55], a[84:87], v[108:111]
    buffer_load_dwordx4 v10, s[20:23], s1 offen offset:2048 lds
    v_mfma_f32_16x16x32_bf16 v[92:95], v[52:55], v[20:23], v[92:95]
    s_waitcnt lgkmcnt(4)
    v_mfma_f32_16x16x32_bf16 v[112:115], v[56:59], a[80:83], v[112:115]
    ds_read_b64_tr_b16 v[40:41], v16 offset:6144
    ds_read_b64_tr_b16 v[42:43], v16 offset:6912
    v_mfma_f32_16x16x32_bf16 v[116:119], v[56:59], a[84:87], v[116:119]
    v_mfma_f32_16x16x32_bf16 v[120:123], v[60:63], a[80:83], v[120:123]
    ds_read_b64_tr_b16 v[44:45], v17 offset:6144
    ds_read_b64_tr_b16 v[46:47], v17 offset:6912
    v_mfma_f32_16x16x32_bf16 v[124:127], v[60:63], a[84:87], v[124:127]
    s_waitcnt lgkmcnt(4)
    v_mfma_f32_16x16x32_bf16 v[128:131], v[32:35], a[80:83], v[128:131]
    ds_read_b64_tr_b16 v[48:49], v18 offset:6144
    ds_read_b64_tr_b16 v[50:51], v18 offset:6912
    v_mfma_f32_16x16x32_bf16 v[132:135], v[32:35], a[84:87], v[132:135]
    v_mfma_f32_16x16x32_bf16 v[136:139], v[36:39], a[80:83], v[136:139]
    ds_read_b64_tr_b16 v[52:53], v19 offset:6144
    ds_read_b64_tr_b16 v[54:55], v19 offset:6912
    v_mfma_f32_16x16x32_bf16 v[140:143], v[36:39], a[84:87], v[140:143]
    s_waitcnt lgkmcnt(4)
    v_mfma_f32_16x16x32_bf16 v[96:99], v[40:43], a[88:91], v[96:99]
    ds_read_b64_tr_b16 v[56:57], v64 offset:6144
    ds_read_b64_tr_b16 v[58:59], v64 offset:6912
    v_mfma_f32_16x16x32_bf16 v[100:103], v[40:43], a[92:95], v[100:103]
    v_mfma_f32_16x16x32_bf16 v[88:91], v[40:43], v[20:23], v[88:91]
    v_mfma_f32_16x16x32_bf16 v[104:107], v[44:47], a[88:91], v[104:107]
    ds_read_b64_tr_b16 v[60:61], v65 offset:6144
    ds_read_b64_tr_b16 v[62:63], v65 offset:6912
    v_mfma_f32_16x16x32_bf16 v[108:111], v[44:47], a[92:95], v[108:111]
    v_mfma_f32_16x16x32_bf16 v[92:95], v[44:47], v[20:23], v[92:95]
    s_waitcnt lgkmcnt(4)
    v_mfma_f32_16x16x32_bf16 v[112:115], v[48:51], a[88:91], v[112:115]
    s_waitcnt vmcnt(6)
    s_barrier
    ds_read_b64_tr_b16 v[32:33], v16 offset:12288
    ds_read_b64_tr_b16 v[34:35], v16 offset:13056
    v_mfma_f32_16x16x32_bf16 v[116:119], v[48:51], a[92:95], v[116:119]
    s_add_u32 m0, s55, 49152
    s_add_u32 s1, s56, 176128
    v_mfma_f32_16x16x32_bf16 v[120:123], v[52:55], a[88:91], v[120:123]
    ds_read_b64_tr_b16 v[36:37], v17 offset:12288
    ds_read_b64_tr_b16 v[38:39], v17 offset:13056
    v_mfma_f32_16x16x32_bf16 v[124:127], v[52:55], a[92:95], v[124:127]
    buffer_load_dwordx4 v8, s[20:23], s1 offen offset:0 lds
    s_waitcnt lgkmcnt(4)
    v_mfma_f32_16x16x32_bf16 v[128:131], v[56:59], a[88:91], v[128:131]
    ds_read_b64_tr_b16 v[40:41], v18 offset:12288
    ds_read_b64_tr_b16 v[42:43], v18 offset:13056
    v_mfma_f32_16x16x32_bf16 v[132:135], v[56:59], a[92:95], v[132:135]
    v_mfma_f32_16x16x32_bf16 v[136:139], v[60:63], a[88:91], v[136:139]
    ds_read_b64_tr_b16 v[44:45], v19 offset:12288
    ds_read_b64_tr_b16 v[46:47], v19 offset:13056
    v_mfma_f32_16x16x32_bf16 v[140:143], v[60:63], a[92:95], v[140:143]
    buffer_load_dwordx4 v9, s[20:23], s1 offen offset:1024 lds
    s_waitcnt lgkmcnt(4)
    v_mfma_f32_16x16x32_bf16 v[96:99], v[32:35], a[96:99], v[96:99]
    ds_read_b64_tr_b16 v[48:49], v64 offset:12288
    ds_read_b64_tr_b16 v[50:51], v64 offset:13056
    v_mfma_f32_16x16x32_bf16 v[100:103], v[32:35], a[100:103], v[100:103]
    v_mfma_f32_16x16x32_bf16 v[88:91], v[32:35], v[20:23], v[88:91]
    v_mfma_f32_16x16x32_bf16 v[104:107], v[36:39], a[96:99], v[104:107]
    ds_read_b64_tr_b16 v[52:53], v65 offset:12288
    ds_read_b64_tr_b16 v[54:55], v65 offset:13056
    v_mfma_f32_16x16x32_bf16 v[108:111], v[36:39], a[100:103], v[108:111]
    buffer_load_dwordx4 v10, s[20:23], s1 offen offset:2048 lds
    v_mfma_f32_16x16x32_bf16 v[92:95], v[36:39], v[20:23], v[92:95]
    s_waitcnt lgkmcnt(4)
    v_mfma_f32_16x16x32_bf16 v[112:115], v[40:43], a[96:99], v[112:115]
    ds_read_b64_tr_b16 v[56:57], v16 offset:18432
    ds_read_b64_tr_b16 v[58:59], v16 offset:19200
    v_mfma_f32_16x16x32_bf16 v[116:119], v[40:43], a[100:103], v[116:119]
    v_mfma_f32_16x16x32_bf16 v[120:123], v[44:47], a[96:99], v[120:123]
    ds_read_b64_tr_b16 v[60:61], v17 offset:18432
    ds_read_b64_tr_b16 v[62:63], v17 offset:19200
    v_mfma_f32_16x16x32_bf16 v[124:127], v[44:47], a[100:103], v[124:127]
    s_waitcnt lgkmcnt(4)
    v_mfma_f32_16x16x32_bf16 v[128:131], v[48:51], a[96:99], v[128:131]
    ds_read_b64_tr_b16 v[32:33], v18 offset:18432
    ds_read_b64_tr_b16 v[34:35], v18 offset:19200
    v_mfma_f32_16x16x32_bf16 v[132:135], v[48:51], a[100:103], v[132:135]
    v_mfma_f32_16x16x32_bf16 v[136:139], v[52:55], a[96:99], v[136:139]
    ds_read_b64_tr_b16 v[36:37], v19 offset:18432
    ds_read_b64_tr_b16 v[38:39], v19 offset:19200
    v_mfma_f32_16x16x32_bf16 v[140:143], v[52:55], a[100:103], v[140:143]
    s_waitcnt lgkmcnt(4)
    v_mfma_f32_16x16x32_bf16 v[96:99], v[56:59], a[104:107], v[96:99]
    ds_read_b64_tr_b16 v[40:41], v64 offset:18432
    ds_read_b64_tr_b16 v[42:43], v64 offset:19200
    v_mfma_f32_16x16x32_bf16 v[100:103], v[56:59], a[108:111], v[100:103]
    v_mfma_f32_16x16x32_bf16 v[88:91], v[56:59], v[20:23], v[88:91]
    v_mfma_f32_16x16x32_bf16 v[104:107], v[60:63], a[104:107], v[104:107]
    ds_read_b64_tr_b16 v[44:45], v65 offset:18432
    ds_read_b64_tr_b16 v[46:47], v65 offset:19200
    v_mfma_f32_16x16x32_bf16 v[108:111], v[60:63], a[108:111], v[108:111]
    v_mfma_f32_16x16x32_bf16 v[92:95], v[60:63], v[20:23], v[92:95]
    s_waitcnt lgkmcnt(4)
    v_mfma_f32_16x16x32_bf16 v[112:115], v[32:35], a[104:107], v[112:115]
    s_waitcnt vmcnt(6)
    s_barrier
    ds_read_b64_tr_b16 v[48:49], v16 offset:24576
    ds_read_b64_tr_b16 v[50:51], v16 offset:25344
    v_mfma_f32_16x16x32_bf16 v[116:119], v[32:35], a[108:111], v[116:119]
    s_add_u32 m0, s55, 0
    s_add_u32 s1, s56, 352256
    v_mfma_f32_16x16x32_bf16 v[120:123], v[36:39], a[104:107], v[120:123]
    ds_read_b64_tr_b16 v[52:53], v17 offset:24576
    ds_read_b64_tr_b16 v[54:55], v17 offset:25344
    v_mfma_f32_16x16x32_bf16 v[124:127], v[36:39], a[108:111], v[124:127]
    buffer_load_dwordx4 v8, s[20:23], s1 offen offset:0 lds
    s_waitcnt lgkmcnt(4)
    v_mfma_f32_16x16x32_bf16 v[128:131], v[40:43], a[104:107], v[128:131]
    ds_read_b64_tr_b16 v[56:57], v18 offset:24576
    ds_read_b64_tr_b16 v[58:59], v18 offset:25344
    v_mfma_f32_16x16x32_bf16 v[132:135], v[40:43], a[108:111], v[132:135]
    v_mfma_f32_16x16x32_bf16 v[136:139], v[44:47], a[104:107], v[136:139]
    ds_read_b64_tr_b16 v[60:61], v19 offset:24576
    ds_read_b64_tr_b16 v[62:63], v19 offset:25344
    v_mfma_f32_16x16x32_bf16 v[140:143], v[44:47], a[108:111], v[140:143]
    buffer_load_dwordx4 v9, s[20:23], s1 offen offset:1024 lds
    s_waitcnt lgkmcnt(4)
    v_mfma_f32_16x16x32_bf16 v[96:99], v[48:51], a[112:115], v[96:99]
    ds_read_b64_tr_b16 v[32:33], v64 offset:24576
    ds_read_b64_tr_b16 v[34:35], v64 offset:25344
    v_mfma_f32_16x16x32_bf16 v[100:103], v[48:51], a[116:119], v[100:103]
    s_lshl_b32 s0, s8, 7
    s_add_u32 s52, s73, 131072
    v_mfma_f32_16x16x32_bf16 v[88:91], v[48:51], v[20:23], v[88:91]
    v_mfma_f32_16x16x32_bf16 v[104:107], v[52:55], a[112:115], v[104:107]
    ds_read_b64_tr_b16 v[36:37], v65 offset:24576
    ds_read_b64_tr_b16 v[38:39], v65 offset:25344
    v_mfma_f32_16x16x32_bf16 v[108:111], v[52:55], a[116:119], v[108:111]
    buffer_load_dwordx4 v10, s[20:23], s1 offen offset:2048 lds
    v_mfma_f32_16x16x32_bf16 v[92:95], v[52:55], v[20:23], v[92:95]
    s_waitcnt lgkmcnt(4)
    v_mfma_f32_16x16x32_bf16 v[112:115], v[56:59], a[112:115], v[112:115]
    ds_read_b64_tr_b16 v[40:41], v16 offset:30720
    ds_read_b64_tr_b16 v[42:43], v16 offset:31488
    v_mfma_f32_16x16x32_bf16 v[116:119], v[56:59], a[116:119], v[116:119]
    s_add_u32 m0, s54, 0
    s_add_u32 s82, s73, s0
    v_mfma_f32_16x16x32_bf16 v[120:123], v[60:63], a[112:115], v[120:123]
    ds_read_b64_tr_b16 v[44:45], v17 offset:30720
    ds_read_b64_tr_b16 v[46:47], v17 offset:31488
    v_mfma_f32_16x16x32_bf16 v[124:127], v[60:63], a[116:119], v[124:127]
    buffer_load_dwordx4 v76, s[24:27], s82 offen offset:0 lds
    s_waitcnt lgkmcnt(4)
    v_mfma_f32_16x16x32_bf16 v[128:131], v[32:35], a[112:115], v[128:131]
    ds_read_b64_tr_b16 v[48:49], v18 offset:30720
    ds_read_b64_tr_b16 v[50:51], v18 offset:31488
    v_mfma_f32_16x16x32_bf16 v[132:135], v[32:35], a[116:119], v[132:135]
    v_mfma_f32_16x16x32_bf16 v[136:139], v[36:39], a[112:115], v[136:139]
    ds_read_b64_tr_b16 v[52:53], v19 offset:30720
    ds_read_b64_tr_b16 v[54:55], v19 offset:31488
    v_mfma_f32_16x16x32_bf16 v[140:143], v[36:39], a[116:119], v[140:143]
    buffer_load_dwordx4 v77, s[24:27], s82 offen offset:1024 lds
    s_waitcnt lgkmcnt(4)
    v_mfma_f32_16x16x32_bf16 v[96:99], v[40:43], a[120:123], v[96:99]
    ds_read_b64_tr_b16 v[56:57], v64 offset:30720
    ds_read_b64_tr_b16 v[58:59], v64 offset:31488
    v_mfma_f32_16x16x32_bf16 v[100:103], v[40:43], a[124:127], v[100:103]
    v_mfma_f32_16x16x32_bf16 v[88:91], v[40:43], v[20:23], v[88:91]
    v_mfma_f32_16x16x32_bf16 v[104:107], v[44:47], a[120:123], v[104:107]
    ds_read_b64_tr_b16 v[60:61], v65 offset:30720
    ds_read_b64_tr_b16 v[62:63], v65 offset:31488
    v_mfma_f32_16x16x32_bf16 v[108:111], v[44:47], a[124:127], v[108:111]
    buffer_load_dwordx4 v78, s[24:27], s82 offen offset:2048 lds
    v_mfma_f32_16x16x32_bf16 v[92:95], v[44:47], v[20:23], v[92:95]
    s_waitcnt lgkmcnt(4)
    v_mfma_f32_16x16x32_bf16 v[112:115], v[48:51], a[120:123], v[112:115]
    v_mfma_f32_16x16x32_bf16 v[116:119], v[48:51], a[124:127], v[116:119]
    buffer_load_dwordx4 v79, s[24:27], s82 offen offset:3072 lds
    v_mfma_f32_16x16x32_bf16 v[120:123], v[52:55], a[120:123], v[120:123]
    v_mfma_f32_16x16x32_bf16 v[124:127], v[52:55], a[124:127], v[124:127]
    s_add_u32 m0, s54, 4096
    s_add_u32 s82, s52, s0
    s_waitcnt lgkmcnt(0)
    v_mfma_f32_16x16x32_bf16 v[128:131], v[56:59], a[120:123], v[128:131]
    v_mfma_f32_16x16x32_bf16 v[132:135], v[56:59], a[124:127], v[132:135]
    buffer_load_dwordx4 v76, s[24:27], s82 offen offset:0 lds
    v_mfma_f32_16x16x32_bf16 v[136:139], v[60:63], a[120:123], v[136:139]
    v_mfma_f32_16x16x32_bf16 v[140:143], v[60:63], a[124:127], v[140:143]
    v_and_b32 v11, 48, v1
    v_add_u32 v11, 126976, v11
    v_lshl_add_u32 v3, s68, 7, v11
    s_mov_b32 exec_lo, 0x00010001
    s_mov_b32 exec_hi, 0x00010001
    ds_write_b128 v3, v[88:91] offset:0
    ds_write_b128 v3, v[92:95] offset:64
    s_mov_b64 exec, -1
    s_waitcnt lgkmcnt(0)
    s_barrier
    v_and_b32 v29, 31, v1
    v_lshlrev_b32 v29, 3, v29
    s_lshl_b32 s58, s5, 8
    s_add_u32 s58, s58, 4096
    v_add_u32 v29, s58, v29
    buffer_load_dwordx2 v[60:61], v29, s[28:31], 0 offen sc1
    v_lshl_add_u32 v56, s68, 7, v11
    v_lshl_add_u32 v57, s69, 7, v11
    v_lshl_add_u32 v58, s70, 7, v11
    ds_read_b128 v[32:35], v56 offset:0
    ds_read_b128 v[36:39], v56 offset:64
    ds_read_b128 v[40:43], v57 offset:0
    ds_read_b128 v[44:47], v57 offset:64
    ds_read_b128 v[48:51], v58 offset:0
    ds_read_b128 v[52:55], v58 offset:64
    s_waitcnt lgkmcnt(5)
    v_pk_fma_f32 v[96:97], v[32:33], v[24:25], v[96:97] op_sel_hi:[1,0,1]
    v_pk_fma_f32 v[98:99], v[34:35], v[24:25], v[98:99] op_sel_hi:[1,0,1]
    v_pk_fma_f32 v[100:101], v[32:33], v[26:27], v[100:101] op_sel_hi:[1,0,1]
    v_pk_fma_f32 v[102:103], v[34:35], v[26:27], v[102:103] op_sel_hi:[1,0,1]
    s_waitcnt lgkmcnt(4)
    v_pk_fma_f32 v[104:105], v[36:37], v[24:25], v[104:105] op_sel_hi:[1,0,1]
    v_pk_fma_f32 v[106:107], v[38:39], v[24:25], v[106:107] op_sel_hi:[1,0,1]
    v_pk_fma_f32 v[108:109], v[36:37], v[26:27], v[108:109] op_sel_hi:[1,0,1]
    v_pk_fma_f32 v[110:111], v[38:39], v[26:27], v[110:111] op_sel_hi:[1,0,1]
    buffer_load_dwordx4 v77, s[24:27], s82 offen offset:1024 lds
    s_waitcnt lgkmcnt(3)
    v_pk_fma_f32 v[112:113], v[40:41], v[24:25], v[112:113] op_sel_hi:[1,0,1]
    v_pk_fma_f32 v[114:115], v[42:43], v[24:25], v[114:115] op_sel_hi:[1,0,1]
    v_pk_fma_f32 v[116:117], v[40:41], v[26:27], v[116:117] op_sel_hi:[1,0,1]
    v_pk_fma_f32 v[118:119], v[42:43], v[26:27], v[118:119] op_sel_hi:[1,0,1]
    s_waitcnt lgkmcnt(2)
    v_pk_fma_f32 v[120:121], v[44:45], v[24:25], v[120:121] op_sel_hi:[1,0,1]
    v_pk_fma_f32 v[122:123], v[46:47], v[24:25], v[122:123] op_sel_hi:[1,0,1]
    v_pk_fma_f32 v[124:125], v[44:45], v[26:27], v[124:125] op_sel_hi:[1,0,1]
    v_pk_fma_f32 v[126:127], v[46:47], v[26:27], v[126:127] op_sel_hi:[1,0,1]
    s_waitcnt lgkmcnt(1)
    v_pk_fma_f32 v[128:129], v[48:49], v[24:25], v[128:129] op_sel_hi:[1,0,1]
    v_pk_fma_f32 v[130:131], v[50:51], v[24:25], v[130:131] op_sel_hi:[1,0,1]
    v_pk_fma_f32 v[132:133], v[48:49], v[26:27], v[132:133] op_sel_hi:[1,0,1]
    v_pk_fma_f32 v[134:135], v[50:51], v[26:27], v[134:135] op_sel_hi:[1,0,1]
    s_waitcnt lgkmcnt(0)
    v_pk_fma_f32 v[136:137], v[52:53], v[24:25], v[136:137] op_sel_hi:[1,0,1]
    v_pk_fma_f32 v[138:139], v[54:55], v[24:25], v[138:139] op_sel_hi:[1,0,1]
    v_pk_fma_f32 v[140:141], v[52:53], v[26:27], v[140:141] op_sel_hi:[1,0,1]
    v_pk_fma_f32 v[142:143], v[54:55], v[26:27], v[142:143] op_sel_hi:[1,0,1]
    buffer_load_dwordx4 v78, s[24:27], s82 offen offset:2048 lds
    v_pk_mul_f32 v[32:33], v[96:97], v[96:97]
    v_pk_mul_f32 v[34:35], v[98:99], v[98:99]
    v_pk_mul_f32 v[36:37], v[100:101], v[100:101]
    v_pk_mul_f32 v[38:39], v[102:103], v[102:103]
    v_pk_fma_f32 v[32:33], v[32:33], v[30:31], v[30:31] op_sel:[0,0,1] op_sel_hi:[1,0,1]
    v_pk_fma_f32 v[34:35], v[34:35], v[30:31], v[30:31] op_sel:[0,0,1] op_sel_hi:[1,0,1]
    v_pk_fma_f32 v[36:37], v[36:37], v[72:73], v[72:73] op_sel:[0,0,1] op_sel_hi:[1,0,1]
    v_pk_fma_f32 v[38:39], v[38:39], v[72:73], v[72:73] op_sel:[0,0,1] op_sel_hi:[1,0,1]
    v_pk_mul_f32 v[32:33], v[32:33], v[96:97]
    v_pk_mul_f32 v[34:35], v[34:35], v[98:99]
    v_pk_mul_f32 v[36:37], v[36:37], v[100:101]
    v_pk_mul_f32 v[38:39], v[38:39], v[102:103]
    buffer_load_dwordx4 v79, s[24:27], s82 offen offset:3072 lds
    v_exp_f32 v32, v32
    v_exp_f32 v33, v33
    v_exp_f32 v34, v34
    v_exp_f32 v35, v35
    v_exp_f32 v36, v36
    v_exp_f32 v37, v37
    v_exp_f32 v38, v38
    v_exp_f32 v39, v39
    s_add_u32 m0, s55, 12288
    s_add_u32 s1, s56, 528384
    v_pk_add_f32 v[32:33], v[32:33], 1.0 op_sel_hi:[1,0]
    v_pk_add_f32 v[34:35], v[34:35], 1.0 op_sel_hi:[1,0]
    v_pk_add_f32 v[36:37], v[36:37], 1.0 op_sel_hi:[1,0]
    v_pk_add_f32 v[38:39], v[38:39], 1.0 op_sel_hi:[1,0]
    buffer_load_dwordx4 v8, s[20:23], s1 offen offset:0 lds
    v_rcp_f32 v32, v32
    v_rcp_f32 v33, v33
    v_rcp_f32 v34, v34
    v_rcp_f32 v35, v35
    v_rcp_f32 v36, v36
    v_rcp_f32 v37, v37
    v_rcp_f32 v38, v38
    v_rcp_f32 v39, v39
    buffer_load_dwordx4 v9, s[20:23], s1 offen offset:1024 lds
    v_pk_mul_f32 v[96:97], v[96:97], v[32:33]
    v_pk_mul_f32 v[98:99], v[98:99], v[34:35]
    v_pk_mul_f32 v[100:101], v[100:101], v[36:37]
    v_pk_mul_f32 v[102:103], v[102:103], v[38:39]
    v_pk_mul_f32 v[42:43], v[96:97], v[96:97]
    v_pk_add_f32 v[40:41], v[96:97], 0 op_sel_hi:[1,0]
    v_pk_fma_f32 v[42:43], v[98:99], v[98:99], v[42:43]
    v_pk_add_f32 v[40:41], v[98:99], v[40:41]
    v_pk_mul_f32 v[46:47], v[100:101], v[100:101]
    v_pk_add_f32 v[44:45], v[100:101], 0 op_sel_hi:[1,0]
    v_pk_fma_f32 v[46:47], v[102:103], v[102:103], v[46:47]
    v_pk_add_f32 v[44:45], v[102:103], v[44:45]
    v_pk_mul_f32 v[32:33], v[104:105], v[104:105]
    v_pk_mul_f32 v[34:35], v[106:107], v[106:107]
    v_pk_mul_f32 v[36:37], v[108:109], v[108:109]
    v_pk_mul_f32 v[38:39], v[110:111], v[110:111]
    v_pk_fma_f32 v[32:33], v[32:33], v[30:31], v[30:31] op_sel:[0,0,1] op_sel_hi:[1,0,1]
    v_pk_fma_f32 v[34:35], v[34:35], v[30:31], v[30:31] op_sel:[0,0,1] op_sel_hi:[1,0,1]
    v_pk_fma_f32 v[36:37], v[36:37], v[72:73], v[72:73] op_sel:[0,0,1] op_sel_hi:[1,0,1]
    v_pk_fma_f32 v[38:39], v[38:39], v[72:73], v[72:73] op_sel:[0,0,1] op_sel_hi:[1,0,1]
    v_pk_mul_f32 v[32:33], v[32:33], v[104:105]
    v_pk_mul_f32 v[34:35], v[34:35], v[106:107]
    v_pk_mul_f32 v[36:37], v[36:37], v[108:109]
    v_pk_mul_f32 v[38:39], v[38:39], v[110:111]
    buffer_load_dwordx4 v10, s[20:23], s1 offen offset:2048 lds
    v_exp_f32 v32, v32
    v_exp_f32 v33, v33
    v_exp_f32 v34, v34
    v_exp_f32 v35, v35
    v_exp_f32 v36, v36
    v_exp_f32 v37, v37
    v_exp_f32 v38, v38
    v_exp_f32 v39, v39
    s_add_u32 m0, s55, 24576
    s_add_u32 s1, s56, 704512
    s_add_u32 m0, s54, 8192
    s_add_u32 s0, s0, 128
    s_and_b32 s0, s0, 1023
    s_add_u32 s82, s73, s0
    v_pk_add_f32 v[32:33], v[32:33], 1.0 op_sel_hi:[1,0]
    v_pk_add_f32 v[34:35], v[34:35], 1.0 op_sel_hi:[1,0]
    v_pk_add_f32 v[36:37], v[36:37], 1.0 op_sel_hi:[1,0]
    v_pk_add_f32 v[38:39], v[38:39], 1.0 op_sel_hi:[1,0]
    buffer_load_dwordx4 v76, s[24:27], s82 offen offset:0 lds
    v_rcp_f32 v32, v32
    v_rcp_f32 v33, v33
    v_rcp_f32 v34, v34
    v_rcp_f32 v35, v35
    v_rcp_f32 v36, v36
    v_rcp_f32 v37, v37
    v_rcp_f32 v38, v38
    v_rcp_f32 v39, v39
    buffer_load_dwordx4 v77, s[24:27], s82 offen offset:1024 lds
    v_pk_mul_f32 v[104:105], v[104:105], v[32:33]
    v_pk_mul_f32 v[106:107], v[106:107], v[34:35]
    v_pk_mul_f32 v[108:109], v[108:109], v[36:37]
    v_pk_mul_f32 v[110:111], v[110:111], v[38:39]
    v_pk_fma_f32 v[42:43], v[104:105], v[104:105], v[42:43]
    v_pk_add_f32 v[40:41], v[104:105], v[40:41]
    v_pk_fma_f32 v[42:43], v[106:107], v[106:107], v[42:43]
    v_pk_add_f32 v[40:41], v[106:107], v[40:41]
    v_pk_fma_f32 v[46:47], v[108:109], v[108:109], v[46:47]
    v_pk_add_f32 v[44:45], v[108:109], v[44:45]
    v_pk_fma_f32 v[46:47], v[110:111], v[110:111], v[46:47]
    v_pk_add_f32 v[44:45], v[110:111], v[44:45]
    v_pk_mul_f32 v[32:33], v[112:113], v[112:113]
    v_pk_mul_f32 v[34:35], v[114:115], v[114:115]
    v_pk_mul_f32 v[36:37], v[116:117], v[116:117]
    v_pk_mul_f32 v[38:39], v[118:119], v[118:119]
    v_pk_fma_f32 v[32:33], v[32:33], v[30:31], v[30:31] op_sel:[0,0,1] op_sel_hi:[1,0,1]
    v_pk_fma_f32 v[34:35], v[34:35], v[30:31], v[30:31] op_sel:[0,0,1] op_sel_hi:[1,0,1]
    v_pk_fma_f32 v[36:37], v[36:37], v[72:73], v[72:73] op_sel:[0,0,1] op_sel_hi:[1,0,1]
    v_pk_fma_f32 v[38:39], v[38:39], v[72:73], v[72:73] op_sel:[0,0,1] op_sel_hi:[1,0,1]
    v_pk_mul_f32 v[32:33], v[32:33], v[112:113]
    v_pk_mul_f32 v[34:35], v[34:35], v[114:115]
    v_pk_mul_f32 v[36:37], v[36:37], v[116:117]
    v_pk_mul_f32 v[38:39], v[38:39], v[118:119]
    buffer_load_dwordx4 v78, s[24:27], s82 offen offset:2048 lds
    v_exp_f32 v32, v32
    v_exp_f32 v33, v33
    v_exp_f32 v34, v34
    v_exp_f32 v35, v35
    v_exp_f32 v36, v36
    v_exp_f32 v37, v37
    v_exp_f32 v38, v38
    v_exp_f32 v39, v39
    buffer_load_dwordx4 v79, s[24:27], s82 offen offset:3072 lds
    v_pk_add_f32 v[32:33], v[32:33], 1.0 op_sel_hi:[1,0]
    v_pk_add_f32 v[34:35], v[34:35], 1.0 op_sel_hi:[1,0]
    v_pk_add_f32 v[36:37], v[36:37], 1.0 op_sel_hi:[1,0]
    v_pk_add_f32 v[38:39], v[38:39], 1.0 op_sel_hi:[1,0]
    s_add_u32 m0, s54, 12288
    s_add_u32 s82, s52, s0
    v_rcp_f32 v32, v32
    v_rcp_f32 v33, v33
    v_rcp_f32 v34, v34
    v_rcp_f32 v35, v35
    v_rcp_f32 v36, v36
    v_rcp_f32 v37, v37
    v_rcp_f32 v38, v38
    v_rcp_f32 v39, v39
    buffer_load_dwordx4 v76, s[24:27], s82 offen offset:0 lds
    v_pk_mul_f32 v[112:113], v[112:113], v[32:33]
    v_pk_mul_f32 v[114:115], v[114:115], v[34:35]
    v_pk_mul_f32 v[116:117], v[116:117], v[36:37]
    v_pk_mul_f32 v[118:119], v[118:119], v[38:39]
    v_pk_fma_f32 v[42:43], v[112:113], v[112:113], v[42:43]
    v_pk_add_f32 v[40:41], v[112:113], v[40:41]
    v_pk_fma_f32 v[42:43], v[114:115], v[114:115], v[42:43]
    v_pk_add_f32 v[40:41], v[114:115], v[40:41]
    v_pk_fma_f32 v[46:47], v[116:117], v[116:117], v[46:47]
    v_pk_add_f32 v[44:45], v[116:117], v[44:45]
    v_pk_fma_f32 v[46:47], v[118:119], v[118:119], v[46:47]
    v_pk_add_f32 v[44:45], v[118:119], v[44:45]
    v_pk_mul_f32 v[32:33], v[120:121], v[120:121]
    v_pk_mul_f32 v[34:35], v[122:123], v[122:123]
    v_pk_mul_f32 v[36:37], v[124:125], v[124:125]
    v_pk_mul_f32 v[38:39], v[126:127], v[126:127]
    v_pk_fma_f32 v[32:33], v[32:33], v[30:31], v[30:31] op_sel:[0,0,1] op_sel_hi:[1,0,1]
    v_pk_fma_f32 v[34:35], v[34:35], v[30:31], v[30:31] op_sel:[0,0,1] op_sel_hi:[1,0,1]
    v_pk_fma_f32 v[36:37], v[36:37], v[72:73], v[72:73] op_sel:[0,0,1] op_sel_hi:[1,0,1]
    v_pk_fma_f32 v[38:39], v[38:39], v[72:73], v[72:73] op_sel:[0,0,1] op_sel_hi:[1,0,1]
    v_pk_mul_f32 v[32:33], v[32:33], v[120:121]
    v_pk_mul_f32 v[34:35], v[34:35], v[122:123]
    v_pk_mul_f32 v[36:37], v[36:37], v[124:125]
    v_pk_mul_f32 v[38:39], v[38:39], v[126:127]
    buffer_load_dwordx4 v77, s[24:27], s82 offen offset:1024 lds
    v_exp_f32 v32, v32
    v_exp_f32 v33, v33
    v_exp_f32 v34, v34
    v_exp_f32 v35, v35
    v_exp_f32 v36, v36
    v_exp_f32 v37, v37
    v_exp_f32 v38, v38
    v_exp_f32 v39, v39
    buffer_load_dwordx4 v78, s[24:27], s82 offen offset:2048 lds
    v_pk_add_f32 v[32:33], v[32:33], 1.0 op_sel_hi:[1,0]
    v_pk_add_f32 v[34:35], v[34:35], 1.0 op_sel_hi:[1,0]
    v_pk_add_f32 v[36:37], v[36:37], 1.0 op_sel_hi:[1,0]
    v_pk_add_f32 v[38:39], v[38:39], 1.0 op_sel_hi:[1,0]
    v_rcp_f32 v32, v32
    v_rcp_f32 v33, v33
    v_rcp_f32 v34, v34
    v_rcp_f32 v35, v35
    v_rcp_f32 v36, v36
    v_rcp_f32 v37, v37
    v_rcp_f32 v38, v38
    v_rcp_f32 v39, v39
    buffer_load_dwordx4 v79, s[24:27], s82 offen offset:3072 lds
    v_pk_mul_f32 v[120:121], v[120:121], v[32:33]
    v_pk_mul_f32 v[122:123], v[122:123], v[34:35]
    v_pk_mul_f32 v[124:125], v[124:125], v[36:37]
    v_pk_mul_f32 v[126:127], v[126:127], v[38:39]
    v_pk_fma_f32 v[42:43], v[120:121], v[120:121], v[42:43]
    v_pk_add_f32 v[40:41], v[120:121], v[40:41]
    v_pk_fma_f32 v[42:43], v[122:123], v[122:123], v[42:43]
    v_pk_add_f32 v[40:41], v[122:123], v[40:41]
    v_pk_fma_f32 v[46:47], v[124:125], v[124:125], v[46:47]
    v_pk_add_f32 v[44:45], v[124:125], v[44:45]
    v_pk_fma_f32 v[46:47], v[126:127], v[126:127], v[46:47]
    v_pk_add_f32 v[44:45], v[126:127], v[44:45]
    v_pk_mul_f32 v[32:33], v[128:129], v[128:129]
    v_pk_mul_f32 v[34:35], v[130:131], v[130:131]
    v_pk_mul_f32 v[36:37], v[132:133], v[132:133]
    v_pk_mul_f32 v[38:39], v[134:135], v[134:135]
    v_pk_fma_f32 v[32:33], v[32:33], v[30:31], v[30:31] op_sel:[0,0,1] op_sel_hi:[1,0,1]
    v_pk_fma_f32 v[34:35], v[34:35], v[30:31], v[30:31] op_sel:[0,0,1] op_sel_hi:[1,0,1]
    v_pk_fma_f32 v[36:37], v[36:37], v[72:73], v[72:73] op_sel:[0,0,1] op_sel_hi:[1,0,1]
    v_pk_fma_f32 v[38:39], v[38:39], v[72:73], v[72:73] op_sel:[0,0,1] op_sel_hi:[1,0,1]
    v_pk_mul_f32 v[32:33], v[32:33], v[128:129]
    v_pk_mul_f32 v[34:35], v[34:35], v[130:131]
    v_pk_mul_f32 v[36:37], v[36:37], v[132:133]
    v_pk_mul_f32 v[38:39], v[38:39], v[134:135]
    s_add_u32 m0, s55, 24576
    s_nop 0
    buffer_load_dwordx4 v8, s[20:23], s1 offen offset:0 lds
    s_waitcnt vmcnt(17)
    ds_read_b128 a[128:131], v12 offset:0
    ds_read_b128 a[132:135], v13 offset:0
    v_exp_f32 v32, v32
    v_exp_f32 v33, v33
    v_exp_f32 v34, v34
    v_exp_f32 v35, v35
    v_exp_f32 v36, v36
    v_exp_f32 v37, v37
    v_exp_f32 v38, v38
    v_exp_f32 v39, v39
    buffer_load_dwordx4 v9, s[20:23], s1 offen offset:1024 lds
    ds_read_b128 a[136:139], v14 offset:0
    ds_read_b128 a[140:143], v15 offset:0
    v_pk_add_f32 v[32:33], v[32:33], 1.0 op_sel_hi:[1,0]
    v_pk_add_f32 v[34:35], v[34:35], 1.0 op_sel_hi:[1,0]
    v_pk_add_f32 v[36:37], v[36:37], 1.0 op_sel_hi:[1,0]
    v_pk_add_f32 v[38:39], v[38:39], 1.0 op_sel_hi:[1,0]
    v_rcp_f32 v32, v32
    v_rcp_f32 v33, v33
    v_rcp_f32 v34, v34
    v_rcp_f32 v35, v35
    v_rcp_f32 v36, v36
    v_rcp_f32 v37, v37
    v_rcp_f32 v38, v38
    v_rcp_f32 v39, v39
    buffer_load_dwordx4 v10, s[20:23], s1 offen offset:2048 lds
    v_pk_mul_f32 v[128:129], v[128:129], v[32:33]
    v_pk_mul_f32 v[130:131], v[130:131], v[34:35]
    v_pk_mul_f32 v[132:133], v[132:133], v[36:37]
    v_pk_mul_f32 v[134:135], v[134:135], v[38:39]
    v_pk_fma_f32 v[42:43], v[128:129], v[128:129], v[42:43]
    v_pk_add_f32 v[40:41], v[128:129], v[40:41]
    v_pk_fma_f32 v[42:43], v[130:131], v[130:131], v[42:43]
    v_pk_add_f32 v[40:41], v[130:131], v[40:41]
    v_pk_fma_f32 v[46:47], v[132:133], v[132:133], v[46:47]
    v_pk_add_f32 v[44:45], v[132:133], v[44:45]
    v_pk_fma_f32 v[46:47], v[134:135], v[134:135], v[46:47]
    v_pk_add_f32 v[44:45], v[134:135], v[44:45]
    v_pk_mul_f32 v[32:33], v[136:137], v[136:137]
    v_pk_mul_f32 v[34:35], v[138:139], v[138:139]
    v_pk_mul_f32 v[36:37], v[140:141], v[140:141]
    v_pk_mul_f32 v[38:39], v[142:143], v[142:143]
    v_pk_fma_f32 v[32:33], v[32:33], v[30:31], v[30:31] op_sel:[0,0,1] op_sel_hi:[1,0,1]
    v_pk_fma_f32 v[34:35], v[34:35], v[30:31], v[30:31] op_sel:[0,0,1] op_sel_hi:[1,0,1]
    v_pk_fma_f32 v[36:37], v[36:37], v[72:73], v[72:73] op_sel:[0,0,1] op_sel_hi:[1,0,1]
    v_pk_fma_f32 v[38:39], v[38:39], v[72:73], v[72:73] op_sel:[0,0,1] op_sel_hi:[1,0,1]
    v_pk_mul_f32 v[32:33], v[32:33], v[136:137]
    v_pk_mul_f32 v[34:35], v[34:35], v[138:139]
    v_pk_mul_f32 v[36:37], v[36:37], v[140:141]
    v_pk_mul_f32 v[38:39], v[38:39], v[142:143]
    s_waitcnt lgkmcnt(0)
    s_add_u32 m0, s54, 0
    s_add_u32 s0, s0, 128
    s_and_b32 s0, s0, 1023
    s_add_u32 s82, s73, s0
    v_exp_f32 v32, v32
    v_exp_f32 v33, v33
    v_exp_f32 v34, v34
    v_exp_f32 v35, v35
    v_exp_f32 v36, v36
    v_exp_f32 v37, v37
    v_exp_f32 v38, v38
    v_exp_f32 v39, v39
    buffer_load_dwordx4 v76, s[24:27], s82 offen offset:0 lds
    v_pk_add_f32 v[32:33], v[32:33], 1.0 op_sel_hi:[1,0]
    v_pk_add_f32 v[34:35], v[34:35], 1.0 op_sel_hi:[1,0]
    v_pk_add_f32 v[36:37], v[36:37], 1.0 op_sel_hi:[1,0]
    v_pk_add_f32 v[38:39], v[38:39], 1.0 op_sel_hi:[1,0]
    v_rcp_f32 v32, v32
    v_rcp_f32 v33, v33
    v_rcp_f32 v34, v34
    v_rcp_f32 v35, v35
    v_rcp_f32 v36, v36
    v_rcp_f32 v37, v37
    v_rcp_f32 v38, v38
    v_rcp_f32 v39, v39
    buffer_load_dwordx4 v77, s[24:27], s82 offen offset:1024 lds
    v_pk_mul_f32 v[136:137], v[136:137], v[32:33]
    v_pk_mul_f32 v[138:139], v[138:139], v[34:35]
    v_pk_mul_f32 v[140:141], v[140:141], v[36:37]
    v_pk_mul_f32 v[142:143], v[142:143], v[38:39]
    v_pk_fma_f32 v[42:43], v[136:137], v[136:137], v[42:43]
    v_pk_add_f32 v[40:41], v[136:137], v[40:41]
    v_pk_fma_f32 v[42:43], v[138:139], v[138:139], v[42:43]
    v_pk_add_f32 v[40:41], v[138:139], v[40:41]
    v_pk_fma_f32 v[46:47], v[140:141], v[140:141], v[46:47]
    v_pk_add_f32 v[44:45], v[140:141], v[44:45]
    v_pk_fma_f32 v[46:47], v[142:143], v[142:143], v[46:47]
    v_pk_add_f32 v[44:45], v[142:143], v[44:45]
    v_add_f32 v40, v40, v41
    v_add_f32 v42, v42, v43
    v_add_f32 v44, v44, v45
    v_add_f32 v46, v46, v47
    s_nop 0
    v_permlane16_swap_b32 v40, v44
    v_permlane16_swap_b32 v42, v46
    v_add_f32 v40, v40, v44
    v_add_f32 v42, v42, v46
    v_mov_b32 v41, v40
    v_mov_b32 v43, v42
    s_nop 0
    v_permlane32_swap_b32 v40, v41
    v_permlane32_swap_b32 v42, v43
    v_add_f32 v40, v40, v41
    v_add_f32 v42, v42, v43
    s_waitcnt vmcnt(19)
    v_cmp_ne_u32 vcc, s11, v60
    s_cbranch_vccnz .slow_z_2
.back_z_3:
    v_cmp_ne_u32 vcc, s13, v61
    s_nop 0
    s_cmp_eq_u64 vcc, 0
    s_cselect_b32 s12, 1, 0
    v_mov_b32 v41, s11
    v_mov_b32 v43, s11
    s_mov_b32 exec_hi, 0
    s_cmp_eq_u32 s12, 0
    s_cbranch_scc1 .sc1_z_4
    buffer_store_dwordx4 v[40:43], v28, s[28:31], s76 offen
.back_z_5:
    s_mov_b64 exec, -1
    s_barrier
    ds_read_b64_tr_b16 v[32:33], v16 offset:36864
    ds_read_b64_tr_b16 v[34:35], v16 offset:37632
    ds_read_b64_tr_b16 v[36:37], v17 offset:36864
    ds_read_b64_tr_b16 v[38:39], v17 offset:37632
    ds_read_b64_tr_b16 v[40:41], v18 offset:36864
    ds_read_b64_tr_b16 v[42:43], v18 offset:37632
    ds_read_b64_tr_b16 v[44:45], v19 offset:36864
    ds_read_b64_tr_b16 v[46:47], v19 offset:37632
    s_waitcnt lgkmcnt(4)
    v_mfma_f32_16x16x32_bf16 v[144:147], v[32:35], a[0:3], 0
    ds_read_b64_tr_b16 v[48:49], v64 offset:36864
    ds_read_b64_tr_b16 v[50:51], v64 offset:37632
    v_mfma_f32_16x16x32_bf16 v[148:151], v[32:35], a[4:7], 0
    s_waitcnt vmcnt(17)
    ds_read_b128 a[160:163], v12 offset:4096
    ds_read_b128 a[164:167], v13 offset:4096
    buffer_load_dwordx4 v78, s[24:27], s82 offen offset:2048 lds
    v_mfma_f32_16x16x32_bf16 v[88:91], v[32:35], v[20:23], 0
    v_mfma_f32_16x16x32_bf16 v[152:155], v[36:39], a[0:3], 0
    ds_read_b64_tr_b16 v[52:53], v65 offset:36864
    ds_read_b64_tr_b16 v[54:55], v65 offset:37632
    v_mfma_f32_16x16x32_bf16 v[156:159], v[36:39], a[4:7], 0
    ds_read_b128 a[168:171], v14 offset:4096
    ds_read_b128 a[172:175], v15 offset:4096
    buffer_load_dwordx4 v79, s[24:27], s82 offen offset:3072 lds
    v_mfma_f32_16x16x32_bf16 v[92:95], v[36:39], v[20:23], 0
    s_waitcnt lgkmcnt(8)
    v_mfma_f32_16x16x32_bf16 v[160:163], v[40:43], a[0:3], 0
    ds_read_b64_tr_b16 v[56:57], v16 offset:43008
    ds_read_b64_tr_b16 v[58:59], v16 offset:43776
    v_mfma_f32_16x16x32_bf16 v[164:167], v[40:43], a[4:7], 0
    v_mfma_f32_16x16x32_bf16 v[168:171], v[44:47], a[0:3], 0
    ds_read_b64_tr_b16 v[60:61], v17 offset:43008
    ds_read_b64_tr_b16 v[62:63], v17 offset:43776
    v_mfma_f32_16x16x32_bf16 v[172:175], v[44:47], a[4:7], 0
    s_waitcnt lgkmcnt(6)
    v_mfma_f32_16x16x32_bf16 v[176:179], v[48:51], a[0:3], 0
    ds_read_b64_tr_b16 v[32:33], v18 offset:43008
    ds_read_b64_tr_b16 v[34:35], v18 offset:43776
    v_mfma_f32_16x16x32_bf16 v[180:183], v[48:51], a[4:7], 0
    s_waitcnt lgkmcnt(6)
    s_add_u32 m0, s54, 4096
    s_add_u32 s82, s52, s0
    v_mfma_f32_16x16x32_bf16 v[184:187], v[52:55], a[0:3], 0
    ds_read_b64_tr_b16 v[36:37], v19 offset:43008
    ds_read_b64_tr_b16 v[38:39], v19 offset:43776
    v_mfma_f32_16x16x32_bf16 v[188:191], v[52:55], a[4:7], 0
    buffer_load_dwordx4 v[192:195], v28, s[28:31], s75 offen offset:0 sc1
    buffer_load_dwordx4 v[196:199], v28, s[28:31], s75 offen offset:1024 sc1
    buffer_load_dwordx4 v[200:203], v28, s[28:31], s75 offen offset:2048 sc1
    buffer_load_dwordx4 v[204:207], v28, s[28:31], s75 offen offset:3072 sc1
    s_waitcnt lgkmcnt(4)
    v_mfma_f32_16x16x32_bf16 v[144:147], v[56:59], a[8:11], v[144:147]
    ds_read_b64_tr_b16 v[40:41], v64 offset:43008
    ds_read_b64_tr_b16 v[42:43], v64 offset:43776
    v_mfma_f32_16x16x32_bf16 v[148:151], v[56:59], a[12:15], v[148:151]
    v_mfma_f32_16x16x32_bf16 v[88:91], v[56:59], v[20:23], v[88:91]
    v_mfma_f32_16x16x32_bf16 v[152:155], v[60:63], a[8:11], v[152:155]
    ds_read_b64_tr_b16 v[44:45], v65 offset:43008
    ds_read_b64_tr_b16 v[46:47], v65 offset:43776
    v_mfma_f32_16x16x32_bf16 v[156:159], v[60:63], a[12:15], v[156:159]
    s_waitcnt vmcnt(16)
    ds_read_b128 a[144:147], v12 offset:8192
    ds_read_b128 a[148:151], v13 offset:8192
    buffer_load_dwordx4 v76, s[24:27], s82 offen offset:0 lds
    v_mfma_f32_16x16x32_bf16 v[92:95], v[60:63], v[20:23], v[92:95]
    s_waitcnt lgkmcnt(6)
    v_mfma_f32_16x16x32_bf16 v[160:163], v[32:35], a[8:11], v[160:163]
    s_barrier
    ds_read_b64_tr_b16 v[48:49], v16 offset:49152
    ds_read_b64_tr_b16 v[50:51], v16 offset:49920
    v_mfma_f32_16x16x32_bf16 v[164:167], v[32:35], a[12:15], v[164:167]
    ds_read_b128 a[152:155], v14 offset:8192
    ds_read_b128 a[156:159], v15 offset:8192
    buffer_load_dwordx4 v77, s[24:27], s82 offen offset:1024 lds
    v_mfma_f32_16x16x32_bf16 v[168:171], v[36:39], a[8:11], v[168:171]
    ds_read_b64_tr_b16 v[52:53], v17 offset:49152
    ds_read_b64_tr_b16 v[54:55], v17 offset:49920
    v_mfma_f32_16x16x32_bf16 v[172:175], v[36:39], a[12:15], v[172:175]
    s_waitcnt lgkmcnt(8)
    v_mfma_f32_16x16x32_bf16 v[176:179], v[40:43], a[8:11], v[176:179]
    ds_read_b64_tr_b16 v[56:57], v18 offset:49152
    ds_read_b64_tr_b16 v[58:59], v18 offset:49920
    v_mfma_f32_16x16x32_bf16 v[180:183], v[40:43], a[12:15], v[180:183]
    buffer_load_dwordx4 v78, s[24:27], s82 offen offset:2048 lds
    v_mfma_f32_16x16x32_bf16 v[184:187], v[44:47], a[8:11], v[184:187]
    ds_read_b64_tr_b16 v[60:61], v19 offset:49152
    ds_read_b64_tr_b16 v[62:63], v19 offset:49920
    v_mfma_f32_16x16x32_bf16 v[188:191], v[44:47], a[12:15], v[188:191]
    s_waitcnt lgkmcnt(6)
    s_waitcnt lgkmcnt(4)
    v_mfma_f32_16x16x32_bf16 v[144:147], v[48:51], a[16:19], v[144:147]
    ds_read_b64_tr_b16 v[32:33], v64 offset:49152
    ds_read_b64_tr_b16 v[34:35], v64 offset:49920
    v_mfma_f32_16x16x32_bf16 v[148:151], v[48:51], a[20:23], v[148:151]
    buffer_load_dwordx4 v79, s[24:27], s82 offen offset:3072 lds
    v_mfma_f32_16x16x32_bf16 v[88:91], v[48:51], v[20:23], v[88:91]
    v_mfma_f32_16x16x32_bf16 v[152:155], v[52:55], a[16:19], v[152:155]
    ds_read_b64_tr_b16 v[36:37], v65 offset:49152
    ds_read_b64_tr_b16 v[38:39], v65 offset:49920
    v_mfma_f32_16x16x32_bf16 v[156:159], v[52:55], a[20:23], v[156:159]
    s_add_u32 m0, s54, 8192
    s_add_u32 s0, s0, 128
    s_and_b32 s0, s0, 1023
    s_add_u32 s82, s73, s0
    v_mfma_f32_16x16x32_bf16 v[92:95], v[52:55], v[20:23], v[92:95]
    s_waitcnt lgkmcnt(4)
    v_mfma_f32_16x16x32_bf16 v[160:163], v[56:59], a[16:19], v[160:163]
    ds_read_b64_tr_b16 v[40:41], v16 offset:55296
    ds_read_b64_tr_b16 v[42:43], v16 offset:56064
    v_mfma_f32_16x16x32_bf16 v[164:167], v[56:59], a[20:23], v[164:167]
    s_waitcnt vmcnt(4)
    s_mov_b32 s57, 0
.loop_z_6:
    v_xor_b32 v208, s11, v193
    v_xor_b32 v209, s11, v195
    v_xor_b32 v210, s11, v197
    v_xor_b32 v211, s11, v199
    v_xor_b32 v212, s11, v201
    v_xor_b32 v213, s11, v203
    v_xor_b32 v214, s11, v205
    v_xor_b32 v215, s11, v207
    v_or3_b32 v208, v208, v209, v210
    v_or3_b32 v211, v211, v212, v213
    v_or3_b32 v208, v208, v214, v215
    v_or_b32 v208, v208, v211
    v_cmp_ne_u32 vcc, 0, v208
    s_cbranch_vccz .ok_z_7
    s_add_u32 s57, s57, 1
    s_cmp_gt_u32 s57, 200000
    s_cbranch_scc1 .Lfail_2
    s_sleep 2
    buffer_load_dwordx4 v[192:195], v28, s[28:31], s75 offen offset:0 sc1
    buffer_load_dwordx4 v[196:199], v28, s[28:31], s75 offen offset:1024 sc1
    buffer_load_dwordx4 v[200:203], v28, s[28:31], s75 offen offset:2048 sc1
    buffer_load_dwordx4 v[204:207], v28, s[28:31], s75 offen offset:3072 sc1
    s_waitcnt vmcnt(0)
    s_branch .loop_z_6
.ok_z_7:
    v_add_f32 v208, v192, v196
    v_add_f32 v209, v200, v204
    v_add_f32 v210, v194, v198
    v_add_f32 v211, v202, v206
    v_add_f32 v208, v208, v209
    v_add_f32 v210, v210, v211
    v_mov_b32 v209, v208
    v_mov_b32 v211, v210
    s_nop 0
    v_permlane32_swap_b32 v208, v209
    v_permlane32_swap_b32 v210, v211
    v_add_f32 v208, v208, v209
    v_add_f32 v210, v210, v211
    v_mul_f32 v208, 3133047546, v208
    v_mul_f32 v210, 985563898, v210
    s_mov_b32 s64, 0xffff0000
    s_mov_b32 s65, 0xffff0000
    v_cndmask_b32 v212, v25, v27, s[64:65]
    v_fma_f32 v210, -v208, v208, v210
    v_mul_f32 v209, v212, v212
    v_mov_b32 v211, 925353388
    v_max_f32 v210, 0, v210
    v_fma_f32 v210, v210, v209, v211
    v_rsq_f32 v210, v210
    s_nop 0
    v_mul_f32 v81, v210, v212
    v_mul_f32 v80, v208, v81
    v_mov_b32 v75, v81
    v_mov_b32 v74, v80
    s_nop 0
    v_permlane16_swap_b32 v81, v75
    v_permlane16_swap_b32 v80, v74
    v_pk_fma_f32 v[96:97], v[96:97], v[80:81], v[80:81] op_sel:[0,1,0] op_sel_hi:[1,1,0]
    v_pk_fma_f32 v[98:99], v[98:99], v[80:81], v[80:81] op_sel:[0,1,0] op_sel_hi:[1,1,0]
    v_cvt_pk_bf16_f32 v96, v96, v97
    v_cvt_pk_bf16_f32 v97, v98, v99
    ds_write_b64 v82, v[96:97] offset:0
    v_pk_fma_f32 v[100:101], v[100:101], v[74:75], v[74:75] op_sel:[0,1,0] op_sel_hi:[1,1,0]
    v_pk_fma_f32 v[102:103], v[102:103], v[74:75], v[74:75] op_sel:[0,1,0] op_sel_hi:[1,1,0]
    v_cvt_pk_bf16_f32 v98, v100, v101
    v_cvt_pk_bf16_f32 v99, v102, v103
    ds_write_b64 v82, v[98:99] offset:3200
    v_pk_fma_f32 v[104:105], v[104:105], v[80:81], v[80:81] op_sel:[0,1,0] op_sel_hi:[1,1,0]
    v_pk_fma_f32 v[106:107], v[106:107], v[80:81], v[80:81] op_sel:[0,1,0] op_sel_hi:[1,1,0]
    v_cvt_pk_bf16_f32 v100, v104, v105
    v_cvt_pk_bf16_f32 v101, v106, v107
    ds_write_b64 v82, v[100:101] offset:32
    v_pk_fma_f32 v[108:109], v[108:109], v[74:75], v[74:75] op_sel:[0,1,0] op_sel_hi:[1,1,0]
    v_pk_fma_f32 v[110:111], v[110:111], v[74:75], v[74:75] op_sel:[0,1,0] op_sel_hi:[1,1,0]
    v_cvt_pk_bf16_f32 v102, v108, v109
    v_cvt_pk_bf16_f32 v103, v110, v111
    ds_write_b64 v82, v[102:103] offset:3232
    v_pk_fma_f32 v[112:113], v[112:113], v[80:81], v[80:81] op_sel:[0,1,0] op_sel_hi:[1,1,0]
    v_pk_fma_f32 v[114:115], v[114:115], v[80:81], v[80:81] op_sel:[0,1,0] op_sel_hi:[1,1,0]
    v_cvt_pk_bf16_f32 v104, v112, v113
    v_cvt_pk_bf16_f32 v105, v114, v115
    ds_write_b64 v66, v[104:105] offset:0
    v_pk_fma_f32 v[116:117], v[116:117], v[74:75], v[74:75] op_sel:[0,1,0] op_sel_hi:[1,1,0]
    v_pk_fma_f32 v[118:119], v[118:119], v[74:75], v[74:75] op_sel:[0,1,0] op_sel_hi:[1,1,0]
    v_cvt_pk_bf16_f32 v106, v116, v117
    v_cvt_pk_bf16_f32 v107, v118, v119
    ds_write_b64 v66, v[106:107] offset:3200
    v_pk_fma_f32 v[120:121], v[120:121], v[80:81], v[80:81] op_sel:[0,1,0] op_sel_hi:[1,1,0]
    v_pk_fma_f32 v[122:123], v[122:123], v[80:81], v[80:81] op_sel:[0,1,0] op_sel_hi:[1,1,0]
    v_cvt_pk_bf16_f32 v108, v120, v121
    v_cvt_pk_bf16_f32 v109, v122, v123
    ds_write_b64 v66, v[108:109] offset:32
    v_pk_fma_f32 v[124:125], v[124:125], v[74:75], v[74:75] op_sel:[0,1,0] op_sel_hi:[1,1,0]
    v_pk_fma_f32 v[126:127], v[126:127], v[74:75], v[74:75] op_sel:[0,1,0] op_sel_hi:[1,1,0]
    v_cvt_pk_bf16_f32 v110, v124, v125
    v_cvt_pk_bf16_f32 v111, v126, v127
    ds_write_b64 v66, v[110:111] offset:3232
    v_pk_fma_f32 v[128:129], v[128:129], v[80:81], v[80:81] op_sel:[0,1,0] op_sel_hi:[1,1,0]
    v_pk_fma_f32 v[130:131], v[130:131], v[80:81], v[80:81] op_sel:[0,1,0] op_sel_hi:[1,1,0]
    v_cvt_pk_bf16_f32 v112, v128, v129
    v_cvt_pk_bf16_f32 v113, v130, v131
    ds_write_b64 v67, v[112:113] offset:0
    v_pk_fma_f32 v[132:133], v[132:133], v[74:75], v[74:75] op_sel:[0,1,0] op_sel_hi:[1,1,0]
    v_pk_fma_f32 v[134:135], v[134:135], v[74:75], v[74:75] op_sel:[0,1,0] op_sel_hi:[1,1,0]
    v_cvt_pk_bf16_f32 v114, v132, v133
    v_cvt_pk_bf16_f32 v115, v134, v135
    ds_write_b64 v67, v[114:115] offset:3200
    v_pk_fma_f32 v[136:137], v[136:137], v[80:81], v[80:81] op_sel:[0,1,0] op_sel_hi:[1,1,0]
    v_pk_fma_f32 v[138:139], v[138:139], v[80:81], v[80:81] op_sel:[0,1,0] op_sel_hi:[1,1,0]
    v_cvt_pk_bf16_f32 v116, v136, v137
    v_cvt_pk_bf16_f32 v117, v138, v139
    ds_write_b64 v67, v[116:117] offset:32
    v_pk_fma_f32 v[140:141], v[140:141], v[74:75], v[74:75] op_sel:[0,1,0] op_sel_hi:[1,1,0]
    v_pk_fma_f32 v[142:143], v[142:143], v[74:75], v[74:75] op_sel:[0,1,0] op_sel_hi:[1,1,0]
    v_cvt_pk_bf16_f32 v118, v140, v141
    v_cvt_pk_bf16_f32 v119, v142, v143
    ds_write_b64 v67, v[118:119] offset:3232
    ds_read_b128 a[176:179], v12 offset:12288
    ds_read_b128 a[180:183], v13 offset:12288
    buffer_load_dwordx4 v76, s[24:27], s82 offen offset:0 lds
    v_mfma_f32_16x16x32_bf16 v[168:171], v[60:63], a[16:19], v[168:171]
    ds_read_b64_tr_b16 v[44:45], v17 offset:55296
    ds_read_b64_tr_b16 v[46:47], v17 offset:56064
    v_mfma_f32_16x16x32_bf16 v[172:175], v[60:63], a[20:23], v[172:175]
    ds_read_b128 a[184:187], v14 offset:12288
    ds_read_b128 a[188:191], v15 offset:12288
    s_waitcnt lgkmcnt(14)
    v_mfma_f32_16x16x32_bf16 v[176:179], v[32:35], a[16:19], v[176:179]
    ds_read_b64_tr_b16 v[48:49], v18 offset:55296
    ds_read_b64_tr_b16 v[50:51], v18 offset:56064
    v_mfma_f32_16x16x32_bf16 v[180:183], v[32:35], a[20:23], v[180:183]
    s_waitcnt lgkmcnt(8)
    ds_read_b64_tr_b16 v[120:121], v83 offset:0
    ds_read_b64_tr_b16 v[122:123], v83 offset:800
    ds_read_b64_tr_b16 v[124:125], v83 offset:64
    ds_read_b64_tr_b16 v[126:127], v83 offset:864
    ds_read_b64_tr_b16 v[128:129], v83 offset:128
    ds_read_b64_tr_b16 v[130:131], v83 offset:928
    ds_read_b64_tr_b16 v[132:133], v83 offset:3200
    ds_read_b64_tr_b16 v[134:135], v83 offset:4000
    ds_read_b64_tr_b16 v[136:137], v83 offset:3264
    ds_read_b64_tr_b16 v[138:139], v83 offset:4064
    ds_read_b64_tr_b16 v[140:141], v83 offset:3328
    ds_read_b64_tr_b16 v[142:143], v83 offset:4128
    s_waitcnt lgkmcnt(14)
    ds_read_b128 a[192:195], v12 offset:0
    ds_read_b128 a[196:199], v13 offset:0
    buffer_load_dwordx4 v77, s[24:27], s82 offen offset:1024 lds
    v_mfma_f32_16x16x32_bf16 v[184:187], v[36:39], a[16:19], v[184:187]
    ds_read_b64_tr_b16 v[52:53], v19 offset:55296
    ds_read_b64_tr_b16 v[54:55], v19 offset:56064
    v_mfma_f32_16x16x32_bf16 v[188:191], v[36:39], a[20:23], v[188:191]
    ds_read_b128 a[200:203], v14 offset:0
    ds_read_b128 a[204:207], v15 offset:0
    v_mfma_f32_16x16x32_bf16 v[144:147], v[40:43], a[24:27], v[144:147]
    ds_read_b64_tr_b16 v[56:57], v64 offset:55296
    ds_read_b64_tr_b16 v[58:59], v64 offset:56064
    v_mfma_f32_16x16x32_bf16 v[148:151], v[40:43], a[28:31], v[148:151]
    s_waitcnt lgkmcnt(14)
    buffer_store_dwordx4 v[120:123], v28, s[28:31], s77 offen offset:0 sc1
    s_waitcnt lgkmcnt(14)
    buffer_store_dwordx4 v[124:127], v28, s[28:31], s77 offen offset:1024 sc1
    s_waitcnt lgkmcnt(14)
    buffer_store_dwordx4 v[128:131], v28, s[28:31], s77 offen offset:2048 sc1
    s_waitcnt lgkmcnt(12)
    buffer_store_dwordx4 v[132:135], v28, s[28:31], s78 offen offset:0 sc1
    s_waitcnt lgkmcnt(10)
    buffer_store_dwordx4 v[136:139], v28, s[28:31], s78 offen offset:1024 sc1
    s_waitcnt lgkmcnt(8)
    buffer_store_dwordx4 v[140:143], v28, s[28:31], s78 offen offset:2048 sc1
    s_waitcnt vmcnt(8)
    s_waitcnt lgkmcnt(2)
    ds_read_b128 a[224:227], v12 offset:4096
    ds_read_b128 a[228:231], v13 offset:4096
    v_mfma_f32_16x16x32_bf16 v[88:91], v[40:43], v[20:23], v[88:91]
    v_mfma_f32_16x16x32_bf16 v[152:155], v[44:47], a[24:27], v[152:155]
    ds_read_b64_tr_b16 v[60:61], v65 offset:55296
    ds_read_b64_tr_b16 v[62:63], v65 offset:56064
    v_mfma_f32_16x16x32_bf16 v[156:159], v[44:47], a[28:31], v[156:159]
    ds_read_b128 a[232:235], v14 offset:4096
    ds_read_b128 a[236:239], v15 offset:4096
    buffer_load_dwordx4 v78, s[24:27], s82 offen offset:2048 lds
    v_mfma_f32_16x16x32_bf16 v[92:95], v[44:47], v[20:23], v[92:95]
    v_mfma_f32_16x16x32_bf16 v[160:163], v[48:51], a[24:27], v[160:163]
    s_barrier
    ds_read_b64_tr_b16 v[32:33], v16 offset:0
    ds_read_b64_tr_b16 v[34:35], v16 offset:768
    v_mfma_f32_16x16x32_bf16 v[164:167], v[48:51], a[28:31], v[164:167]
    buffer_load_dwordx4 v79, s[24:27], s82 offen offset:3072 lds
    v_mfma_f32_16x16x32_bf16 v[168:171], v[52:55], a[24:27], v[168:171]
    ds_read_b64_tr_b16 v[36:37], v17 offset:0
    ds_read_b64_tr_b16 v[38:39], v17 offset:768
    v_mfma_f32_16x16x32_bf16 v[172:175], v[52:55], a[28:31], v[172:175]
    s_add_u32 m0, s55, 36864
    s_add_u32 s1, s56, 880640
    s_waitcnt lgkmcnt(4)
    v_mfma_f32_16x16x32_bf16 v[176:179], v[56:59], a[24:27], v[176:179]
    ds_read_b64_tr_b16 v[40:41], v18 offset:0
    ds_read_b64_tr_b16 v[42:43], v18 offset:768
    v_mfma_f32_16x16x32_bf16 v[180:183], v[56:59], a[28:31], v[180:183]
    buffer_load_dwordx4 v8, s[20:23], s1 offen offset:0 lds
    v_mfma_f32_16x16x32_bf16 v[184:187], v[60:63], a[24:27], v[184:187]
    ds_read_b64_tr_b16 v[44:45], v19 offset:0
    ds_read_b64_tr_b16 v[46:47], v19 offset:768
    v_mfma_f32_16x16x32_bf16 v[188:191], v[60:63], a[28:31], v[188:191]
    s_waitcnt lgkmcnt(4)
    v_mfma_f32_16x16x32_bf16 v[144:147], v[32:35], a[32:35], v[144:147]
    ds_read_b64_tr_b16 v[48:49], v64 offset:0
    ds_read_b64_tr_b16 v[50:51], v64 offset:768
    v_mfma_f32_16x16x32_bf16 v[148:151], v[32:35], a[36:39], v[148:151]
    buffer_load_dwordx4 v9, s[20:23], s1 offen offset:1024 lds
    v_mfma_f32_16x16x32_bf16 v[88:91], v[32:35], v[20:23], v[88:91]
    v_mfma_f32_16x16x32_bf16 v[152:155], v[36:39], a[32:35], v[152:155]
    ds_read_b64_tr_b16 v[52:53], v65 offset:0
    ds_read_b64_tr_b16 v[54:55], v65 offset:768
    v_mfma_f32_16x16x32_bf16 v[156:159], v[36:39], a[36:39], v[156:159]
    v_mfma_f32_16x16x32_bf16 v[92:95], v[36:39], v[20:23], v[92:95]
    s_waitcnt lgkmcnt(4)
    v_mfma_f32_16x16x32_bf16 v[160:163], v[40:43], a[32:35], v[160:163]
    ds_read_b64_tr_b16 v[56:57], v16 offset:6144
    ds_read_b64_tr_b16 v[58:59], v16 offset:6912
    v_mfma_f32_16x16x32_bf16 v[164:167], v[40:43], a[36:39], v[164:167]
    buffer_load_dwordx4 v10, s[20:23], s1 offen offset:2048 lds
    v_mfma_f32_16x16x32_bf16 v[168:171], v[44:47], a[32:35], v[168:171]
    ds_read_b64_tr_b16 v[60:61], v17 offset:6144
    ds_read_b64_tr_b16 v[62:63], v17 offset:6912
    v_mfma_f32_16x16x32_bf16 v[172:175], v[44:47], a[36:39], v[172:175]
    s_add_u32 m0, s54, 12288
    s_add_u32 s82, s52, s0
    s_waitcnt lgkmcnt(4)
    v_mfma_f32_16x16x32_bf16 v[176:179], v[48:51], a[32:35], v[176:179]
    ds_read_b64_tr_b16 v[32:33], v18 offset:6144
    ds_read_b64_tr_b16 v[34:35], v18 offset:6912
    v_mfma_f32_16x16x32_bf16 v[180:183], v[48:51], a[36:39], v[180:183]
    buffer_load_dwordx4 v76, s[24:27], s82 offen offset:0 lds
    v_mfma_f32_16x16x32_bf16 v[184:187], v[52:55], a[32:35], v[184:187]
    ds_read_b64_tr_b16 v[36:37], v19 offset:6144
    ds_read_b64_tr_b16 v[38:39], v19 offset:6912
    v_mfma_f32_16x16x32_bf16 v[188:191], v[52:55], a[36:39], v[188:191]
    s_waitcnt lgkmcnt(4)
    v_mfma_f32_16x16x32_bf16 v[144:147], v[56:59], a[40:43], v[144:147]
    ds_read_b64_tr_b16 v[40:41], v64 offset:6144
    ds_read_b64_tr_b16 v[42:43], v64 offset:6912
    v_mfma_f32_16x16x32_bf16 v[148:151], v[56:59], a[44:47], v[148:151]
    buffer_load_dwordx4 v77, s[24:27], s82 offen offset:1024 lds
    v_mfma_f32_16x16x32_bf16 v[88:91], v[56:59], v[20:23], v[88:91]
    v_mfma_f32_16x16x32_bf16 v[152:155], v[60:63], a[40:43], v[152:155]
    ds_read_b64_tr_b16 v[44:45], v65 offset:6144
    ds_read_b64_tr_b16 v[46:47], v65 offset:6912
    v_mfma_f32_16x16x32_bf16 v[156:159], v[60:63], a[44:47], v[156:159]
    buffer_load_dwordx4 v78, s[24:27], s82 offen offset:2048 lds
    v_mfma_f32_16x16x32_bf16 v[92:95], v[60:63], v[20:23], v[92:95]
    s_waitcnt lgkmcnt(4)
    v_mfma_f32_16x16x32_bf16 v[160:163], v[32:35], a[40:43], v[160:163]
    s_barrier
    ds_read_b64_tr_b16 v[48:49], v16 offset:12288
    ds_read_b64_tr_b16 v[50:51], v16 offset:13056
    v_mfma_f32_16x16x32_bf16 v[164:167], v[32:35], a[44:47], v[164:167]
    s_waitcnt vmcnt(6)
    ds_read_b128 a[208:211], v12 offset:8192
    ds_read_b128 a[212:215], v13 offset:8192
    buffer_load_dwordx4 v79, s[24:27], s82 offen offset:3072 lds
    v_mfma_f32_16x16x32_bf16 v[168:171], v[36:39], a[40:43], v[168:171]
    ds_read_b64_tr_b16 v[52:53], v17 offset:12288
    ds_read_b64_tr_b16 v[54:55], v17 offset:13056
    v_mfma_f32_16x16x32_bf16 v[172:175], v[36:39], a[44:47], v[172:175]
    s_add_u32 m0, s55, 49152
    s_add_u32 s1, s56, 1056768
    ds_read_b128 a[216:219], v14 offset:8192
    ds_read_b128 a[220:223], v15 offset:8192
    s_waitcnt lgkmcnt(8)
    v_mfma_f32_16x16x32_bf16 v[176:179], v[40:43], a[40:43], v[176:179]
    ds_read_b64_tr_b16 v[56:57], v18 offset:12288
    ds_read_b64_tr_b16 v[58:59], v18 offset:13056
    v_mfma_f32_16x16x32_bf16 v[180:183], v[40:43], a[44:47], v[180:183]
    buffer_load_dwordx4 v8, s[20:23], s1 offen offset:0 lds
    v_mfma_f32_16x16x32_bf16 v[184:187], v[44:47], a[40:43], v[184:187]
    ds_read_b64_tr_b16 v[60:61], v19 offset:12288
    ds_read_b64_tr_b16 v[62:63], v19 offset:13056
    v_mfma_f32_16x16x32_bf16 v[188:191], v[44:47], a[44:47], v[188:191]
    s_waitcnt lgkmcnt(6)
    v_mfma_f32_16x16x32_bf16 v[144:147], v[48:51], a[48:51], v[144:147]
    ds_read_b64_tr_b16 v[32:33], v64 offset:12288
    ds_read_b64_tr_b16 v[34:35], v64 offset:13056
    v_mfma_f32_16x16x32_bf16 v[148:151], v[48:51], a[52:55], v[148:151]
    buffer_load_dwordx4 v9, s[20:23], s1 offen offset:1024 lds
    s_waitcnt lgkmcnt(6)
    v_mfma_f32_16x16x32_bf16 v[88:91], v[48:51], v[20:23], v[88:91]
    v_mfma_f32_16x16x32_bf16 v[152:155], v[52:55], a[48:51], v[152:155]
    ds_read_b64_tr_b16 v[36:37], v65 offset:12288
    ds_read_b64_tr_b16 v[38:39], v65 offset:13056
    v_mfma_f32_16x16x32_bf16 v[156:159], v[52:55], a[52:55], v[156:159]
    v_mfma_f32_16x16x32_bf16 v[92:95], v[52:55], v[20:23], v[92:95]
    s_waitcnt lgkmcnt(4)
    v_mfma_f32_16x16x32_bf16 v[160:163], v[56:59], a[48:51], v[160:163]
    ds_read_b64_tr_b16 v[40:41], v16 offset:18432
    ds_read_b64_tr_b16 v[42:43], v16 offset:19200
    v_mfma_f32_16x16x32_bf16 v[164:167], v[56:59], a[52:55], v[164:167]
    buffer_load_dwordx4 v10, s[20:23], s1 offen offset:2048 lds
    v_mfma_f32_16x16x32_bf16 v[168:171], v[60:63], a[48:51], v[168:171]
    ds_read_b64_tr_b16 v[44:45], v17 offset:18432
    ds_read_b64_tr_b16 v[46:47], v17 offset:19200
    v_mfma_f32_16x16x32_bf16 v[172:175], v[60:63], a[52:55], v[172:175]
    s_add_u32 m0, s54, 0
    s_add_u32 s0, s0, 128
    s_and_b32 s0, s0, 1023
    s_add_u32 s82, s73, s0
    s_waitcnt lgkmcnt(4)
    v_mfma_f32_16x16x32_bf16 v[176:179], v[32:35], a[48:51], v[176:179]
    ds_read_b64_tr_b16 v[48:49], v18 offset:18432
    ds_read_b64_tr_b16 v[50:51], v18 offset:19200
    v_mfma_f32_16x16x32_bf16 v[180:183], v[32:35], a[52:55], v[180:183]
    buffer_load_dwordx4 v76, s[24:27], s82 offen offset:0 lds
    v_mfma_f32_16x16x32_bf16 v[184:187], v[36:39], a[48:51], v[184:187]
    ds_read_b64_tr_b16 v[52:53], v19 offset:18432
    ds_read_b64_tr_b16 v[54:55], v19 offset:19200
    v_mfma_f32_16x16x32_bf16 v[188:191], v[36:39], a[52:55], v[188:191]
    s_waitcnt lgkmcnt(4)
    v_mfma_f32_16x16x32_bf16 v[144:147], v[40:43], a[56:59], v[144:147]
    ds_read_b64_tr_b16 v[56:57], v64 offset:18432
    ds_read_b64_tr_b16 v[58:59], v64 offset:19200
    v_mfma_f32_16x16x32_bf16 v[148:151], v[40:43], a[60:63], v[148:151]
    buffer_load_dwordx4 v77, s[24:27], s82 offen offset:1024 lds
    v_mfma_f32_16x16x32_bf16 v[88:91], v[40:43], v[20:23], v[88:91]
    v_mfma_f32_16x16x32_bf16 v[152:155], v[44:47], a[56:59], v[152:155]
    ds_read_b64_tr_b16 v[60:61], v65 offset:18432
    ds_read_b64_tr_b16 v[62:63], v65 offset:19200
    v_mfma_f32_16x16x32_bf16 v[156:159], v[44:47], a[60:63], v[156:159]
    buffer_load_dwordx4 v78, s[24:27], s82 offen offset:2048 lds
    v_mfma_f32_16x16x32_bf16 v[92:95], v[44:47], v[20:23], v[92:95]
    s_waitcnt lgkmcnt(4)
    v_mfma_f32_16x16x32_bf16 v[160:163], v[48:51], a[56:59], v[160:163]
    s_barrier
    ds_read_b64_tr_b16 v[32:33], v16 offset:24576
    ds_read_b64_tr_b16 v[34:35], v16 offset:25344
    v_mfma_f32_16x16x32_bf16 v[164:167], v[48:51], a[60:63], v[164:167]
    v_mov_b32 v2, s11
    v_mov_b32 v3, 0
    s_mov_b64 exec, 1
    buffer_store_dword v2, v3, s[28:31], s79 offen sc1
    s_mov_b64 exec, -1
    v_mfma_f32_16x16x32_bf16 v[168:171], v[52:55], a[56:59], v[168:171]
    ds_read_b64_tr_b16 v[36:37], v17 offset:24576
    ds_read_b64_tr_b16 v[38:39], v17 offset:25344
    v_mfma_f32_16x16x32_bf16 v[172:175], v[52:55], a[60:63], v[172:175]
    s_waitcnt lgkmcnt(4)
    v_mfma_f32_16x16x32_bf16 v[176:179], v[56:59], a[56:59], v[176:179]
    ds_read_b64_tr_b16 v[40:41], v18 offset:24576
    ds_read_b64_tr_b16 v[42:43], v18 offset:25344
    v_mfma_f32_16x16x32_bf16 v[180:183], v[56:59], a[60:63], v[180:183]
    buffer_load_dwordx4 v79, s[24:27], s82 offen offset:3072 lds
    v_mfma_f32_16x16x32_bf16 v[184:187], v[60:63], a[56:59], v[184:187]
    ds_read_b64_tr_b16 v[44:45], v19 offset:24576
    ds_read_b64_tr_b16 v[46:47], v19 offset:25344
    v_mfma_f32_16x16x32_bf16 v[188:191], v[60:63], a[60:63], v[188:191]
    s_add_u32 m0, s55, 0
    s_add_u32 s1, s56, 1232896
    s_waitcnt lgkmcnt(4)
    v_mfma_f32_16x16x32_bf16 v[144:147], v[32:35], a[64:67], v[144:147]
    ds_read_b64_tr_b16 v[48:49], v64 offset:24576
    ds_read_b64_tr_b16 v[50:51], v64 offset:25344
    v_mfma_f32_16x16x32_bf16 v[148:151], v[32:35], a[68:71], v[148:151]
    buffer_load_dwordx4 v8, s[20:23], s1 offen offset:0 lds
    s_waitcnt vmcnt(9)
    ds_read_b128 a[240:243], v12 offset:12288
    ds_read_b128 a[244:247], v13 offset:12288
    v_mfma_f32_16x16x32_bf16 v[88:91], v[32:35], v[20:23], v[88:91]
    v_mfma_f32_16x16x32_bf16 v[152:155], v[36:39], a[64:67], v[152:155]
    ds_read_b64_tr_b16 v[52:53], v65 offset:24576
    ds_read_b64_tr_b16 v[54:55], v65 offset:25344
    v_mfma_f32_16x16x32_bf16 v[156:159], v[36:39], a[68:71], v[156:159]
    ds_read_b128 a[248:251], v14 offset:12288
    ds_read_b128 a[252:255], v15 offset:12288
    v_mfma_f32_16x16x32_bf16 v[92:95], v[36:39], v[20:23], v[92:95]
    s_waitcnt lgkmcnt(8)
    v_mfma_f32_16x16x32_bf16 v[160:163], v[40:43], a[64:67], v[160:163]
    ds_read_b64_tr_b16 v[56:57], v16 offset:30720
    ds_read_b64_tr_b16 v[58:59], v16 offset:31488
    v_mfma_f32_16x16x32_bf16 v[164:167], v[40:43], a[68:71], v[164:167]
    buffer_load_dwordx4 v9, s[20:23], s1 offen offset:1024 lds
    v_mfma_f32_16x16x32_bf16 v[168:171], v[44:47], a[64:67], v[168:171]
    ds_read_b64_tr_b16 v[60:61], v17 offset:30720
    ds_read_b64_tr_b16 v[62:63], v17 offset:31488
    v_mfma_f32_16x16x32_bf16 v[172:175], v[44:47], a[68:71], v[172:175]
    s_waitcnt lgkmcnt(6)
    v_mfma_f32_16x16x32_bf16 v[176:179], v[48:51], a[64:67], v[176:179]
    ds_read_b64_tr_b16 v[32:33], v18 offset:30720
    ds_read_b64_tr_b16 v[34:35], v18 offset:31488
    v_mfma_f32_16x16x32_bf16 v[180:183], v[48:51], a[68:71], v[180:183]
    buffer_load_dwordx4 v10, s[20:23], s1 offen offset:2048 lds
    s_waitcnt lgkmcnt(6)
    v_mfma_f32_16x16x32_bf16 v[184:187], v[52:55], a[64:67], v[184:187]
    ds_read_b64_tr_b16 v[36:37], v19 offset:30720
    ds_read_b64_tr_b16 v[38:39], v19 offset:31488
    v_mfma_f32_16x16x32_bf16 v[188:191], v[52:55], a[68:71], v[188:191]
    s_add_u32 m0, s54, 4096
    s_add_u32 s82, s52, s0
    s_waitcnt lgkmcnt(4)
    v_mfma_f32_16x16x32_bf16 v[144:147], v[56:59], a[72:75], v[144:147]
    ds_read_b64_tr_b16 v[40:41], v64 offset:30720
    ds_read_b64_tr_b16 v[42:43], v64 offset:31488
    v_mfma_f32_16x16x32_bf16 v[148:151], v[56:59], a[76:79], v[148:151]
    buffer_load_dwordx4 v76, s[24:27], s82 offen offset:0 lds
    v_mfma_f32_16x16x32_bf16 v[88:91], v[56:59], v[20:23], v[88:91]
    v_mfma_f32_16x16x32_bf16 v[152:155], v[60:63], a[72:75], v[152:155]
    ds_read_b64_tr_b16 v[44:45], v65 offset:30720
    ds_read_b64_tr_b16 v[46:47], v65 offset:31488
    v_mfma_f32_16x16x32_bf16 v[156:159], v[60:63], a[76:79], v[156:159]
    buffer_load_dwordx4 v77, s[24:27], s82 offen offset:1024 lds
    v_mfma_f32_16x16x32_bf16 v[92:95], v[60:63], v[20:23], v[92:95]
    s_waitcnt lgkmcnt(4)
    v_mfma_f32_16x16x32_bf16 v[160:163], v[32:35], a[72:75], v[160:163]
    s_barrier
    ds_read_b64_tr_b16 v[48:49], v16 offset:36864
    ds_read_b64_tr_b16 v[50:51], v16 offset:37632
    v_mfma_f32_16x16x32_bf16 v[164:167], v[32:35], a[76:79], v[164:167]
    buffer_load_dwordx4 v78, s[24:27], s82 offen offset:2048 lds
    v_mfma_f32_16x16x32_bf16 v[168:171], v[36:39], a[72:75], v[168:171]
    ds_read_b64_tr_b16 v[52:53], v17 offset:36864
    ds_read_b64_tr_b16 v[54:55], v17 offset:37632
    v_mfma_f32_16x16x32_bf16 v[172:175], v[36:39], a[76:79], v[172:175]
    s_waitcnt lgkmcnt(4)
    v_mfma_f32_16x16x32_bf16 v[176:179], v[40:43], a[72:75], v[176:179]
    ds_read_b64_tr_b16 v[56:57], v18 offset:36864
    ds_read_b64_tr_b16 v[58:59], v18 offset:37632
    v_mfma_f32_16x16x32_bf16 v[180:183], v[40:43], a[76:79], v[180:183]
    buffer_load_dwordx4 v79, s[24:27], s82 offen offset:3072 lds
    v_mfma_f32_16x16x32_bf16 v[184:187], v[44:47], a[72:75], v[184:187]
    ds_read_b64_tr_b16 v[60:61], v19 offset:36864
    ds_read_b64_tr_b16 v[62:63], v19 offset:37632
    v_mfma_f32_16x16x32_bf16 v[188:191], v[44:47], a[76:79], v[188:191]
    s_add_u32 m0, s54, 8192
    s_add_u32 s0, s0, 128
    s_and_b32 s0, s0, 1023
    s_add_u32 s82, s73, s0
    s_waitcnt lgkmcnt(4)
    v_mfma_f32_16x16x32_bf16 v[144:147], v[48:51], a[80:83], v[144:147]
    ds_read_b64_tr_b16 v[32:33], v64 offset:36864
    ds_read_b64_tr_b16 v[34:35], v64 offset:37632
    v_mfma_f32_16x16x32_bf16 v[148:151], v[48:51], a[84:87], v[148:151]
    s_waitcnt vmcnt(7)
    ds_read_b128 v[192:195], v12 offset:0
    ds_read_b128 v[196:199], v13 offset:0
    buffer_load_dwordx4 v76, s[24:27], s82 offen offset:0 lds
    v_mfma_f32_16x16x32_bf16 v[88:91], v[48:51], v[20:23], v[88:91]
    v_mfma_f32_16x16x32_bf16 v[152:155], v[52:55], a[80:83], v[152:155]
    ds_read_b64_tr_b16 v[36:37], v65 offset:36864
    ds_read_b64_tr_b16 v[38:39], v65 offset:37632
    v_mfma_f32_16x16x32_bf16 v[156:159], v[52:55], a[84:87], v[156:159]
    ds_read_b128 v[200:203], v14 offset:0
    ds_read_b128 v[204:207], v15 offset:0
    buffer_load_dwordx4 v77, s[24:27], s82 offen offset:1024 lds
    v_mfma_f32_16x16x32_bf16 v[92:95], v[52:55], v[20:23], v[92:95]
    s_waitcnt lgkmcnt(8)
    v_mfma_f32_16x16x32_bf16 v[160:163], v[56:59], a[80:83], v[160:163]
    ds_read_b64_tr_b16 v[40:41], v16 offset:43008
    ds_read_b64_tr_b16 v[42:43], v16 offset:43776
    v_mfma_f32_16x16x32_bf16 v[164:167], v[56:59], a[84:87], v[164:167]
    buffer_load_dwordx4 v78, s[24:27], s82 offen offset:2048 lds
    v_mfma_f32_16x16x32_bf16 v[168:171], v[60:63], a[80:83], v[168:171]
    ds_read_b64_tr_b16 v[44:45], v17 offset:43008
    ds_read_b64_tr_b16 v[46:47], v17 offset:43776
    v_mfma_f32_16x16x32_bf16 v[172:175], v[60:63], a[84:87], v[172:175]
    s_waitcnt lgkmcnt(4)
    v_mfma_f32_16x16x32_bf16 v[176:179], v[32:35], a[80:83], v[176:179]
    ds_read_b64_tr_b16 v[48:49], v18 offset:43008
    ds_read_b64_tr_b16 v[50:51], v18 offset:43776
    v_mfma_f32_16x16x32_bf16 v[180:183], v[32:35], a[84:87], v[180:183]
    buffer_load_dwordx4 v79, s[24:27], s82 offen offset:3072 lds
    v_mfma_f32_16x16x32_bf16 v[184:187], v[36:39], a[80:83], v[184:187]
    ds_read_b64_tr_b16 v[52:53], v19 offset:43008
    ds_read_b64_tr_b16 v[54:55], v19 offset:43776
    v_mfma_f32_16x16x32_bf16 v[188:191], v[36:39], a[84:87], v[188:191]
    s_add_u32 m0, s54, 12288
    s_add_u32 s82, s52, s0
    s_waitcnt lgkmcnt(4)
    v_mfma_f32_16x16x32_bf16 v[144:147], v[40:43], a[88:91], v[144:147]
    ds_read_b64_tr_b16 v[56:57], v64 offset:43008
    ds_read_b64_tr_b16 v[58:59], v64 offset:43776
    v_mfma_f32_16x16x32_bf16 v[148:151], v[40:43], a[92:95], v[148:151]
    buffer_load_dwordx4 v76, s[24:27], s82 offen offset:0 lds
    v_mfma_f32_16x16x32_bf16 v[88:91], v[40:43], v[20:23], v[88:91]
    v_mfma_f32_16x16x32_bf16 v[152:155], v[44:47], a[88:91], v[152:155]
    ds_read_b64_tr_b16 v[60:61], v65 offset:43008
    ds_read_b64_tr_b16 v[62:63], v65 offset:43776
    v_mfma_f32_16x16x32_bf16 v[156:159], v[44:47], a[92:95], v[156:159]
    buffer_load_dwordx4 v77, s[24:27], s82 offen offset:1024 lds
    v_mfma_f32_16x16x32_bf16 v[92:95], v[44:47], v[20:23], v[92:95]
    s_waitcnt lgkmcnt(4)
    v_mfma_f32_16x16x32_bf16 v[160:163], v[48:51], a[88:91], v[160:163]
    s_barrier
    ds_read_b64_tr_b16 v[32:33], v16 offset:49152
    ds_read_b64_tr_b16 v[34:35], v16 offset:49920
    v_mfma_f32_16x16x32_bf16 v[164:167], v[48:51], a[92:95], v[164:167]
    buffer_load_dwordx4 v78, s[24:27], s82 offen offset:2048 lds
    v_mfma_f32_16x16x32_bf16 v[168:171], v[52:55], a[88:91], v[168:171]
    ds_read_b64_tr_b16 v[36:37], v17 offset:49152
    ds_read_b64_tr_b16 v[38:39], v17 offset:49920
    v_mfma_f32_16x16x32_bf16 v[172:175], v[52:55], a[92:95], v[172:175]
    s_waitcnt lgkmcnt(4)
    v_mfma_f32_16x16x32_bf16 v[176:179], v[56:59], a[88:91], v[176:179]
    ds_read_b64_tr_b16 v[40:41], v18 offset:49152
    ds_read_b64_tr_b16 v[42:43], v18 offset:49920
    v_mfma_f32_16x16x32_bf16 v[180:183], v[56:59], a[92:95], v[180:183]
    buffer_load_dwordx4 v79, s[24:27], s82 offen offset:3072 lds
    v_mfma_f32_16x16x32_bf16 v[184:187], v[60:63], a[88:91], v[184:187]
    ds_read_b64_tr_b16 v[44:45], v19 offset:49152
    ds_read_b64_tr_b16 v[46:47], v19 offset:49920
    v_mfma_f32_16x16x32_bf16 v[188:191], v[60:63], a[92:95], v[188:191]
    s_add_u32 m0, s54, 0
    s_add_u32 s0, s0, 128
    s_and_b32 s0, s0, 1023
    s_add_u32 s82, s73, s0
    s_waitcnt lgkmcnt(4)
    v_mfma_f32_16x16x32_bf16 v[144:147], v[32:35], a[96:99], v[144:147]
    ds_read_b64_tr_b16 v[48:49], v64 offset:49152
    ds_read_b64_tr_b16 v[50:51], v64 offset:49920
    v_mfma_f32_16x16x32_bf16 v[148:151], v[32:35], a[100:103], v[148:151]
    buffer_load_dwordx4 v76, s[24:27], s82 offen offset:0 lds
    v_mfma_f32_16x16x32_bf16 v[88:91], v[32:35], v[20:23], v[88:91]
    v_mfma_f32_16x16x32_bf16 v[152:155], v[36:39], a[96:99], v[152:155]
    ds_read_b64_tr_b16 v[52:53], v65 offset:49152
    ds_read_b64_tr_b16 v[54:55], v65 offset:49920
    v_mfma_f32_16x16x32_bf16 v[156:159], v[36:39], a[100:103], v[156:159]
    s_waitcnt vmcnt(9)
    ds_read_b128 v[224:227], v12 offset:4096
    ds_read_b128 v[228:231], v13 offset:4096
    buffer_load_dwordx4 v77, s[24:27], s82 offen offset:1024 lds
    v_mfma_f32_16x16x32_bf16 v[92:95], v[36:39], v[20:23], v[92:95]
    s_waitcnt lgkmcnt(6)
    v_mfma_f32_16x16x32_bf16 v[160:163], v[40:43], a[96:99], v[160:163]
    ds_read_b64_tr_b16 v[56:57], v16 offset:55296
    ds_read_b64_tr_b16 v[58:59], v16 offset:56064
    v_mfma_f32_16x16x32_bf16 v[164:167], v[40:43], a[100:103], v[164:167]
    ds_read_b128 v[232:235], v14 offset:4096
    ds_read_b128 v[236:239], v15 offset:4096
    buffer_load_dwordx4 v78, s[24:27], s82 offen offset:2048 lds
    v_mfma_f32_16x16x32_bf16 v[168:171], v[44:47], a[96:99], v[168:171]
    ds_read_b64_tr_b16 v[60:61], v17 offset:55296
    ds_read_b64_tr_b16 v[62:63], v17 offset:56064
    v_mfma_f32_16x16x32_bf16 v[172:175], v[44:47], a[100:103], v[172:175]
    s_waitcnt lgkmcnt(8)
    v_mfma_f32_16x16x32_bf16 v[176:179], v[48:51], a[96:99], v[176:179]
    ds_read_b64_tr_b16 v[32:33], v18 offset:55296
    ds_read_b64_tr_b16 v[34:35], v18 offset:56064
    v_mfma_f32_16x16x32_bf16 v[180:183], v[48:51], a[100:103], v[180:183]
    s_waitcnt vmcnt(7)
    s_waitcnt lgkmcnt(4)
    ds_read_b128 v[208:211], v12 offset:8192
    ds_read_b128 v[212:215], v13 offset:8192
    buffer_load_dwordx4 v79, s[24:27], s82 offen offset:3072 lds
    v_mfma_f32_16x16x32_bf16 v[184:187], v[52:55], a[96:99], v[184:187]
    ds_read_b64_tr_b16 v[36:37], v19 offset:55296
    ds_read_b64_tr_b16 v[38:39], v19 offset:56064
    v_mfma_f32_16x16x32_bf16 v[188:191], v[52:55], a[100:103], v[188:191]
    ds_read_b128 v[216:219], v14 offset:8192
    ds_read_b128 v[220:223], v15 offset:8192
    s_add_u32 m0, s54, 4096
    s_add_u32 s82, s52, s0
    s_waitcnt lgkmcnt(8)
    v_mfma_f32_16x16x32_bf16 v[144:147], v[56:59], a[104:107], v[144:147]
    ds_read_b64_tr_b16 v[40:41], v64 offset:55296
    ds_read_b64_tr_b16 v[42:43], v64 offset:56064
    v_mfma_f32_16x16x32_bf16 v[148:151], v[56:59], a[108:111], v[148:151]
    buffer_load_dwordx4 v76, s[24:27], s82 offen offset:0 lds
    v_mfma_f32_16x16x32_bf16 v[88:91], v[56:59], v[20:23], v[88:91]
    v_mfma_f32_16x16x32_bf16 v[152:155], v[60:63], a[104:107], v[152:155]
    ds_read_b64_tr_b16 v[44:45], v65 offset:55296
    ds_read_b64_tr_b16 v[46:47], v65 offset:56064
    v_mfma_f32_16x16x32_bf16 v[156:159], v[60:63], a[108:111], v[156:159]
    buffer_load_dwordx4 v77, s[24:27], s82 offen offset:1024 lds
    v_mfma_f32_16x16x32_bf16 v[92:95], v[60:63], v[20:23], v[92:95]
    s_waitcnt lgkmcnt(6)
    v_mfma_f32_16x16x32_bf16 v[160:163], v[32:35], a[104:107], v[160:163]
    s_barrier
    ds_read_b64_tr_b16 v[48:49], v16 offset:0
    ds_read_b64_tr_b16 v[50:51], v16 offset:768
    v_mfma_f32_16x16x32_bf16 v[164:167], v[32:35], a[108:111], v[164:167]
    s_waitcnt lgkmcnt(6)
    buffer_load_dwordx4 v78, s[24:27], s82 offen offset:2048 lds
    v_mfma_f32_16x16x32_bf16 v[168:171], v[36:39], a[104:107], v[168:171]
    ds_read_b64_tr_b16 v[52:53], v17 offset:0
    ds_read_b64_tr_b16 v[54:55], v17 offset:768
    v_mfma_f32_16x16x32_bf16 v[172:175], v[36:39], a[108:111], v[172:175]
    s_waitcnt lgkmcnt(4)
    v_mfma_f32_16x16x32_bf16 v[176:179], v[40:43], a[104:107], v[176:179]
    ds_read_b64_tr_b16 v[56:57], v18 offset:0
    ds_read_b64_tr_b16 v[58:59], v18 offset:768
    v_mfma_f32_16x16x32_bf16 v[180:183], v[40:43], a[108:111], v[180:183]
    s_waitcnt vmcnt(7)
    ds_read_b128 v[240:243], v12 offset:12288
    ds_read_b128 v[244:247], v13 offset:12288
    buffer_load_dwordx4 v79, s[24:27], s82 offen offset:3072 lds
    v_mfma_f32_16x16x32_bf16 v[184:187], v[44:47], a[104:107], v[184:187]
    ds_read_b64_tr_b16 v[60:61], v19 offset:0
    ds_read_b64_tr_b16 v[62:63], v19 offset:768
    v_mfma_f32_16x16x32_bf16 v[188:191], v[44:47], a[108:111], v[188:191]
    ds_read_b128 v[248:251], v14 offset:12288
    ds_read_b128 v[252:255], v15 offset:12288
    s_add_u32 m0, s54, 8192
    s_add_u32 s0, s0, 128
    s_and_b32 s0, s0, 1023
    s_add_u32 s82, s73, s0
    s_waitcnt lgkmcnt(8)
    v_mfma_f32_16x16x32_bf16 v[144:147], v[48:51], a[112:115], v[144:147]
    ds_read_b64_tr_b16 v[32:33], v64 offset:0
    ds_read_b64_tr_b16 v[34:35], v64 offset:768
    v_mfma_f32_16x16x32_bf16 v[148:151], v[48:51], a[116:119], v[148:151]
    buffer_load_dwordx4 v76, s[24:27], s82 offen offset:0 lds
    v_mfma_f32_16x16x32_bf16 v[88:91], v[48:51], v[20:23], v[88:91]
    v_mfma_f32_16x16x32_bf16 v[152:155], v[52:55], a[112:115], v[152:155]
    ds_read_b64_tr_b16 v[36:37], v65 offset:0
    ds_read_b64_tr_b16 v[38:39], v65 offset:768
    v_mfma_f32_16x16x32_bf16 v[156:159], v[52:55], a[116:119], v[156:159]
    buffer_load_dwordx4 v77, s[24:27], s82 offen offset:1024 lds
    v_mfma_f32_16x16x32_bf16 v[92:95], v[52:55], v[20:23], v[92:95]
    s_waitcnt lgkmcnt(6)
    v_mfma_f32_16x16x32_bf16 v[160:163], v[56:59], a[112:115], v[160:163]
    ds_read_b64_tr_b16 v[40:41], v16 offset:6144
    ds_read_b64_tr_b16 v[42:43], v16 offset:6912
    v_mfma_f32_16x16x32_bf16 v[164:167], v[56:59], a[116:119], v[164:167]
    s_waitcnt lgkmcnt(6)
    buffer_load_dwordx4 v78, s[24:27], s82 offen offset:2048 lds
    v_mfma_f32_16x16x32_bf16 v[168:171], v[60:63], a[112:115], v[168:171]
    ds_read_b64_tr_b16 v[44:45], v17 offset:6144
    ds_read_b64_tr_b16 v[46:47], v17 offset:6912
    v_mfma_f32_16x16x32_bf16 v[172:175], v[60:63], a[116:119], v[172:175]
    s_waitcnt lgkmcnt(4)
    v_mfma_f32_16x16x32_bf16 v[176:179], v[32:35], a[112:115], v[176:179]
    ds_read_b64_tr_b16 v[48:49], v18 offset:6144
    ds_read_b64_tr_b16 v[50:51], v18 offset:6912
    v_mfma_f32_16x16x32_bf16 v[180:183], v[32:35], a[116:119], v[180:183]
    s_waitcnt vmcnt(7)
    ds_read_b128 a[0:3], v12 offset:0
    ds_read_b128 a[4:7], v13 offset:0
    buffer_load_dwordx4 v79, s[24:27], s82 offen offset:3072 lds
    v_mfma_f32_16x16x32_bf16 v[184:187], v[36:39], a[112:115], v[184:187]
    ds_read_b64_tr_b16 v[52:53], v19 offset:6144
    ds_read_b64_tr_b16 v[54:55], v19 offset:6912
    v_mfma_f32_16x16x32_bf16 v[188:191], v[36:39], a[116:119], v[188:191]
    ds_read_b128 a[8:11], v14 offset:0
    ds_read_b128 a[12:15], v15 offset:0
    s_add_u32 m0, s54, 12288
    s_add_u32 s82, s52, s0
    s_waitcnt lgkmcnt(8)
    v_mfma_f32_16x16x32_bf16 v[144:147], v[40:43], a[120:123], v[144:147]
    ds_read_b64_tr_b16 v[56:57], v64 offset:6144
    ds_read_b64_tr_b16 v[58:59], v64 offset:6912
    v_mfma_f32_16x16x32_bf16 v[148:151], v[40:43], a[124:127], v[148:151]
    buffer_load_dwordx4 v76, s[24:27], s82 offen offset:0 lds
    v_mfma_f32_16x16x32_bf16 v[88:91], v[40:43], v[20:23], v[88:91]
    v_mfma_f32_16x16x32_bf16 v[152:155], v[44:47], a[120:123], v[152:155]
    ds_read_b64_tr_b16 v[60:61], v65 offset:6144
    ds_read_b64_tr_b16 v[62:63], v65 offset:6912
    v_mfma_f32_16x16x32_bf16 v[156:159], v[44:47], a[124:127], v[156:159]
    buffer_load_dwordx4 v77, s[24:27], s82 offen offset:1024 lds
    v_mfma_f32_16x16x32_bf16 v[92:95], v[44:47], v[20:23], v[92:95]
    s_waitcnt lgkmcnt(6)
    v_mfma_f32_16x16x32_bf16 v[160:163], v[48:51], a[120:123], v[160:163]
    v_mfma_f32_16x16x32_bf16 v[164:167], v[48:51], a[124:127], v[164:167]
    s_waitcnt lgkmcnt(4)
    buffer_load_dwordx4 v78, s[24:27], s82 offen offset:2048 lds
    v_mfma_f32_16x16x32_bf16 v[168:171], v[52:55], a[120:123], v[168:171]
    v_mfma_f32_16x16x32_bf16 v[172:175], v[52:55], a[124:127], v[172:175]
    s_waitcnt lgkmcnt(0)
    v_mfma_f32_16x16x32_bf16 v[176:179], v[56:59], a[120:123], v[176:179]
    v_mfma_f32_16x16x32_bf16 v[180:183], v[56:59], a[124:127], v[180:183]
    s_waitcnt vmcnt(7)
    ds_read_b128 a[32:35], v12 offset:4096
    ds_read_b128 a[36:39], v13 offset:4096
    buffer_load_dwordx4 v79, s[24:27], s82 offen offset:3072 lds
    v_mfma_f32_16x16x32_bf16 v[184:187], v[60:63], a[120:123], v[184:187]
    v_mfma_f32_16x16x32_bf16 v[188:191], v[60:63], a[124:127], v[188:191]
    ds_read_b128 a[40:43], v14 offset:4096
    ds_read_b128 a[44:47], v15 offset:4096
    v_add_u32 v76, 0, v87
    v_add_u32 v77, 7168, v87
    v_add_u32 v78, 14336, v87
    v_add_u32 v79, 21504, v87
    v_and_b32 v11, 48, v1
    v_add_u32 v11, 126976, v11
    v_lshl_add_u32 v3, s68, 7, v11
    s_mov_b32 exec_lo, 0x00010001
    s_mov_b32 exec_hi, 0x00010001
    ds_write_b128 v3, v[88:91] offset:512
    ds_write_b128 v3, v[92:95] offset:576
    s_mov_b64 exec, -1
    s_waitcnt lgkmcnt(0)
    s_barrier
    v_and_b32 v84, 15, v1
    v_lshlrev_b32 v84, 7, v84
    s_lshl_b32 s58, s10, 2
    s_add_u32 s58, s58, s4
    s_lshl_b32 s58, s58, 11
    s_add_u32 s58, s58, 65536
    v_add_u32 v84, s58, v84
    buffer_load_dword v85, v84, s[28:31], 0 offen sc1
    v_and_b32 v2, 31, v1
    s_cmp_eq_u32 s10, 7
    s_cselect_b32 s58, 15, 63
    s_cselect_b32 s59, 2147483648, 0
    v_cmp_lt_u32 vcc, s58, v2
    v_or_b32 v9, s59, v28
    v_mov_b32 v3, 2147483648
    v_cndmask_b32 v8, v28, v3, vcc
    s_mul_i32 s62, s10, 393216
    s_mul_i32 s58, s4, 98304
    s_add_u32 s62, s62, s58
    s_add_u32 s62, s62, 1048576
    s_mov_b32 s56, s62
    s_add_u32 s83, s62, 98304
    s_mul_i32 s58, s8, 12288
    s_add_u32 s62, s62, s58
    v_lshl_add_u32 v56, s68, 7, v11
    v_lshl_add_u32 v57, s69, 7, v11
    v_lshl_add_u32 v58, s70, 7, v11
    ds_read_b128 v[32:35], v56 offset:512
    ds_read_b128 v[36:39], v56 offset:576
    ds_read_b128 v[40:43], v57 offset:512
    ds_read_b128 v[44:47], v57 offset:576
    ds_read_b128 v[48:51], v58 offset:512
    ds_read_b128 v[52:55], v58 offset:576
    s_waitcnt lgkmcnt(5)
    v_pk_fma_f32 v[144:145], v[32:33], v[24:25], v[144:145] op_sel_hi:[1,0,1]
    v_pk_fma_f32 v[146:147], v[34:35], v[24:25], v[146:147] op_sel_hi:[1,0,1]
    v_pk_fma_f32 v[148:149], v[32:33], v[26:27], v[148:149] op_sel_hi:[1,0,1]
    v_pk_fma_f32 v[150:151], v[34:35], v[26:27], v[150:151] op_sel_hi:[1,0,1]
    s_waitcnt lgkmcnt(4)
    v_pk_fma_f32 v[152:153], v[36:37], v[24:25], v[152:153] op_sel_hi:[1,0,1]
    v_pk_fma_f32 v[154:155], v[38:39], v[24:25], v[154:155] op_sel_hi:[1,0,1]
    v_pk_fma_f32 v[156:157], v[36:37], v[26:27], v[156:157] op_sel_hi:[1,0,1]
    v_pk_fma_f32 v[158:159], v[38:39], v[26:27], v[158:159] op_sel_hi:[1,0,1]
    s_waitcnt vmcnt(5)
    ds_read_b128 a[16:19], v12 offset:8192
    ds_read_b128 a[20:23], v13 offset:8192
    s_add_u32 m0, s54, 0
    s_add_u32 s82, s74, 0
    s_waitcnt lgkmcnt(5)
    v_pk_fma_f32 v[160:161], v[40:41], v[24:25], v[160:161] op_sel_hi:[1,0,1]
    v_pk_fma_f32 v[162:163], v[42:43], v[24:25], v[162:163] op_sel_hi:[1,0,1]
    v_pk_fma_f32 v[164:165], v[40:41], v[26:27], v[164:165] op_sel_hi:[1,0,1]
    v_pk_fma_f32 v[166:167], v[42:43], v[26:27], v[166:167] op_sel_hi:[1,0,1]
    s_waitcnt lgkmcnt(4)
    v_pk_fma_f32 v[168:169], v[44:45], v[24:25], v[168:169] op_sel_hi:[1,0,1]
    v_pk_fma_f32 v[170:171], v[46:47], v[24:25], v[170:171] op_sel_hi:[1,0,1]
    v_pk_fma_f32 v[172:173], v[44:45], v[26:27], v[172:173] op_sel_hi:[1,0,1]
    v_pk_fma_f32 v[174:175], v[46:47], v[26:27], v[174:175] op_sel_hi:[1,0,1]
    ds_read_b128 a[24:27], v14 offset:8192
    ds_read_b128 a[28:31], v15 offset:8192
    buffer_load_dwordx4 v76, s[32:35], s82 offen offset:0 lds
    s_waitcnt lgkmcnt(5)
    v_pk_fma_f32 v[176:177], v[48:49], v[24:25], v[176:177] op_sel_hi:[1,0,1]
    v_pk_fma_f32 v[178:179], v[50:51], v[24:25], v[178:179] op_sel_hi:[1,0,1]
    v_pk_fma_f32 v[180:181], v[48:49], v[26:27], v[180:181] op_sel_hi:[1,0,1]
    v_pk_fma_f32 v[182:183], v[50:51], v[26:27], v[182:183] op_sel_hi:[1,0,1]
    s_waitcnt lgkmcnt(4)
    v_pk_fma_f32 v[184:185], v[52:53], v[24:25], v[184:185] op_sel_hi:[1,0,1]
    v_pk_fma_f32 v[186:187], v[54:55], v[24:25], v[186:187] op_sel_hi:[1,0,1]
    v_pk_fma_f32 v[188:189], v[52:53], v[26:27], v[188:189] op_sel_hi:[1,0,1]
    v_pk_fma_f32 v[190:191], v[54:55], v[26:27], v[190:191] op_sel_hi:[1,0,1]
    s_waitcnt vmcnt(2)
    s_waitcnt lgkmcnt(0)
    ds_read_b128 a[48:51], v12 offset:12288
    ds_read_b128 a[52:55], v13 offset:12288
    buffer_load_dwordx4 v77, s[32:35], s82 offen offset:1024 lds
    s_waitcnt vmcnt(2)
    s_mov_b32 s57, 0
.loop_z_8:
    v_cmp_ne_u32 vcc, s11, v85
    s_cbranch_vccz .ok_z_9
    s_add_u32 s57, s57, 1
    s_cmp_gt_u32 s57, 200000
    s_cbranch_scc1 .Lfail_3
    s_sleep 2
    buffer_load_dword v85, v84, s[28:31], 0 offen sc1
    s_waitcnt vmcnt(0)
    s_branch .loop_z_8
.ok_z_9:
    buffer_load_dwordx4 a[64:67], v8, s[28:31], s62 offen offset:0 sc1
    buffer_load_dwordx4 a[68:71], v9, s[28:31], s62 offen offset:1024 sc1
    buffer_load_dwordx4 a[72:75], v9, s[28:31], s62 offen offset:2048 sc1
    s_add_u32 s62, s62, 3072
    buffer_load_dwordx4 a[76:79], v8, s[28:31], s62 offen offset:0 sc1
    v_pk_mul_f32 v[32:33], v[144:145], v[144:145]
    v_pk_mul_f32 v[34:35], v[146:147], v[146:147]
    v_pk_mul_f32 v[36:37], v[148:149], v[148:149]
    v_pk_mul_f32 v[38:39], v[150:151], v[150:151]
    v_pk_fma_f32 v[32:33], v[32:33], v[30:31], v[30:31] op_sel:[0,0,1] op_sel_hi:[1,0,1]
    v_pk_fma_f32 v[34:35], v[34:35], v[30:31], v[30:31] op_sel:[0,0,1] op_sel_hi:[1,0,1]
    v_pk_fma_f32 v[36:37], v[36:37], v[72:73], v[72:73] op_sel:[0,0,1] op_sel_hi:[1,0,1]
    v_pk_fma_f32 v[38:39], v[38:39], v[72:73], v[72:73] op_sel:[0,0,1] op_sel_hi:[1,0,1]
    v_pk_mul_f32 v[32:33], v[32:33], v[144:145]
    v_pk_mul_f32 v[34:35], v[34:35], v[146:147]
    v_pk_mul_f32 v[36:37], v[36:37], v[148:149]
    v_pk_mul_f32 v[38:39], v[38:39], v[150:151]
    ds_read_b128 a[56:59], v14 offset:12288
    ds_read_b128 a[60:63], v15 offset:12288
    buffer_load_dwordx4 v78, s[32:35], s82 offen offset:2048 lds
    v_exp_f32 v32, v32
    v_exp_f32 v33, v33
    v_exp_f32 v34, v34
    v_exp_f32 v35, v35
    v_exp_f32 v36, v36
    v_exp_f32 v37, v37
    v_exp_f32 v38, v38
    v_exp_f32 v39, v39
    buffer_load_dwordx4 v79, s[32:35], s82 offen offset:3072 lds
    v_pk_mul_f32 v[144:145], v[144:145], v[24:25] op_sel:[0,1] op_sel_hi:[1,1]
    v_pk_mul_f32 v[146:147], v[146:147], v[24:25] op_sel:[0,1] op_sel_hi:[1,1]
    v_pk_mul_f32 v[148:149], v[148:149], v[26:27] op_sel:[0,1] op_sel_hi:[1,1]
    v_pk_mul_f32 v[150:151], v[150:151], v[26:27] op_sel:[0,1] op_sel_hi:[1,1]
    v_pk_add_f32 v[32:33], v[32:33], 1.0 op_sel_hi:[1,0]
    v_pk_add_f32 v[34:35], v[34:35], 1.0 op_sel_hi:[1,0]
    v_pk_add_f32 v[36:37], v[36:37], 1.0 op_sel_hi:[1,0]
    v_pk_add_f32 v[38:39], v[38:39], 1.0 op_sel_hi:[1,0]
    s_waitcnt lgkmcnt(0)
    s_add_u32 m0, s54, 4096
    s_add_u32 s82, s74, 32768
    v_rcp_f32 v32, v32
    v_rcp_f32 v33, v33
    v_rcp_f32 v34, v34
    v_rcp_f32 v35, v35
    v_rcp_f32 v36, v36
    v_rcp_f32 v37, v37
    v_rcp_f32 v38, v38
    v_rcp_f32 v39, v39
    buffer_load_dwordx4 v76, s[32:35], s82 offen offset:0 lds
    v_pk_mul_f32 v[144:145], v[144:145], v[32:33]
    v_pk_mul_f32 v[146:147], v[146:147], v[34:35]
    v_pk_mul_f32 v[148:149], v[148:149], v[36:37]
    v_pk_mul_f32 v[150:151], v[150:151], v[38:39]
    v_pk_mul_f32 v[32:33], v[152:153], v[152:153]
    v_pk_mul_f32 v[34:35], v[154:155], v[154:155]
    v_pk_mul_f32 v[36:37], v[156:157], v[156:157]
    v_pk_mul_f32 v[38:39], v[158:159], v[158:159]
    v_pk_fma_f32 v[32:33], v[32:33], v[30:31], v[30:31] op_sel:[0,0,1] op_sel_hi:[1,0,1]
    v_pk_fma_f32 v[34:35], v[34:35], v[30:31], v[30:31] op_sel:[0,0,1] op_sel_hi:[1,0,1]
    v_pk_fma_f32 v[36:37], v[36:37], v[72:73], v[72:73] op_sel:[0,0,1] op_sel_hi:[1,0,1]
    v_pk_fma_f32 v[38:39], v[38:39], v[72:73], v[72:73] op_sel:[0,0,1] op_sel_hi:[1,0,1]
    v_pk_mul_f32 v[32:33], v[32:33], v[152:153]
    v_pk_mul_f32 v[34:35], v[34:35], v[154:155]
    v_pk_mul_f32 v[36:37], v[36:37], v[156:157]
    v_pk_mul_f32 v[38:39], v[38:39], v[158:159]
    buffer_load_dwordx4 v77, s[32:35], s82 offen offset:1024 lds
    v_exp_f32 v32, v32
    v_exp_f32 v33, v33
    v_exp_f32 v34, v34
    v_exp_f32 v35, v35
    v_exp_f32 v36, v36
    v_exp_f32 v37, v37
    v_exp_f32 v38, v38
    v_exp_f32 v39, v39
    buffer_load_dwordx4 v78, s[32:35], s82 offen offset:2048 lds
    v_pk_mul_f32 v[152:153], v[152:153], v[24:25] op_sel:[0,1] op_sel_hi:[1,1]
    v_pk_mul_f32 v[154:155], v[154:155], v[24:25] op_sel:[0,1] op_sel_hi:[1,1]
    v_pk_mul_f32 v[156:157], v[156:157], v[26:27] op_sel:[0,1] op_sel_hi:[1,1]
    v_pk_mul_f32 v[158:159], v[158:159], v[26:27] op_sel:[0,1] op_sel_hi:[1,1]
    v_pk_add_f32 v[32:33], v[32:33], 1.0 op_sel_hi:[1,0]
    v_pk_add_f32 v[34:35], v[34:35], 1.0 op_sel_hi:[1,0]
    v_pk_add_f32 v[36:37], v[36:37], 1.0 op_sel_hi:[1,0]
    v_pk_add_f32 v[38:39], v[38:39], 1.0 op_sel_hi:[1,0]
    v_rcp_f32 v32, v32
    v_rcp_f32 v33, v33
    v_rcp_f32 v34, v34
    v_rcp_f32 v35, v35
    v_rcp_f32 v36, v36
    v_rcp_f32 v37, v37
    v_rcp_f32 v38, v38
    v_rcp_f32 v39, v39
    buffer_load_dwordx4 v79, s[32:35], s82 offen offset:3072 lds
    v_pk_mul_f32 v[152:153], v[152:153], v[32:33]
    v_pk_mul_f32 v[154:155], v[154:155], v[34:35]
    v_pk_mul_f32 v[156:157], v[156:157], v[36:37]
    v_pk_mul_f32 v[158:159], v[158:159], v[38:39]
    v_pk_mul_f32 v[32:33], v[160:161], v[160:161]
    v_pk_mul_f32 v[34:35], v[162:163], v[162:163]
    v_pk_mul_f32 v[36:37], v[164:165], v[164:165]
    v_pk_mul_f32 v[38:39], v[166:167], v[166:167]
    v_pk_fma_f32 v[32:33], v[32:33], v[30:31], v[30:31] op_sel:[0,0,1] op_sel_hi:[1,0,1]
    v_pk_fma_f32 v[34:35], v[34:35], v[30:31], v[30:31] op_sel:[0,0,1] op_sel_hi:[1,0,1]
    v_pk_fma_f32 v[36:37], v[36:37], v[72:73], v[72:73] op_sel:[0,0,1] op_sel_hi:[1,0,1]
    v_pk_fma_f32 v[38:39], v[38:39], v[72:73], v[72:73] op_sel:[0,0,1] op_sel_hi:[1,0,1]
    v_pk_mul_f32 v[32:33], v[32:33], v[160:161]
    v_pk_mul_f32 v[34:35], v[34:35], v[162:163]
    v_pk_mul_f32 v[36:37], v[36:37], v[164:165]
    v_pk_mul_f32 v[38:39], v[38:39], v[166:167]
    s_add_u32 m0, s54, 8192
    s_add_u32 s82, s74, 65536
    v_exp_f32 v32, v32
    v_exp_f32 v33, v33
    v_exp_f32 v34, v34
    v_exp_f32 v35, v35
    v_exp_f32 v36, v36
    v_exp_f32 v37, v37
    v_exp_f32 v38, v38
    v_exp_f32 v39, v39
    buffer_load_dwordx4 v76, s[32:35], s82 offen offset:0 lds
    v_pk_mul_f32 v[160:161], v[160:161], v[24:25] op_sel:[0,1] op_sel_hi:[1,1]
    v_pk_mul_f32 v[162:163], v[162:163], v[24:25] op_sel:[0,1] op_sel_hi:[1,1]
    v_pk_mul_f32 v[164:165], v[164:165], v[26:27] op_sel:[0,1] op_sel_hi:[1,1]
    v_pk_mul_f32 v[166:167], v[166:167], v[26:27] op_sel:[0,1] op_sel_hi:[1,1]
    v_pk_add_f32 v[32:33], v[32:33], 1.0 op_sel_hi:[1,0]
    v_pk_add_f32 v[34:35], v[34:35], 1.0 op_sel_hi:[1,0]
    v_pk_add_f32 v[36:37], v[36:37], 1.0 op_sel_hi:[1,0]
    v_pk_add_f32 v[38:39], v[38:39], 1.0 op_sel_hi:[1,0]
    v_rcp_f32 v32, v32
    v_rcp_f32 v33, v33
    v_rcp_f32 v34, v34
    v_rcp_f32 v35, v35
    v_rcp_f32 v36, v36
    v_rcp_f32 v37, v37
    v_rcp_f32 v38, v38
    v_rcp_f32 v39, v39
    buffer_load_dwordx4 v77, s[32:35], s82 offen offset:1024 lds
    v_pk_mul_f32 v[160:161], v[160:161], v[32:33]
    v_pk_mul_f32 v[162:163], v[162:163], v[34:35]
    v_pk_mul_f32 v[164:165], v[164:165], v[36:37]
    v_pk_mul_f32 v[166:167], v[166:167], v[38:39]
    v_pk_mul_f32 v[32:33], v[168:169], v[168:169]
    v_pk_mul_f32 v[34:35], v[170:171], v[170:171]
    v_pk_mul_f32 v[36:37], v[172:173], v[172:173]
    v_pk_mul_f32 v[38:39], v[174:175], v[174:175]
    v_pk_fma_f32 v[32:33], v[32:33], v[30:31], v[30:31] op_sel:[0,0,1] op_sel_hi:[1,0,1]
    v_pk_fma_f32 v[34:35], v[34:35], v[30:31], v[30:31] op_sel:[0,0,1] op_sel_hi:[1,0,1]
    v_pk_fma_f32 v[36:37], v[36:37], v[72:73], v[72:73] op_sel:[0,0,1] op_sel_hi:[1,0,1]
    v_pk_fma_f32 v[38:39], v[38:39], v[72:73], v[72:73] op_sel:[0,0,1] op_sel_hi:[1,0,1]
    v_pk_mul_f32 v[32:33], v[32:33], v[168:169]
    v_pk_mul_f32 v[34:35], v[34:35], v[170:171]
    v_pk_mul_f32 v[36:37], v[36:37], v[172:173]
    v_pk_mul_f32 v[38:39], v[38:39], v[174:175]
    buffer_load_dwordx4 v78, s[32:35], s82 offen offset:2048 lds
    v_exp_f32 v32, v32
    v_exp_f32 v33, v33
    v_exp_f32 v34, v34
    v_exp_f32 v35, v35
    v_exp_f32 v36, v36
    v_exp_f32 v37, v37
    v_exp_f32 v38, v38
    v_exp_f32 v39, v39
    buffer_load_dwordx4 v79, s[32:35], s82 offen offset:3072 lds
    v_pk_mul_f32 v[168:169], v[168:169], v[24:25] op_sel:[0,1] op_sel_hi:[1,1]
    v_pk_mul_f32 v[170:171], v[170:171], v[24:25] op_sel:[0,1] op_sel_hi:[1,1]
    v_pk_mul_f32 v[172:173], v[172:173], v[26:27] op_sel:[0,1] op_sel_hi:[1,1]
    v_pk_mul_f32 v[174:175], v[174:175], v[26:27] op_sel:[0,1] op_sel_hi:[1,1]
    v_pk_add_f32 v[32:33], v[32:33], 1.0 op_sel_hi:[1,0]
    v_pk_add_f32 v[34:35], v[34:35], 1.0 op_sel_hi:[1,0]
    v_pk_add_f32 v[36:37], v[36:37], 1.0 op_sel_hi:[1,0]
    v_pk_add_f32 v[38:39], v[38:39], 1.0 op_sel_hi:[1,0]
    s_add_u32 m0, s54, 12288
    s_add_u32 s82, s74, 98304
    v_rcp_f32 v32, v32
    v_rcp_f32 v33, v33
    v_rcp_f32 v34, v34
    v_rcp_f32 v35, v35
    v_rcp_f32 v36, v36
    v_rcp_f32 v37, v37
    v_rcp_f32 v38, v38
    v_rcp_f32 v39, v39
    buffer_load_dwordx4 v76, s[32:35], s82 offen offset:0 lds
    v_pk_mul_f32 v[168:169], v[168:169], v[32:33]
    v_pk_mul_f32 v[170:171], v[170:171], v[34:35]
    v_pk_mul_f32 v[172:173], v[172:173], v[36:37]
    v_pk_mul_f32 v[174:175], v[174:175], v[38:39]
    v_pk_mul_f32 v[32:33], v[176:177], v[176:177]
    v_pk_mul_f32 v[34:35], v[178:179], v[178:179]
    v_pk_mul_f32 v[36:37], v[180:181], v[180:181]
    v_pk_mul_f32 v[38:39], v[182:183], v[182:183]
    v_pk_fma_f32 v[32:33], v[32:33], v[30:31], v[30:31] op_sel:[0,0,1] op_sel_hi:[1,0,1]
    v_pk_fma_f32 v[34:35], v[34:35], v[30:31], v[30:31] op_sel:[0,0,1] op_sel_hi:[1,0,1]
    v_pk_fma_f32 v[36:37], v[36:37], v[72:73], v[72:73] op_sel:[0,0,1] op_sel_hi:[1,0,1]
    v_pk_fma_f32 v[38:39], v[38:39], v[72:73], v[72:73] op_sel:[0,0,1] op_sel_hi:[1,0,1]
    v_pk_mul_f32 v[32:33], v[32:33], v[176:177]
    v_pk_mul_f32 v[34:35], v[34:35], v[178:179]
    v_pk_mul_f32 v[36:37], v[36:37], v[180:181]
    v_pk_mul_f32 v[38:39], v[38:39], v[182:183]
    buffer_load_dwordx4 v77, s[32:35], s82 offen offset:1024 lds
    v_exp_f32 v32, v32
    v_exp_f32 v33, v33
    v_exp_f32 v34, v34
    v_exp_f32 v35, v35
    v_exp_f32 v36, v36
    v_exp_f32 v37, v37
    v_exp_f32 v38, v38
    v_exp_f32 v39, v39
    buffer_load_dwordx4 v78, s[32:35], s82 offen offset:2048 lds
    v_pk_mul_f32 v[176:177], v[176:177], v[24:25] op_sel:[0,1] op_sel_hi:[1,1]
    v_pk_mul_f32 v[178:179], v[178:179], v[24:25] op_sel:[0,1] op_sel_hi:[1,1]
    v_pk_mul_f32 v[180:181], v[180:181], v[26:27] op_sel:[0,1] op_sel_hi:[1,1]
    v_pk_mul_f32 v[182:183], v[182:183], v[26:27] op_sel:[0,1] op_sel_hi:[1,1]
    v_pk_add_f32 v[32:33], v[32:33], 1.0 op_sel_hi:[1,0]
    v_pk_add_f32 v[34:35], v[34:35], 1.0 op_sel_hi:[1,0]
    v_pk_add_f32 v[36:37], v[36:37], 1.0 op_sel_hi:[1,0]
    v_pk_add_f32 v[38:39], v[38:39], 1.0 op_sel_hi:[1,0]
    v_rcp_f32 v32, v32
    v_rcp_f32 v33, v33
    v_rcp_f32 v34, v34
    v_rcp_f32 v35, v35
    v_rcp_f32 v36, v36
    v_rcp_f32 v37, v37
    v_rcp_f32 v38, v38
    v_rcp_f32 v39, v39
    buffer_load_dwordx4 v79, s[32:35], s82 offen offset:3072 lds
    v_pk_mul_f32 v[176:177], v[176:177], v[32:33]
    v_pk_mul_f32 v[178:179], v[178:179], v[34:35]
    v_pk_mul_f32 v[180:181], v[180:181], v[36:37]
    v_pk_mul_f32 v[182:183], v[182:183], v[38:39]
    v_pk_mul_f32 v[32:33], v[184:185], v[184:185]
    v_pk_mul_f32 v[34:35], v[186:187], v[186:187]
    v_pk_mul_f32 v[36:37], v[188:189], v[188:189]
    v_pk_mul_f32 v[38:39], v[190:191], v[190:191]
    v_pk_fma_f32 v[32:33], v[32:33], v[30:31], v[30:31] op_sel:[0,0,1] op_sel_hi:[1,0,1]
    v_pk_fma_f32 v[34:35], v[34:35], v[30:31], v[30:31] op_sel:[0,0,1] op_sel_hi:[1,0,1]
    v_pk_fma_f32 v[36:37], v[36:37], v[72:73], v[72:73] op_sel:[0,0,1] op_sel_hi:[1,0,1]
    v_pk_fma_f32 v[38:39], v[38:39], v[72:73], v[72:73] op_sel:[0,0,1] op_sel_hi:[1,0,1]
    v_pk_mul_f32 v[32:33], v[32:33], v[184:185]
    v_pk_mul_f32 v[34:35], v[34:35], v[186:187]
    v_pk_mul_f32 v[36:37], v[36:37], v[188:189]
    v_pk_mul_f32 v[38:39], v[38:39], v[190:191]
    buffer_load_dwordx4 a[80:83], v9, s[28:31], s62 offen offset:1024 sc1
    v_exp_f32 v32, v32
    v_exp_f32 v33, v33
    v_exp_f32 v34, v34
    v_exp_f32 v35, v35
    v_exp_f32 v36, v36
    v_exp_f32 v37, v37
    v_exp_f32 v38, v38
    v_exp_f32 v39, v39
    buffer_load_dwordx4 a[84:87], v9, s[28:31], s62 offen offset:2048 sc1
    v_pk_mul_f32 v[184:185], v[184:185], v[24:25] op_sel:[0,1] op_sel_hi:[1,1]
    v_pk_mul_f32 v[186:187], v[186:187], v[24:25] op_sel:[0,1] op_sel_hi:[1,1]
    v_pk_mul_f32 v[188:189], v[188:189], v[26:27] op_sel:[0,1] op_sel_hi:[1,1]
    v_pk_mul_f32 v[190:191], v[190:191], v[26:27] op_sel:[0,1] op_sel_hi:[1,1]
    v_pk_add_f32 v[32:33], v[32:33], 1.0 op_sel_hi:[1,0]
    v_pk_add_f32 v[34:35], v[34:35], 1.0 op_sel_hi:[1,0]
    v_pk_add_f32 v[36:37], v[36:37], 1.0 op_sel_hi:[1,0]
    v_pk_add_f32 v[38:39], v[38:39], 1.0 op_sel_hi:[1,0]
    s_add_u32 s62, s62, 3072
    buffer_load_dwordx4 a[88:91], v8, s[28:31], s62 offen offset:0 sc1
    v_rcp_f32 v32, v32
    v_rcp_f32 v33, v33
    v_rcp_f32 v34, v34
    v_rcp_f32 v35, v35
    v_rcp_f32 v36, v36
    v_rcp_f32 v37, v37
    v_rcp_f32 v38, v38
    v_rcp_f32 v39, v39
    buffer_load_dwordx4 a[92:95], v9, s[28:31], s62 offen offset:1024 sc1
    v_pk_mul_f32 v[184:185], v[184:185], v[32:33]
    v_pk_mul_f32 v[186:187], v[186:187], v[34:35]
    v_pk_mul_f32 v[188:189], v[188:189], v[36:37]
    v_pk_mul_f32 v[190:191], v[190:191], v[38:39]
    v_cvt_pk_bf16_f32 v144, v144, v145
    v_cvt_pk_bf16_f32 v145, v146, v147
    v_cvt_pk_bf16_f32 v146, v148, v149
    v_cvt_pk_bf16_f32 v147, v150, v151
    v_cvt_pk_bf16_f32 v148, v152, v153
    v_cvt_pk_bf16_f32 v149, v154, v155
    v_cvt_pk_bf16_f32 v150, v156, v157
    v_cvt_pk_bf16_f32 v151, v158, v159
    v_cvt_pk_bf16_f32 v152, v160, v161
    v_cvt_pk_bf16_f32 v153, v162, v163
    v_cvt_pk_bf16_f32 v154, v164, v165
    v_cvt_pk_bf16_f32 v155, v166, v167
    v_cvt_pk_bf16_f32 v156, v168, v169
    v_cvt_pk_bf16_f32 v157, v170, v171
    v_cvt_pk_bf16_f32 v158, v172, v173
    v_cvt_pk_bf16_f32 v159, v174, v175
    v_cvt_pk_bf16_f32 v160, v176, v177
    v_cvt_pk_bf16_f32 v161, v178, v179
    v_cvt_pk_bf16_f32 v162, v180, v181
    v_cvt_pk_bf16_f32 v163, v182, v183
    v_cvt_pk_bf16_f32 v164, v184, v185
    v_cvt_pk_bf16_f32 v165, v186, v187
    v_cvt_pk_bf16_f32 v166, v188, v189
    v_cvt_pk_bf16_f32 v167, v190, v191
    v_permlane16_swap_b32 v144, v146
    v_permlane16_swap_b32 v145, v147
    v_permlane16_swap_b32 v148, v150
    v_permlane16_swap_b32 v149, v151
    v_permlane16_swap_b32 v152, v154
    v_permlane16_swap_b32 v153, v155
    v_permlane16_swap_b32 v156, v158
    v_permlane16_swap_b32 v157, v159
    v_permlane16_swap_b32 v160, v162
    v_permlane16_swap_b32 v161, v163
    v_permlane16_swap_b32 v164, v166
    v_permlane16_swap_b32 v165, v167
    buffer_load_dwordx4 a[96:99], v9, s[28:31], s62 offen offset:2048 sc1
    v_permlane32_swap_b32 v144, v146
    v_permlane32_swap_b32 v145, v147
    v_permlane32_swap_b32 v148, v150
    v_permlane32_swap_b32 v149, v151
    v_permlane32_swap_b32 v152, v154
    v_permlane32_swap_b32 v153, v155
    v_permlane32_swap_b32 v156, v158
    v_permlane32_swap_b32 v157, v159
    v_permlane32_swap_b32 v160, v162
    v_permlane32_swap_b32 v161, v163
    v_permlane32_swap_b32 v164, v166
    v_permlane32_swap_b32 v165, v167
    s_add_u32 s62, s62, 3072
    buffer_load_dwordx4 a[100:103], v8, s[28:31], s62 offen offset:0 sc1
    s_cmp_eq_u32 s12, 0
    s_cbranch_scc1 .sc1_z_10
    buffer_store_dwordx4 v[144:147], v28, s[28:31], s80 offen offset:0
    buffer_store_dwordx4 v[148:151], v28, s[28:31], s80 offen offset:1024
    buffer_store_dwordx4 v[152:155], v28, s[28:31], s81 offen offset:0
    buffer_store_dwordx4 v[156:159], v28, s[28:31], s81 offen offset:1024
    buffer_store_dwordx4 v[160:163], v28, s[28:31], s72 offen offset:0
    buffer_store_dwordx4 v[164:167], v28, s[28:31], s72 offen offset:1024
.back_z_11:
    v_lshrrev_b32 v2, 4, v1
    v_bfe_u32 v3, v1, 2, 2
    v_lshrrev_b32 v16, 1, v2
    v_lshl_add_u32 v16, v16, 3, v3
    v_lshlrev_b32 v16, 7, v16
    v_lshrrev_b32 v3, 1, v3
    v_lshl_add_u32 v16, v3, 6, v16
    v_and_b32 v2, 1, v2
    v_lshl_add_u32 v16, v2, 5, v16
    v_and_b32 v2, 3, v1
    v_lshl_add_u32 v16, v2, 3, v16
    v_add_u32 v16, s54, v16
    v_xor_b32 v17, 64, v16
    s_mul_i32 s55, s4, 40960
    s_lshl_b32 s53, s10, 7
    s_mul_i32 s58, s4, 180224
    s_add_u32 s53, s53, s58
    buffer_load_dwordx4 a[104:107], v9, s[28:31], s62 offen offset:1024 sc1
    buffer_load_dwordx4 a[108:111], v9, s[28:31], s62 offen offset:2048 sc1
    s_add_u32 s62, s62, 3072
    s_cmp_eq_u32 s62, s83
    s_cselect_b32 s62, s56, s62
    buffer_load_dwordx4 a[112:115], v8, s[28:31], s62 offen offset:0 sc1
    buffer_load_dwordx4 a[116:119], v9, s[28:31], s62 offen offset:1024 sc1
    buffer_load_dwordx4 a[120:123], v9, s[28:31], s62 offen offset:2048 sc1
    s_waitcnt vmcnt(34)
    v_mfma_f32_32x32x16_bf16 v[96:111], a[64:67], a[128:131], 0
    v_mfma_f32_32x32x16_bf16 v[112:127], a[64:67], a[160:163], 0
    s_add_u32 s62, s62, 3072
    buffer_load_dwordx4 a[124:127], v8, s[28:31], s62 offen offset:0 sc1
    s_waitcnt vmcnt(34)
    v_mfma_f32_32x32x16_bf16 v[128:143], a[68:71], a[128:131], 0
    v_mfma_f32_32x32x16_bf16 v[144:159], a[68:71], a[160:163], 0
    buffer_load_dwordx4 v[40:43], v9, s[28:31], s62 offen offset:1024 sc1
    s_waitcnt vmcnt(34)
    v_mfma_f32_32x32x16_bf16 v[160:175], a[72:75], a[128:131], 0
    v_mfma_f32_32x32x16_bf16 v[176:191], a[72:75], a[160:163], 0
    buffer_load_dwordx4 v[44:47], v9, s[28:31], s62 offen offset:2048 sc1
    s_waitcnt vmcnt(34)
    v_mfma_f32_32x32x16_bf16 v[96:111], a[76:79], a[132:135], v[96:111]
    v_mfma_f32_32x32x16_bf16 v[112:127], a[76:79], a[164:167], v[112:127]
    s_add_u32 s62, s62, 3072
    buffer_load_dwordx4 v[48:51], v8, s[28:31], s62 offen offset:0 sc1
    s_waitcnt vmcnt(20)
    v_mfma_f32_32x32x16_bf16 v[128:143], a[80:83], a[132:135], v[128:143]
    v_mfma_f32_32x32x16_bf16 v[144:159], a[80:83], a[164:167], v[144:159]
    buffer_load_dwordx4 v[52:55], v9, s[28:31], s62 offen offset:1024 sc1
    s_waitcnt vmcnt(20)
    v_mfma_f32_32x32x16_bf16 v[160:175], a[84:87], a[132:135], v[160:175]
    v_mfma_f32_32x32x16_bf16 v[176:191], a[84:87], a[164:167], v[176:191]
    buffer_load_dwordx4 v[56:59], v9, s[28:31], s62 offen offset:2048 sc1
    s_lshl_b32 s58, s9, 1
    s_and_b32 s59, s4, 1
    s_add_u32 s58, s58, s59
    s_mul_i32 s65, s58, 49152
    s_mul_i32 s60, s10, 6
    s_add_u32 s60, s60, 1
    s_cmp_eq_u32 s10, 7
    s_cselect_b32 s60, 0, s60
    s_lshr_b32 s59, s4, 1
    s_add_u32 s64, s60, s59
    s_lshl_b32 s60, s64, 10
    s_add_u32 s65, s65, s60
    s_add_u32 s65, s65, 4194304
    v_and_b32 v2, 31, v1
    s_lshl_b32 s58, s58, 5
    v_add_lshl_u32 v2, v2, s58, 1
    buffer_load_ushort v29, v2, s[44:47], 0 offen
    s_waitcnt vmcnt(21)
    v_mfma_f32_32x32x16_bf16 v[96:111], a[88:91], a[136:139], v[96:111]
    v_mfma_f32_32x32x16_bf16 v[112:127], a[88:91], a[168:171], v[112:127]
    s_add_u32 s62, s62, 3072
    buffer_load_dwordx4 v[60:63], v8, s[28:31], s62 offen offset:0 sc1
    s_waitcnt vmcnt(21)
    v_mfma_f32_32x32x16_bf16 v[128:143], a[92:95], a[136:139], v[128:143]
    v_mfma_f32_32x32x16_bf16 v[144:159], a[92:95], a[168:171], v[144:159]
    buffer_load_dwordx4 v[64:67], v9, s[28:31], s62 offen offset:1024 sc1
    s_waitcnt vmcnt(21)
    v_mfma_f32_32x32x16_bf16 v[160:175], a[96:99], a[136:139], v[160:175]
    v_mfma_f32_32x32x16_bf16 v[176:191], a[96:99], a[168:171], v[176:191]
    buffer_load_dwordx4 v[68:71], v9, s[28:31], s62 offen offset:2048 sc1
    v_lshrrev_b32 v2, 3, v0
    v_and_b32 v3, 7, v0
    v_lshlrev_b32 v30, 10, v2
    v_lshl_add_u32 v30, v3, 4, v30
    s_lshl_b32 s58, s9, 16
    s_lshl_b32 s59, s10, 7
    s_add_u32 s58, s58, s59
    v_add_u32 v30, s58, v30
    v_add_u32 v31, 32768, v30
    s_lshl_b32 s58, s9, 2
    s_add_u32 s58, s58, s4
    s_lshl_b32 s58, s58, 14
    s_add_u32 s67, s58, 7340032
    s_waitcnt vmcnt(21)
    v_mfma_f32_32x32x16_bf16 v[96:111], a[100:103], a[140:143], v[96:111]
    s_add_u32 s62, s62, 3072
    s_cmp_eq_u32 s62, s83
    s_cselect_b32 s62, s56, s62
    buffer_load_dwordx4 a[64:67], v8, s[28:31], s62 offen offset:0 sc1
    v_mfma_f32_32x32x16_bf16 v[112:127], a[100:103], a[172:175], v[112:127]
    s_waitcnt vmcnt(15)
    v_mfma_f32_32x32x16_bf16 v[128:143], a[104:107], a[140:143], v[128:143]
    buffer_load_dwordx4 a[68:71], v9, s[28:31], s62 offen offset:1024 sc1
    v_mfma_f32_32x32x16_bf16 v[144:159], a[104:107], a[172:175], v[144:159]
    s_waitcnt vmcnt(15)
    v_mfma_f32_32x32x16_bf16 v[160:175], a[108:111], a[140:143], v[160:175]
    buffer_load_dwordx4 a[72:75], v9, s[28:31], s62 offen offset:2048 sc1
    v_mfma_f32_32x32x16_bf16 v[176:191], a[108:111], a[172:175], v[176:191]
    s_mov_b32 s68, s65
    s_add_u32 s69, s68, 2048
    s_add_u32 s70, s68, 4096
    s_cmp_eq_u32 s10, 7
    s_cselect_b32 s69, 2147418112, s69
    s_cselect_b32 s70, 2147418112, s70
    s_cselect_b32 s59, s4, 0
    s_cmp_ge_u32 s59, 2
    s_cselect_b32 s68, 2147418112, s68
    s_waitcnt vmcnt(15)
    v_mfma_f32_32x32x16_bf16 v[96:111], a[112:115], a[144:147], v[96:111]
    s_add_u32 s62, s62, 3072
    buffer_load_dwordx4 a[76:79], v8, s[28:31], s62 offen offset:0 sc1
    v_mfma_f32_32x32x16_bf16 v[112:127], a[112:115], a[176:179], v[112:127]
    s_waitcnt vmcnt(15)
    v_mfma_f32_32x32x16_bf16 v[128:143], a[116:119], a[144:147], v[128:143]
    buffer_load_dwordx4 a[80:83], v9, s[28:31], s62 offen offset:1024 sc1
    v_mfma_f32_32x32x16_bf16 v[144:159], a[116:119], a[176:179], v[144:159]
    s_waitcnt vmcnt(15)
    v_mfma_f32_32x32x16_bf16 v[160:175], a[120:123], a[144:147], v[160:175]
    buffer_load_dwordx4 a[84:87], v9, s[28:31], s62 offen offset:2048 sc1
    v_mfma_f32_32x32x16_bf16 v[176:191], a[120:123], a[176:179], v[176:191]
    s_lshl_b32 s71, s9, 7
    s_add_u32 s71, s71, 262144
    s_lshl_b32 s66, s10, 2
    s_add_u32 s66, s66, s4
    s_lshl_b32 s66, s66, 2
    s_add_u32 s66, s66, s71
    s_mul_i32 s72, s9, 96
    s_mul_i32 s59, s4, 11
    s_add_u32 s72, s72, s59
    s_lshl_b32 s72, s72, 10
    s_add_u32 s72, s72, 4194304
    s_add_u32 s75, s72, 49152
    s_waitcnt vmcnt(15)
    v_mfma_f32_32x32x16_bf16 v[96:111], a[124:127], a[148:151], v[96:111]
    s_add_u32 s62, s62, 3072
    buffer_load_dwordx4 a[88:91], v8, s[28:31], s62 offen offset:0 sc1
    v_mfma_f32_32x32x16_bf16 v[112:127], a[124:127], a[180:183], v[112:127]
    s_waitcnt vmcnt(15)
    v_mfma_f32_32x32x16_bf16 v[128:143], v[40:43], a[148:151], v[128:143]
    buffer_load_dwordx4 a[92:95], v9, s[28:31], s62 offen offset:1024 sc1
    v_mfma_f32_32x32x16_bf16 v[144:159], v[40:43], a[180:183], v[144:159]
    s_waitcnt vmcnt(15)
    v_mfma_f32_32x32x16_bf16 v[160:175], v[44:47], a[148:151], v[160:175]
    buffer_load_dwordx4 a[96:99], v9, s[28:31], s62 offen offset:2048 sc1
    v_mfma_f32_32x32x16_bf16 v[176:191], v[44:47], a[180:183], v[176:191]
    v_mov_b32 v2, s11
    v_mov_b32 v3, 0
    v_not_b32 v36, v2
    s_mov_b64 exec, 1
    s_cmp_eq_u32 s12, 0
    s_cbranch_scc1 .sc1_z_12
    buffer_store_dword v2, v3, s[28:31], s63 offen
    buffer_store_dword v36, v3, s[28:31], s66 offen
.back_z_13:
    s_mov_b64 exec, -1
    s_waitcnt vmcnt(17)
    v_mfma_f32_32x32x16_bf16 v[96:111], v[48:51], a[152:155], v[96:111]
    v_mfma_f32_32x32x16_bf16 v[112:127], v[48:51], a[184:187], v[112:127]
    s_add_u32 s62, s62, 3072
    buffer_load_dwordx4 a[100:103], v8, s[28:31], s62 offen offset:0 sc1
    s_waitcnt vmcnt(17)
    v_mfma_f32_32x32x16_bf16 v[128:143], v[52:55], a[152:155], v[128:143]
    v_mfma_f32_32x32x16_bf16 v[144:159], v[52:55], a[184:187], v[144:159]
    buffer_load_dwordx4 a[104:107], v9, s[28:31], s62 offen offset:1024 sc1
    s_waitcnt vmcnt(17)
    v_mfma_f32_32x32x16_bf16 v[160:175], v[56:59], a[152:155], v[160:175]
    v_mfma_f32_32x32x16_bf16 v[176:191], v[56:59], a[184:187], v[176:191]
    buffer_load_dwordx4 a[108:111], v9, s[28:31], s62 offen offset:2048 sc1
    s_waitcnt vmcnt(16)
    v_mfma_f32_32x32x16_bf16 v[96:111], v[60:63], a[156:159], v[96:111]
    v_mfma_f32_32x32x16_bf16 v[112:127], v[60:63], a[188:191], v[112:127]
    s_add_u32 s62, s62, 3072
    s_cmp_eq_u32 s62, s83
    s_cselect_b32 s62, s56, s62
    buffer_load_dwordx4 a[112:115], v8, s[28:31], s62 offen offset:0 sc1
    s_waitcnt vmcnt(16)
    v_mfma_f32_32x32x16_bf16 v[128:143], v[64:67], a[156:159], v[128:143]
    v_mfma_f32_32x32x16_bf16 v[144:159], v[64:67], a[188:191], v[144:159]
    buffer_load_dwordx4 a[116:119], v9, s[28:31], s62 offen offset:1024 sc1
    s_waitcnt vmcnt(16)
    v_mfma_f32_32x32x16_bf16 v[160:175], v[68:71], a[156:159], v[160:175]
    v_mfma_f32_32x32x16_bf16 v[176:191], v[68:71], a[188:191], v[176:191]
    buffer_load_dwordx4 a[120:123], v9, s[28:31], s62 offen offset:2048 sc1
    s_waitcnt vmcnt(16)
    v_mfma_f32_32x32x16_bf16 v[96:111], a[64:67], a[192:195], v[96:111]
    ds_read_b64_tr_b16 a[128:129], v16 offset:0
    ds_read_b64_tr_b16 a[130:131], v16 offset:512
    v_mfma_f32_32x32x16_bf16 v[112:127], a[64:67], a[224:227], v[112:127]
    s_add_u32 s62, s62, 3072
    buffer_load_dwordx4 a[124:127], v8, s[28:31], s62 offen offset:0 sc1
    ds_read_b64_tr_b16 a[132:133], v17 offset:0
    ds_read_b64_tr_b16 a[134:135], v17 offset:512
    s_waitcnt vmcnt(16)
    v_mfma_f32_32x32x16_bf16 v[128:143], a[68:71], a[192:195], v[128:143]
    ds_read_b64_tr_b16 a[136:137], v16 offset:2048
    ds_read_b64_tr_b16 a[138:139], v16 offset:2560
    v_mfma_f32_32x32x16_bf16 v[144:159], a[68:71], a[224:227], v[144:159]
    buffer_load_dwordx4 v[40:43], v9, s[28:31], s62 offen offset:1024 sc1
    ds_read_b64_tr_b16 a[140:141], v17 offset:2048
    ds_read_b64_tr_b16 a[142:143], v17 offset:2560
    s_waitcnt vmcnt(16)
    v_mfma_f32_32x32x16_bf16 v[160:175], a[72:75], a[192:195], v[160:175]
    ds_read_b64_tr_b16 a[144:145], v16 offset:4096
    ds_read_b64_tr_b16 a[146:147], v16 offset:4608
    v_mfma_f32_32x32x16_bf16 v[176:191], a[72:75], a[224:227], v[176:191]
    buffer_load_dwordx4 v[44:47], v9, s[28:31], s62 offen offset:2048 sc1
    ds_read_b64_tr_b16 a[148:149], v17 offset:4096
    ds_read_b64_tr_b16 a[150:151], v17 offset:4608
    s_waitcnt vmcnt(16)
    v_mfma_f32_32x32x16_bf16 v[96:111], a[76:79], a[196:199], v[96:111]
    ds_read_b64_tr_b16 a[152:153], v16 offset:6144
    ds_read_b64_tr_b16 a[154:155], v16 offset:6656
    v_mfma_f32_32x32x16_bf16 v[112:127], a[76:79], a[228:231], v[112:127]
    s_add_u32 s62, s62, 3072
    buffer_load_dwordx4 v[48:51], v8, s[28:31], s62 offen offset:0 sc1
    ds_read_b64_tr_b16 a[156:157], v17 offset:6144
    ds_read_b64_tr_b16 a[158:159], v17 offset:6656
    s_waitcnt vmcnt(16)
    v_mfma_f32_32x32x16_bf16 v[128:143], a[80:83], a[196:199], v[128:143]
    ds_read_b64_tr_b16 a[160:161], v16 offset:8192
    ds_read_b64_tr_b16 a[162:163], v16 offset:8704
    v_mfma_f32_32x32x16_bf16 v[144:159], a[80:83], a[228:231], v[144:159]
    buffer_load_dwordx4 v[52:55], v9, s[28:31], s62 offen offset:1024 sc1
    ds_read_b64_tr_b16 a[164:165], v17 offset:8192
    ds_read_b64_tr_b16 a[166:167], v17 offset:8704
    s_waitcnt vmcnt(16)
    v_mfma_f32_32x32x16_bf16 v[160:175], a[84:87], a[196:199], v[160:175]
    ds_read_b64_tr_b16 a[168:169], v16 offset:10240
    ds_read_b64_tr_b16 a[170:171], v16 offset:10752
    v_mfma_f32_32x32x16_bf16 v[176:191], a[84:87], a[228:231], v[176:191]
    buffer_load_dwordx4 v[56:59], v9, s[28:31], s62 offen offset:2048 sc1
    ds_read_b64_tr_b16 a[172:173], v17 offset:10240
    ds_read_b64_tr_b16 a[174:175], v17 offset:10752
    s_waitcnt vmcnt(16)
    v_mfma_f32_32x32x16_bf16 v[96:111], a[88:91], a[200:203], v[96:111]
    ds_read_b64_tr_b16 a[176:177], v16 offset:12288
    ds_read_b64_tr_b16 a[178:179], v16 offset:12800
    v_mfma_f32_32x32x16_bf16 v[112:127], a[88:91], a[232:235], v[112:127]
    s_add_u32 s62, s62, 3072
    buffer_load_dwordx4 v[60:63], v8, s[28:31], s62 offen offset:0 sc1
    ds_read_b64_tr_b16 a[180:181], v17 offset:12288
    ds_read_b64_tr_b16 a[182:183], v17 offset:12800
    s_waitcnt vmcnt(16)
    v_mfma_f32_32x32x16_bf16 v[128:143], a[92:95], a[200:203], v[128:143]
    ds_read_b64_tr_b16 a[184:185], v16 offset:14336
    ds_read_b64_tr_b16 a[186:187], v16 offset:14848
    v_mfma_f32_32x32x16_bf16 v[144:159], a[92:95], a[232:235], v[144:159]
    buffer_load_dwordx4 v[64:67], v9, s[28:31], s62 offen offset:1024 sc1
    ds_read_b64_tr_b16 a[188:189], v17 offset:14336
    ds_read_b64_tr_b16 a[190:191], v17 offset:14848
    s_waitcnt vmcnt(16)
    v_mfma_f32_32x32x16_bf16 v[160:175], a[96:99], a[200:203], v[160:175]
    v_mfma_f32_32x32x16_bf16 v[176:191], a[96:99], a[232:235], v[176:191]
    buffer_load_dwordx4 v[68:71], v9, s[28:31], s62 offen offset:2048 sc1
    s_waitcnt vmcnt(14)
    v_mfma_f32_32x32x16_bf16 v[96:111], a[100:103], a[204:207], v[96:111]
    v_mfma_f32_32x32x16_bf16 v[112:127], a[100:103], a[236:239], v[112:127]
    s_add_u32 s62, s62, 3072
    s_cmp_eq_u32 s62, s83
    s_cselect_b32 s62, s56, s62
    buffer_load_dwordx4 a[64:67], v8, s[28:31], s62 offen offset:0 sc1
    s_waitcnt vmcnt(14)
    v_mfma_f32_32x32x16_bf16 v[128:143], a[104:107], a[204:207], v[128:143]
    v_mfma_f32_32x32x16_bf16 v[144:159], a[104:107], a[236:239], v[144:159]
    buffer_load_dwordx4 a[68:71], v9, s[28:31], s62 offen offset:1024 sc1
    s_waitcnt vmcnt(14)
    v_mfma_f32_32x32x16_bf16 v[160:175], a[108:111], a[204:207], v[160:175]
    v_mfma_f32_32x32x16_bf16 v[176:191], a[108:111], a[236:239], v[176:191]
    buffer_load_dwordx4 a[72:75], v9, s[28:31], s62 offen offset:2048 sc1
    s_waitcnt vmcnt(14)
    v_mfma_f32_32x32x16_bf16 v[96:111], a[112:115], a[208:211], v[96:111]
    v_mfma_f32_32x32x16_bf16 v[112:127], a[112:115], a[240:243], v[112:127]
    s_add_u32 s62, s62, 3072
    buffer_load_dwordx4 a[76:79], v8, s[28:31], s62 offen offset:0 sc1
    s_waitcnt vmcnt(14)
    v_mfma_f32_32x32x16_bf16 v[128:143], a[116:119], a[208:211], v[128:143]
    v_mfma_f32_32x32x16_bf16 v[144:159], a[116:119], a[240:243], v[144:159]
    buffer_load_dwordx4 a[80:83], v9, s[28:31], s62 offen offset:1024 sc1
    s_waitcnt vmcnt(14)
    v_mfma_f32_32x32x16_bf16 v[160:175], a[120:123], a[208:211], v[160:175]
    v_mfma_f32_32x32x16_bf16 v[176:191], a[120:123], a[240:243], v[176:191]
    buffer_load_dwordx4 a[84:87], v9, s[28:31], s62 offen offset:2048 sc1
    s_waitcnt vmcnt(14)
    v_mfma_f32_32x32x16_bf16 v[96:111], a[124:127], a[212:215], v[96:111]
    v_mfma_f32_32x32x16_bf16 v[112:127], a[124:127], a[244:247], v[112:127]
    s_add_u32 s62, s62, 3072
    buffer_load_dwordx4 a[88:91], v8, s[28:31], s62 offen offset:0 sc1
    s_waitcnt vmcnt(14)
    v_mfma_f32_32x32x16_bf16 v[128:143], v[40:43], a[212:215], v[128:143]
    v_mfma_f32_32x32x16_bf16 v[144:159], v[40:43], a[244:247], v[144:159]
    buffer_load_dwordx4 a[92:95], v9, s[28:31], s62 offen offset:1024 sc1
    s_waitcnt vmcnt(14)
    v_mfma_f32_32x32x16_bf16 v[160:175], v[44:47], a[212:215], v[160:175]
    v_mfma_f32_32x32x16_bf16 v[176:191], v[44:47], a[244:247], v[176:191]
    buffer_load_dwordx4 a[96:99], v9, s[28:31], s62 offen offset:2048 sc1
    s_waitcnt vmcnt(14)
    v_mfma_f32_32x32x16_bf16 v[96:111], v[48:51], a[216:219], v[96:111]
    v_mfma_f32_32x32x16_bf16 v[112:127], v[48:51], a[248:251], v[112:127]
    s_add_u32 s62, s62, 3072
    buffer_load_dwordx4 a[100:103], v8, s[28:31], s62 offen offset:0 sc1
    s_waitcnt vmcnt(14)
    v_mfma_f32_32x32x16_bf16 v[128:143], v[52:55], a[216:219], v[128:143]
    v_mfma_f32_32x32x16_bf16 v[144:159], v[52:55], a[248:251], v[144:159]
    buffer_load_dwordx4 a[104:107], v9, s[28:31], s62 offen offset:1024 sc1
    s_waitcnt vmcnt(14)
    v_mfma_f32_32x32x16_bf16 v[160:175], v[56:59], a[216:219], v[160:175]
    v_mfma_f32_32x32x16_bf16 v[176:191], v[56:59], a[248:251], v[176:191]
    buffer_load_dwordx4 a[108:111], v9, s[28:31], s62 offen offset:2048 sc1
    s_waitcnt vmcnt(14)
    v_mfma_f32_32x32x16_bf16 v[96:111], v[60:63], a[220:223], v[96:111]
    v_mfma_f32_32x32x16_bf16 v[112:127], v[60:63], a[252:255], v[112:127]
    s_add_u32 s62, s62, 3072
    s_cmp_eq_u32 s62, s83
    s_cselect_b32 s62, s56, s62
    buffer_load_dwordx4 a[112:115], v8, s[28:31], s62 offen offset:0 sc1
    s_waitcnt vmcnt(14)
    v_mfma_f32_32x32x16_bf16 v[128:143], v[64:67], a[220:223], v[128:143]
    v_mfma_f32_32x32x16_bf16 v[144:159], v[64:67], a[252:255], v[144:159]
    buffer_load_dwordx4 a[116:119], v9, s[28:31], s62 offen offset:1024 sc1
    s_waitcnt vmcnt(14)
    v_mfma_f32_32x32x16_bf16 v[160:175], v[68:71], a[220:223], v[160:175]
    v_mfma_f32_32x32x16_bf16 v[176:191], v[68:71], a[252:255], v[176:191]
    buffer_load_dwordx4 a[120:123], v9, s[28:31], s62 offen offset:2048 sc1
    s_waitcnt vmcnt(14)
    v_mfma_f32_32x32x16_bf16 v[96:111], a[64:67], v[192:195], v[96:111]
    v_mfma_f32_32x32x16_bf16 v[112:127], a[64:67], v[224:227], v[112:127]
    s_add_u32 s62, s62, 3072
    buffer_load_dwordx4 a[124:127], v8, s[28:31], s62 offen offset:0 sc1
    s_waitcnt vmcnt(14)
    v_mfma_f32_32x32x16_bf16 v[128:143], a[68:71], v[192:195], v[128:143]
    v_mfma_f32_32x32x16_bf16 v[144:159], a[68:71], v[224:227], v[144:159]
    buffer_load_dwordx4 v[40:43], v9, s[28:31], s62 offen offset:1024 sc1
    s_waitcnt vmcnt(14)
    v_mfma_f32_32x32x16_bf16 v[160:175], a[72:75], v[192:195], v[160:175]
    v_mfma_f32_32x32x16_bf16 v[176:191], a[72:75], v[224:227], v[176:191]
    buffer_load_dwordx4 v[44:47], v9, s[28:31], s62 offen offset:2048 sc1
    s_waitcnt vmcnt(14)
    v_mfma_f32_32x32x16_bf16 v[96:111], a[76:79], v[196:199], v[96:111]
    v_mfma_f32_32x32x16_bf16 v[112:127], a[76:79], v[228:231], v[112:127]
    s_add_u32 s62, s62, 3072
    buffer_load_dwordx4 v[48:51], v8, s[28:31], s62 offen offset:0 sc1
    s_waitcnt vmcnt(14)
    v_mfma_f32_32x32x16_bf16 v[128:143], a[80:83], v[196:199], v[128:143]
    v_mfma_f32_32x32x16_bf16 v[144:159], a[80:83], v[228:231], v[144:159]
    buffer_load_dwordx4 v[52:55], v9, s[28:31], s62 offen offset:1024 sc1
    s_waitcnt vmcnt(14)
    v_mfma_f32_32x32x16_bf16 v[160:175], a[84:87], v[196:199], v[160:175]
    v_mfma_f32_32x32x16_bf16 v[176:191], a[84:87], v[228:231], v[176:191]
    buffer_load_dwordx4 v[56:59], v9, s[28:31], s62 offen offset:2048 sc1
    s_waitcnt vmcnt(14)
    v_mfma_f32_32x32x16_bf16 v[96:111], a[88:91], v[200:203], v[96:111]
    v_mfma_f32_32x32x16_bf16 v[112:127], a[88:91], v[232:235], v[112:127]
    s_add_u32 s62, s62, 3072
    buffer_load_dwordx4 v[60:63], v8, s[28:31], s62 offen offset:0 sc1
    s_waitcnt vmcnt(14)
    v_mfma_f32_32x32x16_bf16 v[128:143], a[92:95], v[200:203], v[128:143]
    v_mfma_f32_32x32x16_bf16 v[144:159], a[92:95], v[232:235], v[144:159]
    buffer_load_dwordx4 v[64:67], v9, s[28:31], s62 offen offset:1024 sc1
    s_waitcnt vmcnt(14)
    v_mfma_f32_32x32x16_bf16 v[160:175], a[96:99], v[200:203], v[160:175]
    v_mfma_f32_32x32x16_bf16 v[176:191], a[96:99], v[232:235], v[176:191]
    buffer_load_dwordx4 v[68:71], v9, s[28:31], s62 offen offset:2048 sc1
    s_waitcnt vmcnt(14)
    v_mfma_f32_32x32x16_bf16 v[96:111], a[100:103], v[204:207], v[96:111]
    v_mfma_f32_32x32x16_bf16 v[112:127], a[100:103], v[236:239], v[112:127]
    s_add_u32 s62, s62, 3072
    s_cmp_eq_u32 s62, s83
    s_cselect_b32 s62, s56, s62
    buffer_load_dwordx4 a[64:67], v8, s[28:31], s62 offen offset:0 sc1
    s_waitcnt vmcnt(14)
    v_mfma_f32_32x32x16_bf16 v[128:143], a[104:107], v[204:207], v[128:143]
    v_mfma_f32_32x32x16_bf16 v[144:159], a[104:107], v[236:239], v[144:159]
    buffer_load_dwordx4 a[68:71], v9, s[28:31], s62 offen offset:1024 sc1
    s_waitcnt vmcnt(14)
    v_mfma_f32_32x32x16_bf16 v[160:175], a[108:111], v[204:207], v[160:175]
    v_mfma_f32_32x32x16_bf16 v[176:191], a[108:111], v[236:239], v[176:191]
    buffer_load_dwordx4 a[72:75], v9, s[28:31], s62 offen offset:2048 sc1
    v_and_b32 v2, 7, v1
    s_lshl_b32 s58, s9, 1
    s_and_b32 s59, s4, 1
    s_add_u32 s58, s58, s59
    s_lshl_b32 s60, s58, 7
    s_add_u32 s60, s60, 131072
    v_lshl_add_u32 v84, v2, 2, s60
    v_and_b32 v2, 15, v1
    s_lshl_b32 s60, s9, 7
    s_add_u32 s60, s60, 196608
    v_lshl_add_u32 v3, v2, 2, s60
    v_cmp_gt_u32 vcc, 32, v1
    s_nop 1
    v_cndmask_b32 v84, v3, v84, vcc
    buffer_load_dword v85, v84, s[28:31], 0 offen sc1
    s_waitcnt vmcnt(15)
    v_mfma_f32_32x32x16_bf16 v[96:111], a[112:115], v[208:211], v[96:111]
    v_mfma_f32_32x32x16_bf16 v[112:127], a[112:115], v[240:243], v[112:127]
    s_add_u32 s62, s62, 3072
    buffer_load_dwordx4 a[76:79], v8, s[28:31], s62 offen offset:0 sc1
    s_waitcnt vmcnt(15)
    v_mfma_f32_32x32x16_bf16 v[128:143], a[116:119], v[208:211], v[128:143]
    v_mfma_f32_32x32x16_bf16 v[144:159], a[116:119], v[240:243], v[144:159]
    buffer_load_dwordx4 a[80:83], v9, s[28:31], s62 offen offset:1024 sc1
    s_waitcnt vmcnt(15)
    v_mfma_f32_32x32x16_bf16 v[160:175], a[120:123], v[208:211], v[160:175]
    v_mfma_f32_32x32x16_bf16 v[176:191], a[120:123], v[240:243], v[176:191]
    buffer_load_dwordx4 a[84:87], v9, s[28:31], s62 offen offset:2048 sc1
    s_waitcnt vmcnt(15)
    v_mfma_f32_32x32x16_bf16 v[96:111], a[124:127], v[212:215], v[96:111]
    v_mfma_f32_32x32x16_bf16 v[112:127], a[124:127], v[244:247], v[112:127]
    s_add_u32 s62, s62, 3072
    buffer_load_dwordx4 a[88:91], v8, s[28:31], s62 offen offset:0 sc1
    s_waitcnt vmcnt(15)
    v_mfma_f32_32x32x16_bf16 v[128:143], v[40:43], v[212:215], v[128:143]
    v_mfma_f32_32x32x16_bf16 v[144:159], v[40:43], v[244:247], v[144:159]
    buffer_load_dwordx4 a[92:95], v9, s[28:31], s62 offen offset:1024 sc1
    s_waitcnt vmcnt(15)
    v_mfma_f32_32x32x16_bf16 v[160:175], v[44:47], v[212:215], v[160:175]
    v_mfma_f32_32x32x16_bf16 v[176:191], v[44:47], v[244:247], v[176:191]
    buffer_load_dwordx4 a[96:99], v9, s[28:31], s62 offen offset:2048 sc1
    s_cmp_le_u32 s4, 0
    s_cselect_b32 s58, 47104, 0
    s_mul_i32 s59, s4, 6144
    s_add_u32 s58, s58, s59
    s_add_u32 s58, s58, 4294961152
    v_add_u32 v10, s58, v28
    s_cmp_le_u32 s4, 1
    s_cselect_b32 s58, 47104, 0
    s_mul_i32 s59, s4, 6144
    s_add_u32 s58, s58, s59
    s_add_u32 s58, s58, 34816
    v_add_u32 v11, s58, v28
    s_cmp_le_u32 s4, 2
    s_cselect_b32 s58, 47104, 0
    s_mul_i32 s59, s4, 6144
    s_add_u32 s58, s58, s59
    s_add_u32 s58, s58, 75776
    v_add_u32 v12, s58, v28
    s_waitcnt vmcnt(15)
    v_mfma_f32_32x32x16_bf16 v[96:111], v[48:51], v[216:219], v[96:111]
    s_add_u32 s62, s62, 3072
    buffer_load_dwordx4 a[100:103], v8, s[28:31], s62 offen offset:0 sc1
    v_mfma_f32_32x32x16_bf16 v[112:127], v[48:51], v[248:251], v[112:127]
    s_waitcnt vmcnt(15)
    v_mfma_f32_32x32x16_bf16 v[128:143], v[52:55], v[216:219], v[128:143]
    buffer_load_dwordx4 a[104:107], v9, s[28:31], s62 offen offset:1024 sc1
    v_mfma_f32_32x32x16_bf16 v[144:159], v[52:55], v[248:251], v[144:159]
    s_waitcnt vmcnt(15)
    v_mfma_f32_32x32x16_bf16 v[160:175], v[56:59], v[216:219], v[160:175]
    buffer_load_dwordx4 a[108:111], v9, s[28:31], s62 offen offset:2048 sc1
    v_mfma_f32_32x32x16_bf16 v[176:191], v[56:59], v[248:251], v[176:191]
    v_add_u32 v6, s55, v28
    v_subrev_u32 v7, 6144, v6
    s_cmp_gt_u32 s4, 1
    s_cselect_b64 vcc, -1, 0
    v_cndmask_b32 v4, v7, v6, vcc
    s_cmp_gt_u32 s4, 2
    s_cselect_b64 vcc, -1, 0
    v_cndmask_b32 v5, v7, v6, vcc
    s_waitcnt vmcnt(9) lgkmcnt(0)
    s_barrier
    v_cmp_ne_u32 vcc, s11, v85
    s_cbranch_vccnz .slow_z_14
.back_z_15:
    v_and_b32 v84, 31, v1
    v_lshl_add_u32 v84, v84, 2, s71
    v_lshrrev_b32 v2, 4, v1
    v_bfe_u32 v3, v1, 2, 2
    v_lshrrev_b32 v16, 1, v2
    v_lshl_add_u32 v16, v16, 3, v3
    v_lshlrev_b32 v16, 7, v16
    v_lshrrev_b32 v3, 1, v3
    v_lshl_add_u32 v16, v3, 6, v16
    v_and_b32 v2, 1, v2
    v_lshl_add_u32 v16, v2, 5, v16
    v_and_b32 v2, 3, v1
    v_lshl_add_u32 v16, v2, 3, v16
    v_add_u32 v16, s55, v16
    v_xor_b32 v17, 64, v16
    v_mfma_f32_32x32x16_bf16 v[96:111], v[60:63], v[220:223], v[96:111]
    s_add_u32 s62, s62, 3072
    s_cmp_eq_u32 s62, s83
    s_cselect_b32 s62, s56, s62
    buffer_load_dwordx4 a[112:115], v8, s[28:31], s62 offen offset:0 sc1
    v_mfma_f32_32x32x16_bf16 v[112:127], v[60:63], v[252:255], v[112:127]
    v_mfma_f32_32x32x16_bf16 v[128:143], v[64:67], v[220:223], v[128:143]
    s_add_u32 s61, s62, 3072
    buffer_load_dwordx4 a[116:119], v8, s[28:31], s61 offen offset:0 sc1
    v_mfma_f32_32x32x16_bf16 v[144:159], v[64:67], v[252:255], v[144:159]
    v_mfma_f32_32x32x16_bf16 v[160:175], v[68:71], v[220:223], v[160:175]
    s_add_u32 s61, s62, 6144
    buffer_load_dwordx4 a[120:123], v8, s[28:31], s61 offen offset:0 sc1
    v_mfma_f32_32x32x16_bf16 v[176:191], v[68:71], v[252:255], v[176:191]
    v_mfma_f32_32x32x16_bf16 v[96:111], a[64:67], a[0:3], v[96:111]
    s_add_u32 s61, s62, 9216
    buffer_load_dwordx4 a[124:127], v8, s[28:31], s61 offen offset:0 sc1
    v_mfma_f32_32x32x16_bf16 v[112:127], a[64:67], a[32:35], v[112:127]
    v_mfma_f32_32x32x16_bf16 v[128:143], a[68:71], a[0:3], v[128:143]
    buffer_load_dwordx4 v[40:43], v9, s[28:31], s62 offen offset:1024 sc1
    v_mfma_f32_32x32x16_bf16 v[144:159], a[68:71], a[32:35], v[144:159]
    v_mfma_f32_32x32x16_bf16 v[160:175], a[72:75], a[0:3], v[160:175]
    s_add_u32 s61, s62, 3072
    buffer_load_dwordx4 v[44:47], v9, s[28:31], s61 offen offset:1024 sc1
    v_mfma_f32_32x32x16_bf16 v[176:191], a[72:75], a[32:35], v[176:191]
    buffer_load_dwordx4 v[216:219], v28, s[28:31], s68 offen sc1
    buffer_load_dwordx4 v[220:223], v28, s[28:31], s69 offen sc1
    buffer_load_dwordx4 v[224:227], v28, s[28:31], s70 offen sc1
    s_waitcnt vmcnt(17)
    v_mfma_f32_32x32x16_bf16 v[96:111], a[76:79], a[4:7], v[96:111]
    v_mfma_f32_32x32x16_bf16 v[112:127], a[76:79], a[36:39], v[112:127]
    s_add_u32 s61, s62, 6144
    buffer_load_dwordx4 v[48:51], v9, s[28:31], s61 offen offset:1024 sc1
    s_waitcnt vmcnt(17)
    v_mfma_f32_32x32x16_bf16 v[128:143], a[80:83], a[4:7], v[128:143]
    v_mfma_f32_32x32x16_bf16 v[144:159], a[80:83], a[36:39], v[144:159]
    s_add_u32 s61, s62, 9216
    buffer_load_dwordx4 v[52:55], v9, s[28:31], s61 offen offset:1024 sc1
    s_waitcnt vmcnt(17)
    v_mfma_f32_32x32x16_bf16 v[160:175], a[84:87], a[4:7], v[160:175]
    v_mfma_f32_32x32x16_bf16 v[176:191], a[84:87], a[36:39], v[176:191]
    buffer_load_dwordx4 v[56:59], v9, s[28:31], s62 offen offset:2048 sc1
    buffer_load_dwordx4 v[88:91], v30, s[16:19], 0 offen
    buffer_load_dwordx4 v[92:95], v31, s[16:19], 0 offen
    s_waitcnt vmcnt(19)
    v_mfma_f32_32x32x16_bf16 v[96:111], a[88:91], a[8:11], v[96:111]
    v_mfma_f32_32x32x16_bf16 v[112:127], a[88:91], a[40:43], v[112:127]
    s_add_u32 s61, s62, 3072
    buffer_load_dwordx4 v[60:63], v9, s[28:31], s61 offen offset:2048 sc1
    s_waitcnt vmcnt(19)
    v_mfma_f32_32x32x16_bf16 v[128:143], a[92:95], a[8:11], v[128:143]
    v_mfma_f32_32x32x16_bf16 v[144:159], a[92:95], a[40:43], v[144:159]
    s_add_u32 s61, s62, 6144
    buffer_load_dwordx4 v[64:67], v9, s[28:31], s61 offen offset:2048 sc1
    s_waitcnt vmcnt(19)
    v_mfma_f32_32x32x16_bf16 v[160:175], a[96:99], a[8:11], v[160:175]
    v_mfma_f32_32x32x16_bf16 v[176:191], a[96:99], a[40:43], v[176:191]
    s_add_u32 s61, s62, 9216
    buffer_load_dwordx4 v[68:71], v9, s[28:31], s61 offen offset:2048 sc1
    s_waitcnt vmcnt(19)
    v_mfma_f32_32x32x16_bf16 v[96:111], a[100:103], a[12:15], v[96:111]
    v_mfma_f32_32x32x16_bf16 v[112:127], a[100:103], a[44:47], v[112:127]
    buffer_load_dwordx4 a[192:195], v28, s[28:31], s67 offen offset:0 sc1
    s_waitcnt vmcnt(19)
    v_mfma_f32_32x32x16_bf16 v[128:143], a[104:107], a[12:15], v[128:143]
    v_mfma_f32_32x32x16_bf16 v[144:159], a[104:107], a[44:47], v[144:159]
    buffer_load_dwordx4 a[196:199], v28, s[28:31], s67 offen offset:1024 sc1
    s_waitcnt vmcnt(19)
    v_mfma_f32_32x32x16_bf16 v[160:175], a[108:111], a[12:15], v[160:175]
    v_mfma_f32_32x32x16_bf16 v[176:191], a[108:111], a[44:47], v[176:191]
    buffer_load_dwordx4 a[200:203], v28, s[28:31], s67 offen offset:2048 sc1
    s_waitcnt vmcnt(19)
    v_mfma_f32_32x32x16_bf16 v[96:111], a[112:115], a[16:19], v[96:111]
    v_mfma_f32_32x32x16_bf16 v[112:127], a[112:115], a[48:51], v[112:127]
    buffer_load_dwordx4 a[204:207], v28, s[28:31], s67 offen offset:3072 sc1
    s_waitcnt vmcnt(19)
    v_mfma_f32_32x32x16_bf16 v[96:111], a[116:119], a[20:23], v[96:111]
    v_mfma_f32_32x32x16_bf16 v[112:127], a[116:119], a[52:55], v[112:127]
    s_add_u32 s67, s67, 4096
    buffer_load_dwordx4 a[208:211], v28, s[28:31], s67 offen offset:0 sc1
    s_waitcnt vmcnt(19)
    v_mfma_f32_32x32x16_bf16 v[96:111], a[120:123], a[24:27], v[96:111]
    v_mfma_f32_32x32x16_bf16 v[112:127], a[120:123], a[56:59], v[112:127]
    buffer_load_dwordx4 a[212:215], v28, s[28:31], s67 offen offset:1024 sc1
    s_waitcnt vmcnt(19)
    v_mfma_f32_32x32x16_bf16 v[96:111], a[124:127], a[28:31], v[96:111]
    v_mfma_f32_32x32x16_bf16 v[112:127], a[124:127], a[60:63], v[112:127]
    buffer_load_dwordx4 a[216:219], v28, s[28:31], s67 offen offset:2048 sc1
    s_waitcnt vmcnt(19)
    v_mfma_f32_32x32x16_bf16 v[128:143], v[40:43], a[16:19], v[128:143]
    v_mfma_f32_32x32x16_bf16 v[144:159], v[40:43], a[48:51], v[144:159]
    buffer_load_dwordx4 a[220:223], v28, s[28:31], s67 offen offset:3072 sc1
    s_waitcnt vmcnt(19)
    v_mfma_f32_32x32x16_bf16 v[128:143], v[44:47], a[20:23], v[128:143]
    s_nop 6
    s_cmp_eq_u32 s4, 0
    s_cbranch_scc1 .cls_z_16
    ds_write_b128 v6, v[96:99] offset:0
    ds_write_b128 v6, v[100:103] offset:1024
.cls_z_16:
    s_add_u32 s67, s67, 4096
    buffer_load_dwordx4 a[224:227], v28, s[28:31], s67 offen offset:0 sc1
    v_mfma_f32_32x32x16_bf16 v[144:159], v[44:47], a[52:55], v[144:159]
    s_cmp_eq_u32 s4, 1
    s_cbranch_scc1 .cls_z_17
    ds_write_b128 v4, v[112:115] offset:6144
    ds_write_b128 v4, v[116:119] offset:7168
.cls_z_17:
    buffer_load_dwordx4 a[228:231], v28, s[28:31], s67 offen offset:1024 sc1
    s_waitcnt vmcnt(17)
    v_mfma_f32_32x32x16_bf16 v[128:143], v[48:51], a[24:27], v[128:143]
    s_cmp_eq_u32 s4, 2
    s_cbranch_scc1 .cls_z_18
    ds_write_b128 v5, v[104:107] offset:12288
    ds_write_b128 v5, v[108:111] offset:13312
.cls_z_18:
    buffer_load_dwordx4 a[232:235], v28, s[28:31], s67 offen offset:2048 sc1
    v_mfma_f32_32x32x16_bf16 v[144:159], v[48:51], a[56:59], v[144:159]
    s_cmp_eq_u32 s4, 3
    s_cbranch_scc1 .cls_z_19
    ds_write_b128 v7, v[120:123] offset:18432
    ds_write_b128 v7, v[124:127] offset:19456
.cls_z_19:
    buffer_load_dwordx4 a[236:239], v28, s[28:31], s67 offen offset:3072 sc1
    s_waitcnt vmcnt(18)
    v_mfma_f32_32x32x16_bf16 v[128:143], v[52:55], a[28:31], v[128:143]
    v_mfma_f32_32x32x16_bf16 v[144:159], v[52:55], a[60:63], v[144:159]
    s_add_u32 s67, s67, 4096
    buffer_load_dwordx4 a[240:243], v28, s[28:31], s67 offen offset:0 sc1
    s_waitcnt vmcnt(18)
    v_mfma_f32_32x32x16_bf16 v[160:175], v[56:59], a[16:19], v[160:175]
    v_mfma_f32_32x32x16_bf16 v[176:191], v[56:59], a[48:51], v[176:191]
    buffer_load_dwordx4 a[244:247], v28, s[28:31], s67 offen offset:1024 sc1
    s_waitcnt vmcnt(16)
    v_mfma_f32_32x32x16_bf16 v[160:175], v[60:63], a[20:23], v[160:175]
    s_nop 6
    s_cmp_eq_u32 s4, 0
    s_cbranch_scc1 .cls_z_20
    ds_write_b128 v6, v[128:131] offset:2048
    ds_write_b128 v6, v[132:135] offset:3072
.cls_z_20:
    buffer_load_dwordx4 a[248:251], v28, s[28:31], s67 offen offset:2048 sc1
    v_mfma_f32_32x32x16_bf16 v[176:191], v[60:63], a[52:55], v[176:191]
    s_cmp_eq_u32 s4, 1
    s_cbranch_scc1 .cls_z_21
    ds_write_b128 v4, v[144:147] offset:8192
    ds_write_b128 v4, v[148:151] offset:9216
.cls_z_21:
    buffer_load_dwordx4 a[252:255], v28, s[28:31], s67 offen offset:3072 sc1
    s_waitcnt vmcnt(17)
    v_mfma_f32_32x32x16_bf16 v[160:175], v[64:67], a[24:27], v[160:175]
    s_cmp_eq_u32 s4, 2
    s_cbranch_scc1 .cls_z_22
    ds_write_b128 v5, v[136:139] offset:14336
    ds_write_b128 v5, v[140:143] offset:15360
.cls_z_22:
    s_add_u32 m0, s55, 18432
    s_add_u32 s84, s53, 0
    v_mfma_f32_32x32x16_bf16 v[176:191], v[64:67], a[56:59], v[176:191]
    s_cmp_eq_u32 s4, 3
    s_cbranch_scc1 .cls_z_23
    ds_write_b128 v7, v[152:155] offset:20480
    ds_write_b128 v7, v[156:159] offset:21504
.cls_z_23:
    buffer_load_dwordx4 v76, s[36:39], s84 offen offset:0 lds
    s_waitcnt vmcnt(17)
    v_mfma_f32_32x32x16_bf16 v[160:175], v[68:71], a[28:31], v[160:175]
    v_mfma_f32_32x32x16_bf16 v[176:191], v[68:71], a[60:63], v[176:191]
    buffer_load_dwordx4 v77, s[36:39], s84 offen offset:1024 lds
    v_lshlrev_b32 v2, 16, v29
    v_lshlrev_b32 v32, 16, v216
    v_and_b32 v33, 0xffff0000, v216
    v_lshlrev_b32 v34, 16, v217
    v_and_b32 v35, 0xffff0000, v217
    v_lshlrev_b32 v36, 16, v218
    v_and_b32 v37, 0xffff0000, v218
    v_lshlrev_b32 v38, 16, v219
    v_and_b32 v39, 0xffff0000, v219
    v_lshlrev_b32 v40, 16, v220
    v_and_b32 v41, 0xffff0000, v220
    v_lshlrev_b32 v42, 16, v221
    v_and_b32 v43, 0xffff0000, v221
    v_lshlrev_b32 v44, 16, v222
    v_and_b32 v45, 0xffff0000, v222
    v_lshlrev_b32 v46, 16, v223
    v_and_b32 v47, 0xffff0000, v223
    v_lshlrev_b32 v48, 16, v224
    v_and_b32 v49, 0xffff0000, v224
    v_lshlrev_b32 v50, 16, v225
    v_and_b32 v51, 0xffff0000, v225
    v_lshlrev_b32 v52, 16, v226
    v_and_b32 v53, 0xffff0000, v226
    v_lshlrev_b32 v54, 16, v227
    v_and_b32 v55, 0xffff0000, v227
    buffer_load_dwordx4 v78, s[36:39], s84 offen offset:2048 lds
    s_cmp_eq_u32 s4, 0
    s_cbranch_scc1 .cls_z_24
    ds_write_b128 v6, v[160:163] offset:4096
    ds_write_b128 v6, v[164:167] offset:5120
.cls_z_24:
    buffer_load_dwordx4 v79, s[36:39], s84 offen offset:3072 lds
    s_cmp_eq_u32 s4, 1
    s_cbranch_scc1 .cls_z_25
    ds_write_b128 v4, v[176:179] offset:10240
    ds_write_b128 v4, v[180:183] offset:11264
.cls_z_25:
    s_add_u32 m0, s55, 22528
    s_add_u32 s84, s53, 32768
    s_cmp_eq_u32 s4, 2
    s_cbranch_scc1 .cls_z_26
    ds_write_b128 v5, v[168:171] offset:16384
    ds_write_b128 v5, v[172:175] offset:17408
.cls_z_26:
    buffer_load_dwordx4 v76, s[36:39], s84 offen offset:0 lds
    s_cmp_eq_u32 s4, 3
    s_cbranch_scc1 .cls_z_27
    ds_write_b128 v7, v[184:187] offset:22528
    ds_write_b128 v7, v[188:191] offset:23552
.cls_z_27:
    buffer_load_dwordx4 v77, s[36:39], s84 offen offset:1024 lds
    s_cmp_lg_u32 s4, 0
    s_cbranch_scc1 .own_z_29
    v_pk_add_f32 v[192:193], v[96:97], v[2:3] op_sel_hi:[1,0]
    v_pk_add_f32 v[194:195], v[98:99], v[2:3] op_sel_hi:[1,0]
    v_pk_add_f32 v[196:197], v[100:101], v[2:3] op_sel_hi:[1,0]
    v_pk_add_f32 v[198:199], v[102:103], v[2:3] op_sel_hi:[1,0]
    v_pk_add_f32 v[200:201], v[128:129], v[2:3] op_sel_hi:[1,0]
    v_pk_add_f32 v[202:203], v[130:131], v[2:3] op_sel_hi:[1,0]
    v_pk_add_f32 v[204:205], v[132:133], v[2:3] op_sel_hi:[1,0]
    v_pk_add_f32 v[206:207], v[134:135], v[2:3] op_sel_hi:[1,0]
    v_pk_add_f32 v[208:209], v[160:161], v[2:3] op_sel_hi:[1,0]
    v_pk_add_f32 v[210:211], v[162:163], v[2:3] op_sel_hi:[1,0]
    v_pk_add_f32 v[212:213], v[164:165], v[2:3] op_sel_hi:[1,0]
    v_pk_add_f32 v[214:215], v[166:167], v[2:3] op_sel_hi:[1,0]
    s_branch .own_z_28
.own_z_29:
    s_cmp_lg_u32 s4, 1
    s_cbranch_scc1 .own_z_30
    v_pk_add_f32 v[192:193], v[112:113], v[2:3] op_sel_hi:[1,0]
    v_pk_add_f32 v[194:195], v[114:115], v[2:3] op_sel_hi:[1,0]
    v_pk_add_f32 v[196:197], v[116:117], v[2:3] op_sel_hi:[1,0]
    v_pk_add_f32 v[198:199], v[118:119], v[2:3] op_sel_hi:[1,0]
    v_pk_add_f32 v[200:201], v[144:145], v[2:3] op_sel_hi:[1,0]
    v_pk_add_f32 v[202:203], v[146:147], v[2:3] op_sel_hi:[1,0]
    v_pk_add_f32 v[204:205], v[148:149], v[2:3] op_sel_hi:[1,0]
    v_pk_add_f32 v[206:207], v[150:151], v[2:3] op_sel_hi:[1,0]
    v_pk_add_f32 v[208:209], v[176:177], v[2:3] op_sel_hi:[1,0]
    v_pk_add_f32 v[210:211], v[178:179], v[2:3] op_sel_hi:[1,0]
    v_pk_add_f32 v[212:213], v[180:181], v[2:3] op_sel_hi:[1,0]
    v_pk_add_f32 v[214:215], v[182:183], v[2:3] op_sel_hi:[1,0]
    s_branch .own_z_28
.own_z_30:
    s_cmp_lg_u32 s4, 2
    s_cbranch_scc1 .own_z_31
    v_pk_add_f32 v[192:193], v[104:105], v[2:3] op_sel_hi:[1,0]
    v_pk_add_f32 v[194:195], v[106:107], v[2:3] op_sel_hi:[1,0]
    v_pk_add_f32 v[196:197], v[108:109], v[2:3] op_sel_hi:[1,0]
    v_pk_add_f32 v[198:199], v[110:111], v[2:3] op_sel_hi:[1,0]
    v_pk_add_f32 v[200:201], v[136:137], v[2:3] op_sel_hi:[1,0]
    v_pk_add_f32 v[202:203], v[138:139], v[2:3] op_sel_hi:[1,0]
    v_pk_add_f32 v[204:205], v[140:141], v[2:3] op_sel_hi:[1,0]
    v_pk_add_f32 v[206:207], v[142:143], v[2:3] op_sel_hi:[1,0]
    v_pk_add_f32 v[208:209], v[168:169], v[2:3] op_sel_hi:[1,0]
    v_pk_add_f32 v[210:211], v[170:171], v[2:3] op_sel_hi:[1,0]
    v_pk_add_f32 v[212:213], v[172:173], v[2:3] op_sel_hi:[1,0]
    v_pk_add_f32 v[214:215], v[174:175], v[2:3] op_sel_hi:[1,0]
    s_branch .own_z_28
.own_z_31:
    v_pk_add_f32 v[192:193], v[120:121], v[2:3] op_sel_hi:[1,0]
    v_pk_add_f32 v[194:195], v[122:123], v[2:3] op_sel_hi:[1,0]
    v_pk_add_f32 v[196:197], v[124:125], v[2:3] op_sel_hi:[1,0]
    v_pk_add_f32 v[198:199], v[126:127], v[2:3] op_sel_hi:[1,0]
    v_pk_add_f32 v[200:201], v[152:153], v[2:3] op_sel_hi:[1,0]
    v_pk_add_f32 v[202:203], v[154:155], v[2:3] op_sel_hi:[1,0]
    v_pk_add_f32 v[204:205], v[156:157], v[2:3] op_sel_hi:[1,0]
    v_pk_add_f32 v[206:207], v[158:159], v[2:3] op_sel_hi:[1,0]
    v_pk_add_f32 v[208:209], v[184:185], v[2:3] op_sel_hi:[1,0]
    v_pk_add_f32 v[210:211], v[186:187], v[2:3] op_sel_hi:[1,0]
    v_pk_add_f32 v[212:213], v[188:189], v[2:3] op_sel_hi:[1,0]
    v_pk_add_f32 v[214:215], v[190:191], v[2:3] op_sel_hi:[1,0]
.own_z_28:
    buffer_load_dwordx4 v78, s[36:39], s84 offen offset:2048 lds
    s_waitcnt lgkmcnt(0)
    s_barrier
    ds_read_b128 v[96:99], v10 offset:0
    ds_read_b128 v[100:103], v10 offset:1024
    ds_read_b128 v[104:107], v11 offset:0
    ds_read_b128 v[108:111], v11 offset:1024
    ds_read_b128 v[112:115], v12 offset:0
    ds_read_b128 v[116:119], v12 offset:1024
    ds_read_b128 v[120:123], v10 offset:2048
    ds_read_b128 v[124:127], v10 offset:3072
    ds_read_b128 v[128:131], v11 offset:2048
    ds_read_b128 v[132:135], v11 offset:3072
    ds_read_b128 v[136:139], v12 offset:2048
    ds_read_b128 v[140:143], v12 offset:3072
    s_waitcnt lgkmcnt(6)
    ds_read_b128 v[144:147], v10 offset:4096
    ds_read_b128 v[148:151], v10 offset:5120
    ds_read_b128 v[152:155], v11 offset:4096
    ds_read_b128 v[156:159], v11 offset:5120
    ds_read_b128 v[160:163], v12 offset:4096
    ds_read_b128 v[164:167], v12 offset:5120
    buffer_load_dwordx4 v79, s[36:39], s84 offen offset:3072 lds
    s_add_u32 m0, s55, 26624
    s_add_u32 s84, s53, 65536
    v_pk_add_f32 v[96:97], v[96:97], v[104:105]
    v_pk_add_f32 v[98:99], v[98:99], v[106:107]
    v_pk_add_f32 v[100:101], v[100:101], v[108:109]
    v_pk_add_f32 v[102:103], v[102:103], v[110:111]
    v_pk_add_f32 v[192:193], v[192:193], v[112:113]
    v_pk_add_f32 v[194:195], v[194:195], v[114:115]
    v_pk_add_f32 v[196:197], v[196:197], v[116:117]
    v_pk_add_f32 v[198:199], v[198:199], v[118:119]
    v_pk_add_f32 v[192:193], v[192:193], v[96:97]
    v_pk_add_f32 v[194:195], v[194:195], v[98:99]
    v_pk_add_f32 v[196:197], v[196:197], v[100:101]
    v_pk_add_f32 v[198:199], v[198:199], v[102:103]
    v_pk_mul_f32 v[192:193], v[192:193], v[32:33]
    v_pk_mul_f32 v[194:195], v[194:195], v[34:35]
    v_pk_mul_f32 v[196:197], v[196:197], v[36:37]
    v_pk_mul_f32 v[198:199], v[198:199], v[38:39]
    v_cvt_pk_bf16_f32 v56, v192, v193
    v_cvt_pk_bf16_f32 v57, v194, v195
    v_cvt_pk_bf16_f32 v58, v196, v197
    v_cvt_pk_bf16_f32 v59, v198, v199
    s_nop 0
    v_permlane32_swap_b32 v56, v58
    v_permlane32_swap_b32 v57, v59
    s_cmp_eq_u32 s12, 0
    s_cbranch_scc1 .sc1_z_33
    buffer_store_dwordx4 v[56:59], v28, s[28:31], s68 offen
.back_z_34:
    s_waitcnt lgkmcnt(8)
    v_pk_add_f32 v[120:121], v[120:121], v[128:129]
    v_pk_add_f32 v[122:123], v[122:123], v[130:131]
    v_pk_add_f32 v[124:125], v[124:125], v[132:133]
    v_pk_add_f32 v[126:127], v[126:127], v[134:135]
    s_waitcnt lgkmcnt(6)
    v_pk_add_f32 v[200:201], v[200:201], v[136:137]
    v_pk_add_f32 v[202:203], v[202:203], v[138:139]
    v_pk_add_f32 v[204:205], v[204:205], v[140:141]
    v_pk_add_f32 v[206:207], v[206:207], v[142:143]
    v_pk_add_f32 v[200:201], v[200:201], v[120:121]
    v_pk_add_f32 v[202:203], v[202:203], v[122:123]
    v_pk_add_f32 v[204:205], v[204:205], v[124:125]
    v_pk_add_f32 v[206:207], v[206:207], v[126:127]
    v_pk_mul_f32 v[200:201], v[200:201], v[40:41]
    v_pk_mul_f32 v[202:203], v[202:203], v[42:43]
    v_pk_mul_f32 v[204:205], v[204:205], v[44:45]
    v_pk_mul_f32 v[206:207], v[206:207], v[46:47]
    v_cvt_pk_bf16_f32 v60, v200, v201
    v_cvt_pk_bf16_f32 v61, v202, v203
    v_cvt_pk_bf16_f32 v62, v204, v205
    v_cvt_pk_bf16_f32 v63, v206, v207
    s_nop 0
    v_permlane32_swap_b32 v60, v62
    v_permlane32_swap_b32 v61, v63
    s_cmp_eq_u32 s12, 0
    s_cbranch_scc1 .sc1_z_35
    buffer_store_dwordx4 v[60:63], v28, s[28:31], s69 offen
.back_z_36:
    s_waitcnt lgkmcnt(2)
    v_pk_add_f32 v[144:145], v[144:145], v[152:153]
    v_pk_add_f32 v[146:147], v[146:147], v[154:155]
    v_pk_add_f32 v[148:149], v[148:149], v[156:157]
    v_pk_add_f32 v[150:151], v[150:151], v[158:159]
    s_waitcnt lgkmcnt(0)
    v_pk_add_f32 v[208:209], v[208:209], v[160:161]
    v_pk_add_f32 v[210:211], v[210:211], v[162:163]
    v_pk_add_f32 v[212:213], v[212:213], v[164:165]
    v_pk_add_f32 v[214:215], v[214:215], v[166:167]
    v_pk_add_f32 v[208:209], v[208:209], v[144:145]
    v_pk_add_f32 v[210:211], v[210:211], v[146:147]
    v_pk_add_f32 v[212:213], v[212:213], v[148:149]
    v_pk_add_f32 v[214:215], v[214:215], v[150:151]
    v_pk_mul_f32 v[208:209], v[208:209], v[48:49]
    v_pk_mul_f32 v[210:211], v[210:211], v[50:51]
    v_pk_mul_f32 v[212:213], v[212:213], v[52:53]
    v_pk_mul_f32 v[214:215], v[214:215], v[54:55]
    v_cvt_pk_bf16_f32 v64, v208, v209
    v_cvt_pk_bf16_f32 v65, v210, v211
    v_cvt_pk_bf16_f32 v66, v212, v213
    v_cvt_pk_bf16_f32 v67, v214, v215
    s_nop 0
    v_permlane32_swap_b32 v64, v66
    v_permlane32_swap_b32 v65, v67
    s_cmp_eq_u32 s12, 0
    s_cbranch_scc1 .sc1_z_37
    buffer_store_dwordx4 v[64:67], v28, s[28:31], s70 offen
.back_z_38:
    s_waitcnt vmcnt(25)
    v_mfma_f32_32x32x16_bf16 v[128:143], a[128:131], a[192:195], 0
    v_mfma_f32_32x32x16_bf16 v[144:159], a[128:131], a[196:199], 0
    buffer_load_dwordx4 v76, s[36:39], s84 offen offset:0 lds
    v_mfma_f32_32x32x16_bf16 v[160:175], a[132:135], a[192:195], 0
    v_mfma_f32_32x32x16_bf16 v[176:191], a[132:135], a[196:199], 0
    buffer_load_dwordx4 v77, s[36:39], s84 offen offset:1024 lds
    s_waitcnt vmcnt(11)
    ds_read_b64_tr_b16 a[64:65], v16 offset:18432
    ds_read_b64_tr_b16 a[66:67], v16 offset:18944
    v_mfma_f32_32x32x16_bf16 v[128:143], a[136:139], a[200:203], v[128:143]
    ds_read_b64_tr_b16 a[68:69], v17 offset:18432
    ds_read_b64_tr_b16 a[70:71], v17 offset:18944
    v_mfma_f32_32x32x16_bf16 v[144:159], a[136:139], a[204:207], v[144:159]
    buffer_load_dwordx4 v78, s[36:39], s84 offen offset:2048 lds
    v_mfma_f32_32x32x16_bf16 v[160:175], a[140:143], a[200:203], v[160:175]
    v_mfma_f32_32x32x16_bf16 v[176:191], a[140:143], a[204:207], v[176:191]
    s_waitcnt vmcnt(3)
    v_mov_b32 v2, s11
    v_mov_b32 v3, 0
    s_mov_b64 exec, 1
    s_cmp_eq_u32 s12, 0
    s_cbranch_scc1 .sc1_z_39
    buffer_store_dword v2, v3, s[28:31], s66 offen
.back_z_40:
    s_mov_b64 exec, -1
    v_mfma_f32_32x32x16_bf16 v[128:143], a[144:147], a[208:211], v[128:143]
    ds_read_b64_tr_b16 a[72:73], v16 offset:20480
    ds_read_b64_tr_b16 a[74:75], v16 offset:20992
    v_mfma_f32_32x32x16_bf16 v[144:159], a[144:147], a[212:215], v[144:159]
    buffer_load_dwordx4 v79, s[36:39], s84 offen offset:3072 lds
    ds_read_b64_tr_b16 a[76:77], v17 offset:20480
    ds_read_b64_tr_b16 a[78:79], v17 offset:20992
    v_and_b32 v2, 31, v1
    v_mul_u32_u24 v2, 272, v2
    v_lshrrev_b32 v3, 5, v1
    v_lshl_add_u32 v2, v3, 4, v2
    v_add_u32 v2, s55, v2
    v_mfma_f32_32x32x16_bf16 v[160:175], a[148:151], a[208:211], v[160:175]
    s_add_u32 m0, s55, 30720
    s_add_u32 s84, s53, 98304
    ds_read_b64_tr_b16 a[80:81], v16 offset:22528
    ds_read_b64_tr_b16 a[82:83], v16 offset:23040
    v_lshrrev_b32 v3, 3, v0
    v_mul_u32_u24 v3, 272, v3
    v_and_b32 v4, 7, v0
    v_lshl_add_u32 v3, v4, 5, v3
    v_add_u32 v3, 18432, v3
    v_add_u32 v4, 81920, v3
    v_mfma_f32_32x32x16_bf16 v[176:191], a[148:151], a[212:215], v[176:191]
    buffer_load_dwordx4 v76, s[36:39], s84 offen offset:0 lds
    ds_read_b64_tr_b16 a[84:85], v17 offset:22528
    ds_read_b64_tr_b16 a[86:87], v17 offset:23040
    v_lshlrev_b32 v112, 16, v88
    v_and_b32 v113, 0xffff0000, v88
    v_lshlrev_b32 v114, 16, v89
    v_and_b32 v115, 0xffff0000, v89
    v_mfma_f32_32x32x16_bf16 v[128:143], a[152:155], a[216:219], v[128:143]
    ds_read_b64_tr_b16 a[88:89], v16 offset:24576
    ds_read_b64_tr_b16 a[90:91], v16 offset:25088
    v_lshlrev_b32 v116, 16, v90
    v_and_b32 v117, 0xffff0000, v90
    v_lshlrev_b32 v118, 16, v91
    v_and_b32 v119, 0xffff0000, v91
    v_mfma_f32_32x32x16_bf16 v[144:159], a[152:155], a[220:223], v[144:159]
    buffer_load_dwordx4 v77, s[36:39], s84 offen offset:1024 lds
    ds_read_b64_tr_b16 a[92:93], v17 offset:24576
    ds_read_b64_tr_b16 a[94:95], v17 offset:25088
    v_lshlrev_b32 v120, 16, v92
    v_and_b32 v121, 0xffff0000, v92
    v_lshlrev_b32 v122, 16, v93
    v_and_b32 v123, 0xffff0000, v93
    v_mfma_f32_32x32x16_bf16 v[160:175], a[156:159], a[216:219], v[160:175]
    v_lshlrev_b32 v124, 16, v94
    v_and_b32 v125, 0xffff0000, v94
    v_lshlrev_b32 v126, 16, v95
    v_and_b32 v127, 0xffff0000, v95
    v_mfma_f32_32x32x16_bf16 v[176:191], a[156:159], a[220:223], v[176:191]
    buffer_load_dwordx4 v78, s[36:39], s84 offen offset:2048 lds
    v_mfma_f32_32x32x16_bf16 v[128:143], a[160:163], a[224:227], v[128:143]
    v_mfma_f32_32x32x16_bf16 v[144:159], a[160:163], a[228:231], v[144:159]
    buffer_load_dword v85, v84, s[28:31], 0 offen sc1
    v_mfma_f32_32x32x16_bf16 v[160:175], a[164:167], a[224:227], v[160:175]
    v_mfma_f32_32x32x16_bf16 v[176:191], a[164:167], a[228:231], v[176:191]
    buffer_load_dwordx4 v79, s[36:39], s84 offen offset:3072 lds
    s_waitcnt vmcnt(8)
    ds_read_b64_tr_b16 a[96:97], v16 offset:26624
    ds_read_b64_tr_b16 a[98:99], v16 offset:27136
    v_mfma_f32_32x32x16_bf16 v[128:143], a[168:171], a[232:235], v[128:143]
    s_add_u32 m0, s55, 34816
    s_add_u32 s84, s53, 131072
    ds_read_b64_tr_b16 a[100:101], v17 offset:26624
    ds_read_b64_tr_b16 a[102:103], v17 offset:27136
    v_mfma_f32_32x32x16_bf16 v[144:159], a[168:171], a[236:239], v[144:159]
    buffer_load_dwordx4 v76, s[36:39], s84 offen offset:0 lds
    v_mfma_f32_32x32x16_bf16 v[160:175], a[172:175], a[232:235], v[160:175]
    v_mfma_f32_32x32x16_bf16 v[176:191], a[172:175], a[236:239], v[176:191]
    buffer_load_dwordx4 v77, s[36:39], s84 offen offset:1024 lds
    v_mfma_f32_32x32x16_bf16 v[128:143], a[176:179], a[240:243], v[128:143]
    v_mfma_f32_32x32x16_bf16 v[144:159], a[176:179], a[244:247], v[144:159]
    buffer_load_dwordx4 v78, s[36:39], s84 offen offset:2048 lds
    buffer_load_dwordx4 v79, s[36:39], s84 offen offset:3072 lds
    s_add_u32 m0, s55, 38912
    s_add_u32 s84, s53, 163840
    buffer_load_dwordx4 v76, s[36:39], s84 offen offset:0 lds
    buffer_load_dwordx4 v77, s[36:39], s84 offen offset:1024 lds
    s_waitcnt vmcnt(7)
    s_mov_b32 s57, 0
.loop_z_41:
    v_cmp_ne_u32 vcc, s11, v85
    s_cbranch_vccz .ok_z_42
    s_add_u32 s57, s57, 1
    s_cmp_gt_u32 s57, 200000
    s_cbranch_scc1 .Lfail_5
    s_sleep 2
    buffer_load_dword v85, v84, s[28:31], 0 offen sc1
    s_waitcnt vmcnt(0)
    s_branch .loop_z_41
.ok_z_42:
    buffer_load_dwordx4 a[0:3], v28, s[28:31], s72 offen offset:0 sc1
    buffer_load_dwordx4 a[4:7], v28, s[28:31], s72 offen offset:1024 sc1
    buffer_load_dwordx4 a[8:11], v28, s[28:31], s72 offen offset:2048 sc1
    buffer_load_dwordx4 a[12:15], v28, s[28:31], s72 offen offset:3072 sc1
    s_add_u32 s72, s72, 4096
    buffer_load_dwordx4 a[16:19], v28, s[28:31], s72 offen offset:0 sc1
    buffer_load_dwordx4 a[20:23], v28, s[28:31], s72 offen offset:1024 sc1
    v_mfma_f32_32x32x16_bf16 v[160:175], a[180:183], a[240:243], v[160:175]
    ds_read_b64_tr_b16 a[104:105], v16 offset:28672
    ds_read_b64_tr_b16 a[106:107], v16 offset:29184
    v_mfma_f32_32x32x16_bf16 v[176:191], a[180:183], a[244:247], v[176:191]
    buffer_load_dwordx4 a[24:27], v28, s[28:31], s72 offen offset:2048 sc1
    ds_read_b64_tr_b16 a[108:109], v17 offset:28672
    ds_read_b64_tr_b16 a[110:111], v17 offset:29184
    v_mfma_f32_32x32x16_bf16 v[128:143], a[184:187], a[248:251], v[128:143]
    ds_read_b64_tr_b16 a[112:113], v16 offset:30720
    ds_read_b64_tr_b16 a[114:115], v16 offset:31232
    v_mfma_f32_32x32x16_bf16 v[144:159], a[184:187], a[252:255], v[144:159]
    buffer_load_dwordx4 a[28:31], v28, s[28:31], s72 offen offset:3072 sc1
    ds_read_b64_tr_b16 a[116:117], v17 offset:30720
    ds_read_b64_tr_b16 a[118:119], v17 offset:31232
    v_mfma_f32_32x32x16_bf16 v[160:175], a[188:191], a[248:251], v[160:175]
    s_waitcnt vmcnt(14)
    ds_read_b64_tr_b16 a[120:121], v16 offset:32768
    ds_read_b64_tr_b16 a[122:123], v16 offset:33280
    v_mfma_f32_32x32x16_bf16 v[176:191], a[188:191], a[252:255], v[176:191]
    s_add_u32 s72, s72, 4096
    buffer_load_dwordx4 a[32:35], v28, s[28:31], s72 offen offset:0 sc1
    ds_read_b64_tr_b16 a[124:125], v17 offset:32768
    ds_read_b64_tr_b16 a[126:127], v17 offset:33280
    s_waitcnt vmcnt(13)
    ds_read_b64_tr_b16 v[40:41], v16 offset:34816
    ds_read_b64_tr_b16 v[42:43], v16 offset:35328
    ds_read_b64_tr_b16 v[44:45], v17 offset:34816
    ds_read_b64_tr_b16 v[46:47], v17 offset:35328
    s_waitcnt vmcnt(8) lgkmcnt(14)
    v_mfma_f32_32x32x16_bf16 v[128:143], a[64:67], a[0:3], v[128:143]
    buffer_load_dwordx4 a[36:39], v28, s[28:31], s72 offen offset:1024 sc1
    ds_read_b64_tr_b16 v[48:49], v16 offset:36864
    ds_read_b64_tr_b16 v[50:51], v16 offset:37376
    v_mfma_f32_32x32x16_bf16 v[160:175], a[68:71], a[0:3], v[160:175]
    ds_read_b64_tr_b16 v[52:53], v17 offset:36864
    ds_read_b64_tr_b16 v[54:55], v17 offset:37376
    s_waitcnt vmcnt(8) lgkmcnt(14)
    v_mfma_f32_32x32x16_bf16 v[128:143], a[72:75], a[4:7], v[128:143]
    s_cmp_eq_u32 s4, 3
    s_cselect_b32 s72, 2147418112, s72
    buffer_load_dwordx4 a[40:43], v28, s[28:31], s72 offen offset:2048 sc1
    ds_read_b64_tr_b16 v[56:57], v16 offset:38912
    ds_read_b64_tr_b16 v[58:59], v16 offset:39424
    v_mfma_f32_32x32x16_bf16 v[160:175], a[76:79], a[4:7], v[160:175]
    ds_read_b64_tr_b16 v[60:61], v17 offset:38912
    ds_read_b64_tr_b16 v[62:63], v17 offset:39424
    s_waitcnt vmcnt(8) lgkmcnt(14)
    v_mfma_f32_32x32x16_bf16 v[128:143], a[80:83], a[8:11], v[128:143]
    buffer_load_dwordx4 a[44:47], v28, s[28:31], s75 offen offset:0 sc1
    v_mfma_f32_32x32x16_bf16 v[160:175], a[84:87], a[8:11], v[160:175]
    s_waitcnt vmcnt(8) lgkmcnt(14)
    v_mfma_f32_32x32x16_bf16 v[128:143], a[88:91], a[12:15], v[128:143]
    buffer_load_dwordx4 a[48:51], v28, s[28:31], s75 offen offset:1024 sc1
    v_mfma_f32_32x32x16_bf16 v[160:175], a[92:95], a[12:15], v[160:175]
    s_waitcnt vmcnt(8) lgkmcnt(14)
    v_mfma_f32_32x32x16_bf16 v[128:143], a[96:99], a[16:19], v[128:143]
    buffer_load_dwordx4 a[52:55], v28, s[28:31], s75 offen offset:2048 sc1
    v_mfma_f32_32x32x16_bf16 v[160:175], a[100:103], a[16:19], v[160:175]
    s_waitcnt vmcnt(8) lgkmcnt(14)
    v_mfma_f32_32x32x16_bf16 v[128:143], a[104:107], a[20:23], v[128:143]
    buffer_load_dwordx4 a[56:59], v28, s[28:31], s75 offen offset:3072 sc1
    v_mfma_f32_32x32x16_bf16 v[160:175], a[108:111], a[20:23], v[160:175]
    s_waitcnt vmcnt(8) lgkmcnt(14)
    v_mfma_f32_32x32x16_bf16 v[128:143], a[112:115], a[24:27], v[128:143]
    s_add_u32 s75, s75, 4096
    buffer_load_dwordx4 a[60:63], v28, s[28:31], s75 offen offset:0 sc1
    v_mfma_f32_32x32x16_bf16 v[160:175], a[116:119], a[24:27], v[160:175]
    s_waitcnt vmcnt(8) lgkmcnt(12)
    v_mfma_f32_32x32x16_bf16 v[128:143], a[120:123], a[28:31], v[128:143]
    buffer_load_dwordx4 v[192:195], v28, s[28:31], s75 offen offset:1024 sc1
    v_mfma_f32_32x32x16_bf16 v[160:175], a[124:127], a[28:31], v[160:175]
    s_waitcnt vmcnt(8) lgkmcnt(8)
    v_mfma_f32_32x32x16_bf16 v[128:143], v[40:43], a[32:35], v[128:143]
    buffer_load_dwordx4 v[196:199], v28, s[28:31], s75 offen offset:2048 sc1
    v_mfma_f32_32x32x16_bf16 v[160:175], v[44:47], a[32:35], v[160:175]
    s_waitcnt vmcnt(8) lgkmcnt(4)
    v_mfma_f32_32x32x16_bf16 v[128:143], v[48:51], a[36:39], v[128:143]
    buffer_load_dwordx4 v[200:203], v28, s[28:31], s75 offen offset:3072 sc1
    v_mfma_f32_32x32x16_bf16 v[160:175], v[52:55], a[36:39], v[160:175]
    s_waitcnt vmcnt(8) lgkmcnt(0)
    v_mfma_f32_32x32x16_bf16 v[128:143], v[56:59], a[40:43], v[128:143]
    s_add_u32 s75, s75, 4096
    buffer_load_dwordx4 v[204:207], v28, s[28:31], s75 offen offset:0 sc1
    v_mfma_f32_32x32x16_bf16 v[160:175], v[60:63], a[40:43], v[160:175]
    s_waitcnt vmcnt(8)
    v_mfma_f32_32x32x16_bf16 v[144:159], a[64:67], a[44:47], v[144:159]
    buffer_load_dwordx4 v[208:211], v28, s[28:31], s75 offen offset:1024 sc1
    v_mfma_f32_32x32x16_bf16 v[176:191], a[68:71], a[44:47], v[176:191]
    s_waitcnt vmcnt(8)
    v_mfma_f32_32x32x16_bf16 v[144:159], a[72:75], a[48:51], v[144:159]
    s_cmp_eq_u32 s4, 3
    s_cselect_b32 s75, 2147418112, s75
    buffer_load_dwordx4 v[212:215], v28, s[28:31], s75 offen offset:2048 sc1
    ds_write_b128 v2, v[128:131] offset:18432
    v_mfma_f32_32x32x16_bf16 v[176:191], a[76:79], a[48:51], v[176:191]
    ds_write_b128 v2, v[132:135] offset:18464
    s_waitcnt vmcnt(8)
    v_mfma_f32_32x32x16_bf16 v[144:159], a[80:83], a[52:55], v[144:159]
    ds_write_b128 v2, v[136:139] offset:18496
    v_mfma_f32_32x32x16_bf16 v[176:191], a[84:87], a[52:55], v[176:191]
    ds_write_b128 v2, v[140:143] offset:18528
    s_waitcnt vmcnt(7)
    v_mfma_f32_32x32x16_bf16 v[144:159], a[88:91], a[56:59], v[144:159]
    ds_write_b128 v2, v[160:163] offset:18560
    v_mfma_f32_32x32x16_bf16 v[176:191], a[92:95], a[56:59], v[176:191]
    ds_write_b128 v2, v[164:167] offset:18592
    s_waitcnt vmcnt(6)
    v_mfma_f32_32x32x16_bf16 v[144:159], a[96:99], a[60:63], v[144:159]
    ds_write_b128 v2, v[168:171] offset:18624
    v_mfma_f32_32x32x16_bf16 v[176:191], a[100:103], a[60:63], v[176:191]
    ds_write_b128 v2, v[172:175] offset:18656
    s_waitcnt vmcnt(5)
    v_mfma_f32_32x32x16_bf16 v[144:159], a[104:107], v[192:195], v[144:159]
    v_mfma_f32_32x32x16_bf16 v[176:191], a[108:111], v[192:195], v[176:191]
    s_waitcnt vmcnt(4)
    v_mfma_f32_32x32x16_bf16 v[144:159], a[112:115], v[196:199], v[144:159]
    v_mfma_f32_32x32x16_bf16 v[176:191], a[116:119], v[196:199], v[176:191]
    s_waitcnt vmcnt(3)
    v_mfma_f32_32x32x16_bf16 v[144:159], a[120:123], v[200:203], v[144:159]
    v_mfma_f32_32x32x16_bf16 v[176:191], a[124:127], v[200:203], v[176:191]
    s_waitcnt lgkmcnt(0)
    s_barrier
    ds_read_b128 v[64:67], v3 offset:0
    ds_read_b128 v[68:71], v3 offset:16
    ds_read_b128 v[72:75], v3 offset:40960
    ds_read_b128 v[76:79], v3 offset:40976
    ds_read_b128 v[80:83], v4 offset:0
    ds_read_b128 v[84:87], v4 offset:16
    ds_read_b128 v[88:91], v4 offset:40960
    ds_read_b128 v[92:95], v4 offset:40976
    s_waitcnt vmcnt(2)
    v_mfma_f32_32x32x16_bf16 v[144:159], v[40:43], v[204:207], v[144:159]
    v_mfma_f32_32x32x16_bf16 v[176:191], v[44:47], v[204:207], v[176:191]
    s_waitcnt vmcnt(1)
    v_mfma_f32_32x32x16_bf16 v[144:159], v[48:51], v[208:211], v[144:159]
    v_mfma_f32_32x32x16_bf16 v[176:191], v[52:55], v[208:211], v[176:191]
    s_waitcnt vmcnt(0)
    v_mfma_f32_32x32x16_bf16 v[144:159], v[56:59], v[212:215], v[144:159]
    v_mfma_f32_32x32x16_bf16 v[176:191], v[60:63], v[212:215], v[176:191]
    s_nop 10
    ds_write_b128 v2, v[144:147] offset:27136
    ds_write_b128 v2, v[148:151] offset:27168
    ds_write_b128 v2, v[152:155] offset:27200
    ds_write_b128 v2, v[156:159] offset:27232
    ds_write_b128 v2, v[176:179] offset:27264
    ds_write_b128 v2, v[180:183] offset:27296
    ds_write_b128 v2, v[184:187] offset:27328
    ds_write_b128 v2, v[188:191] offset:27360
    s_waitcnt lgkmcnt(14)
    v_pk_add_f32 v[112:113], v[112:113], v[64:65]
    v_pk_add_f32 v[114:115], v[114:115], v[66:67]
    v_pk_add_f32 v[116:117], v[116:117], v[68:69]
    v_pk_add_f32 v[118:119], v[118:119], v[70:71]
    s_waitcnt lgkmcnt(12)
    v_pk_add_f32 v[112:113], v[112:113], v[72:73]
    v_pk_add_f32 v[114:115], v[114:115], v[74:75]
    v_pk_add_f32 v[116:117], v[116:117], v[76:77]
    v_pk_add_f32 v[118:119], v[118:119], v[78:79]
    s_waitcnt lgkmcnt(10)
    v_pk_add_f32 v[112:113], v[112:113], v[80:81]
    v_pk_add_f32 v[114:115], v[114:115], v[82:83]
    v_pk_add_f32 v[116:117], v[116:117], v[84:85]
    v_pk_add_f32 v[118:119], v[118:119], v[86:87]
    s_waitcnt lgkmcnt(8)
    v_pk_add_f32 v[112:113], v[112:113], v[88:89]
    v_pk_add_f32 v[114:115], v[114:115], v[90:91]
    v_pk_add_f32 v[116:117], v[116:117], v[92:93]
    v_pk_add_f32 v[118:119], v[118:119], v[94:95]
    v_cvt_pk_bf16_f32 v96, v112, v113
    v_cvt_pk_bf16_f32 v97, v114, v115
    v_cvt_pk_bf16_f32 v98, v116, v117
    v_cvt_pk_bf16_f32 v99, v118, v119
    buffer_store_dwordx4 v[96:99], v30, s[40:43], 0 offen sc1
    s_waitcnt lgkmcnt(0)
    s_barrier
    ds_read_b128 v[32:35], v3 offset:8704
    ds_read_b128 v[36:39], v3 offset:8720
    ds_read_b128 v[40:43], v3 offset:49664
    ds_read_b128 v[44:47], v3 offset:49680
    ds_read_b128 v[48:51], v4 offset:8704
    ds_read_b128 v[52:55], v4 offset:8720
    ds_read_b128 v[56:59], v4 offset:49664
    ds_read_b128 v[60:63], v4 offset:49680
    s_waitcnt lgkmcnt(6)
    v_pk_add_f32 v[120:121], v[120:121], v[32:33]
    v_pk_add_f32 v[122:123], v[122:123], v[34:35]
    v_pk_add_f32 v[124:125], v[124:125], v[36:37]
    v_pk_add_f32 v[126:127], v[126:127], v[38:39]
    s_waitcnt lgkmcnt(4)
    v_pk_add_f32 v[120:121], v[120:121], v[40:41]
    v_pk_add_f32 v[122:123], v[122:123], v[42:43]
    v_pk_add_f32 v[124:125], v[124:125], v[44:45]
    v_pk_add_f32 v[126:127], v[126:127], v[46:47]
    s_waitcnt lgkmcnt(2)
    v_pk_add_f32 v[120:121], v[120:121], v[48:49]
    v_pk_add_f32 v[122:123], v[122:123], v[50:51]
    v_pk_add_f32 v[124:125], v[124:125], v[52:53]
    v_pk_add_f32 v[126:127], v[126:127], v[54:55]
    s_waitcnt lgkmcnt(0)
    v_pk_add_f32 v[120:121], v[120:121], v[56:57]
    v_pk_add_f32 v[122:123], v[122:123], v[58:59]
    v_pk_add_f32 v[124:125], v[124:125], v[60:61]
    v_pk_add_f32 v[126:127], v[126:127], v[62:63]
    v_cvt_pk_bf16_f32 v100, v120, v121
    v_cvt_pk_bf16_f32 v101, v122, v123
    v_cvt_pk_bf16_f32 v102, v124, v125
    v_cvt_pk_bf16_f32 v103, v126, v127
    buffer_store_dwordx4 v[100:103], v31, s[40:43], 0 offen sc1
    s_endpgm
.slow_z_2:
    s_mov_b32 s57, 0
.loop_zt0_1:
    s_add_u32 s57, s57, 1
    s_cmp_gt_u32 s57, 200000
    s_cbranch_scc1 .Lfail_1
    s_sleep 2
    buffer_load_dwordx2 v[60:61], v29, s[28:31], 0 offen sc1
    s_waitcnt vmcnt(0)
    v_cmp_ne_u32 vcc, s11, v60
    s_cbranch_vccnz .loop_zt0_1
    s_nop 4
    s_branch .back_z_3
.sc1_z_4:
    buffer_store_dwordx4 v[40:43], v28, s[28:31], s76 offen sc1
    s_branch .back_z_5
.sc1_z_10:
    buffer_store_dwordx4 v[144:147], v28, s[28:31], s80 offen offset:0 sc1
    buffer_store_dwordx4 v[148:151], v28, s[28:31], s80 offen offset:1024 sc1
    buffer_store_dwordx4 v[152:155], v28, s[28:31], s81 offen offset:0 sc1
    buffer_store_dwordx4 v[156:159], v28, s[28:31], s81 offen offset:1024 sc1
    buffer_store_dwordx4 v[160:163], v28, s[28:31], s72 offen offset:0 sc1
    buffer_store_dwordx4 v[164:167], v28, s[28:31], s72 offen offset:1024 sc1
    s_branch .back_z_11
.sc1_z_12:
    buffer_store_dword v2, v3, s[28:31], s63 offen sc1
    buffer_store_dword v36, v3, s[28:31], s66 offen sc1
    s_branch .back_z_13
.slow_z_14:
    s_mov_b32 s57, 0
.loop_zt4_1:
    s_add_u32 s57, s57, 1
    s_cmp_gt_u32 s57, 200000
    s_cbranch_scc1 .Lfail_4
    s_sleep 2
    buffer_load_dword v85, v84, s[28:31], 0 offen sc1
    s_waitcnt vmcnt(0)
    v_cmp_ne_u32 vcc, s11, v85
    s_cbranch_vccnz .loop_zt4_1
    s_nop 4
    s_branch .back_z_15
.sc1_z_33:
    buffer_store_dwordx4 v[56:59], v28, s[28:31], s68 offen sc1
    s_branch .back_z_34
.sc1_z_35:
    buffer_store_dwordx4 v[60:63], v28, s[28:31], s69 offen sc1
    s_branch .back_z_36
.sc1_z_37:
    buffer_store_dwordx4 v[64:67], v28, s[28:31], s70 offen sc1
    s_branch .back_z_38
.sc1_z_39:
    buffer_store_dword v2, v3, s[28:31], s66 offen sc1
    s_branch .back_z_40
.slow_a_3:
    s_mov_b32 s57, 0
.loop_at9_1:
    s_add_u32 s57, s57, 1
    s_cmp_gt_u32 s57, 200000
    s_cbranch_scc1 .Lfail_1
    s_sleep 2
    buffer_load_dwordx2 v[30:31], v29, s[28:31], 0 offen sc1
    s_waitcnt vmcnt(0)
    v_cmp_ne_u32 vcc, s11, v30
    s_cbranch_vccnz .loop_at9_1
    s_nop 4
    s_branch .back_a_4
.sc1_a_5:
    buffer_store_dwordx4 v[96:99], v186, s[28:31], s80 offen offset:0 sc1
    buffer_store_dwordx4 v[100:103], v186, s[28:31], s80 offen offset:512 sc1
    s_branch .back_a_6
.sc1_a_9:
    buffer_store_dwordx4 v[104:107], v186, s[28:31], s80 offen offset:0 sc1
    buffer_store_dwordx4 v[108:111], v186, s[28:31], s80 offen offset:512 sc1
    s_branch .back_a_10
.sc1_a_11:
    buffer_store_dword v2, v3, s[28:31], s63 offen sc1
    buffer_store_dword v36, v3, s[28:31], s66 offen sc1
    s_branch .back_a_12
.slow_a_14:
    s_mov_b32 s57, 0
.loop_at13_1:
    s_add_u32 s57, s57, 1
    s_cmp_gt_u32 s57, 200000
    s_cbranch_scc1 .Lfail_6
    s_sleep 2
    buffer_load_dwordx4 v[32:35], v2, s[28:31], 0 offen offset:0 sc1
    buffer_load_dwordx4 v[36:39], v2, s[28:31], 0 offen offset:1024 sc1
    s_waitcnt vmcnt(0)
    v_xor_b32 v33, s11, v32
    v_xor_b32 v35, s11, v34
    v_or_b32 v33, v33, v35
    v_xor_b32 v35, s11, v36
    v_or_b32 v33, v33, v35
    v_xor_b32 v35, s11, v38
    v_or_b32 v33, v33, v35
    v_cmp_ne_u32 vcc, 0, v33
    s_cbranch_vccnz .loop_at13_1
    s_nop 4
    s_branch .back_a_15
.slow_a_16:
    s_mov_b32 s57, 0
.loop_at14_1:
    s_add_u32 s57, s57, 1
    s_cmp_gt_u32 s57, 200000
    s_cbranch_scc1 .Lfail_4
    s_sleep 2
    buffer_load_dword v85, v84, s[28:31], 0 offen sc1
    s_waitcnt vmcnt(0)
    v_cmp_ne_u32 vcc, s11, v85
    s_cbranch_vccnz .loop_at14_1
    s_nop 4
    s_branch .back_a_17
.sc1_a_35:
    buffer_store_dwordx4 v[56:59], v28, s[28:31], s68 offen sc1
    s_branch .back_a_36
.sc1_a_37:
    buffer_store_dwordx4 v[60:63], v28, s[28:31], s69 offen sc1
    s_branch .back_a_38
.sc1_a_39:
    buffer_store_dwordx4 v[64:67], v28, s[28:31], s70 offen sc1
    s_branch .back_a_40
.sc1_a_41:
    buffer_store_dword v2, v3, s[28:31], s66 offen sc1
    s_branch .back_a_42
.Lfail_1:
    v_mov_b32 v2, 1
    v_mov_b32 v3, 36
    s_mov_b64 exec, 1
    buffer_store_dword v2, v3, s[48:51], 0 offen
    s_endpgm
.Lfail_2:
    v_mov_b32 v2, 2
    v_mov_b32 v3, 40
    s_mov_b64 exec, 1
    buffer_store_dword v2, v3, s[48:51], 0 offen
    s_endpgm
.Lfail_3:
    v_mov_b32 v2, 3
    v_mov_b32 v3, 44
    s_mov_b64 exec, 1
    buffer_store_dword v2, v3, s[48:51], 0 offen
    s_endpgm
.Lfail_4:
    v_mov_b32 v2, 4
    v_mov_b32 v3, 48
    s_mov_b64 exec, 1
    buffer_store_dword v2, v3, s[48:51], 0 offen
    s_endpgm
.Lfail_5:
    v_mov_b32 v2, 5
    v_mov_b32 v3, 52
    s_mov_b64 exec, 1
    buffer_store_dword v2, v3, s[48:51], 0 offen
    s_endpgm
.Lfail_6:
    v_mov_b32 v2, 6
    v_mov_b32 v3, 56
    s_mov_b64 exec, 1
    buffer_store_dword v2, v3, s[48:51], 0 offen
    s_endpgm
.Lend:
    s_endpgm
.Lcode_end:
.section .rodata,"a"
.p2align 6
.amdhsa_kernel parallel_sum__sliding_local_dilated__mixer_gmlp__prompt_kernel
  .amdhsa_next_free_vgpr 512
  .amdhsa_next_free_sgpr 102
  .amdhsa_accum_offset 256
  .amdhsa_group_segment_fixed_size 0
  .amdhsa_kernarg_size 88
  .amdhsa_user_sgpr_count 2
  .amdhsa_user_sgpr_kernarg_segment_ptr 1
  .amdhsa_system_sgpr_workgroup_id_x 1
.end_amdhsa_kernel
```
